```python
import torch

def _softmax(x, axis=-1):
    return torch.softmax(x, dim=axis)
def _gelu(x):
    return torch.nn.functional.gelu(x, approximate="tanh")
def _silu(x):
    return torch.nn.functional.silu(x)
def _sigmoid(x):
    return torch.sigmoid(x)
def _layernorm(x, axis=-1, eps=1e-5):
    m = x.mean(dim=axis, keepdim=True)
    v = x.var(dim=axis, keepdim=True, unbiased=False)
    return (x - m) / torch.sqrt(v + eps)
def _scatter_add(tgt, idx, src, axis=0):
    return tgt.clone().index_add_(axis, idx, src)
def _segment_sum(src, seg, n):
    out = torch.zeros((n,) + src.shape[1:], dtype=src.dtype)
    return out.index_add_(0, seg, src)
def _pad(x, pw):
    flat = tuple(v for pair in reversed(pw) for v in pair)
    return torch.nn.functional.pad(x, flat)

kernel_name = 'recurrent_scan__sliding_block_cached__glu_gated_reglu__prompt'

def setup_inputs():

    _w = (lambda a: (lambda t: t.to(torch.bfloat16) if t.is_floating_point() else t)(torch.as_tensor(a)))
    def _A_setup():
        B, Sq, D = 1, 2048, 512
        Hq, Hkv, Sk, Dh = 32, 8, 2048, 128
        assert Hq % Hkv == 0, (Hq, Hkv)
        return {
            "x": _w((lambda *s: torch.randn(*s, dtype=torch.bfloat16) * 0.05)(B, Sq, D)),
            "k_cache": _w((lambda *s: torch.randn(*s, dtype=torch.bfloat16) * 1.6)(B, Hkv, Sk, Dh)),
            "v_cache": _w((lambda *s: torch.randn(*s, dtype=torch.bfloat16) * 1.6)(B, Hkv, Sk, Dh)),
            "wq": _w((lambda *s: torch.randn(*s, dtype=torch.bfloat16) * 1.6)(D, Hq * Dh) * (D ** -0.5)),
            "wo": _w((lambda *s: torch.randn(*s, dtype=torch.bfloat16) * 1.6)(Hq * Dh, D) * ((Hq * Dh) ** -0.5)),
        }
    _A_in = _A_setup()

    def _B_setup():
        B, S, D, F = 1, 2048, 512, 1792
        return {
            "x": _w((lambda *s: torch.randn(*s, dtype=torch.bfloat16) * 0.05)(B, S, D)),
            "W_gate": _w((lambda *s: torch.randn(*s, dtype=torch.bfloat16) * 0.2)(D, F) * (2.0 / D) ** 0.5),
            "W_up": _w((lambda *s: torch.randn(*s, dtype=torch.bfloat16) * 0.2)(D, F) * (2.0 / D) ** 0.5),
            "W_down": _w((lambda *s: torch.randn(*s, dtype=torch.bfloat16) * 0.2)(F, D) * (1.0 / F) ** 0.5),
        }
    _B_in = _B_setup()

    return {
        "A_x": _A_in["x"],
        "A_k_cache": _A_in["k_cache"],
        "A_v_cache": _A_in["v_cache"],
        "A_wq": _A_in["wq"],
        "A_wo": _A_in["wo"],
        "B_x": _B_in["x"],
        "B_W_gate": _B_in["W_gate"],
        "B_W_up": _B_in["W_up"],
        "B_W_down": _B_in["W_down"],
    }

def reference(A_x, A_k_cache, A_v_cache, A_wq, A_wo, B_x, B_W_gate, B_W_up, B_W_down):
    def _A_ref(x, k_cache, v_cache, wq, wo):
        B, Sq, D = x.shape
        Hq, Dh = 32, 128
        Hkv, Sk = k_cache.shape[1], k_cache.shape[2]
        W = min(4096, max(256, Sk // 4))
        rep = Hq // Hkv
        q = (lambda x, *d: x.permute(*d))((x @ wq).reshape(B, Sq, Hq, Dh), 0, 2, 1, 3)
        k = (lambda x, n, axis: torch.repeat_interleave(x, n, dim=axis))(k_cache[:, :, Sk - W:, :], rep, axis=1)
        v = (lambda x, n, axis: torch.repeat_interleave(x, n, dim=axis))(v_cache[:, :, Sk - W:, :], rep, axis=1)
        scores = torch.einsum("bhqd,bhkd->bhqk", q, k) * (Dh ** -0.5)
        p = _softmax(scores, axis=-1)
        o = torch.einsum("bhqk,bhkd->bhqd", p, v)
        return (lambda x, *d: x.permute(*d))(o, 0, 2, 1, 3).reshape(B, Sq, Hq * Dh) @ wo

    def _B_ref(x, W_gate, W_up, W_down):
        gate = torch.einsum("bsd,df->bsf", x, W_gate)
        up = torch.einsum("bsd,df->bsf", x, W_up)
        gate = gate * (lambda x, dt: x.to(dt))(gate > 0, gate.dtype)
        h = gate * up
        return torch.einsum("bsf,fd->bsd", h, W_down)

    x = A_x
    xn = _layernorm(x, axis=-1)
    s = _A_ref(xn, A_k_cache, A_v_cache, A_wq, A_wo)
    g = _silu(_B_ref(xn, B_W_gate, B_W_up, B_W_down))
    return x + s * g
```

```asm
; @launch grid=(256,1,1) block=(256,1,1) lds=163840
.amdgcn_target "amdgcn-amd-amdhsa--gfx950"
.text
.globl recurrent_scan__sliding_block_cached__glu_gated_reglu__prompt_kernel
.p2align 8
.type recurrent_scan__sliding_block_cached__glu_gated_reglu__prompt_kernel,@function
recurrent_scan__sliding_block_cached__glu_gated_reglu__prompt_kernel:
  s_cmp_ge_u32 s2, 256
  s_cbranch_scc1 L_end
  s_load_dwordx16 s[64:79], s[0:1], 0
  s_load_dwordx8 s[80:87], s[0:1], 64
  s_and_b32 s49, s2, 7
  s_lshr_b32 s51, s2, 3
  s_and_b32 s44, s49, 3
  s_lshl_b32 s44, s44, 1
  s_and_b32 s52, s51, 1
  s_add_u32 s44, s44, s52
  s_lshr_b32 s45, s49, 2
  s_mul_i32 s45, s45, 16
  s_lshr_b32 s52, s51, 1
  s_add_u32 s45, s45, s52
  s_and_b32 s100, s45, 15
  s_lshl_b32 s100, s100, 1
  v_and_b32 v1, 63, v0
  v_lshrrev_b32 v46, 6, v0
  s_nop 0
  v_readfirstlane_b32 s46, v46
  v_and_b32 v48, 15, v1
  v_lshrrev_b32 v47, 4, v1
  s_lshl_b32 s49, s45, 6
  s_lshl_b32 s51, s46, 4
  s_add_u32 s49, s49, s51
  v_lshrrev_b32 v60, 2, v1
  v_and_b32 v61, 3, v1
  v_add_u32 v52, s49, v60
  v_lshlrev_b32 v52, 10, v52
  v_lshl_add_u32 v52, v61, 4, v52
  v_lshrrev_b32 v56, 3, v1
  v_and_b32 v57, 7, v1
  v_and_b32 v53, 2, v56
  v_xor_b32 v53, v53, v57
  s_lshl_b32 s98, s46, 7
  s_and_b32 s49, s44, 1
  s_lshl_b32 s52, s49, 6
  s_cmp_eq_u32 s46, 0
  s_cselect_b32 s52, 0, s52
  s_sub_u32 s98, s98, s52
  s_mul_i32 s52, s49, 3
  s_add_u32 s52, s52, s46
  s_cmp_eq_u32 s52, 3
  s_cselect_b32 s99, 1, 0
  s_cmp_eq_u32 s52, 6
  s_cselect_b32 s99, 0, s99
  s_mul_i32 s51, s44, 0x1c0
  s_add_u32 s51, s51, s98
  s_mov_b32 s52, 0xe00
  v_mul_lo_u32 v54, v56, s52
  v_add_u32 v54, s51, v54
  s_cmp_eq_u32 s99, 1
  s_cselect_b32 s52, 4, 8
  v_mov_b32 v58, 0x40000000
  v_xor_b32 v55, 0, v53
  v_cmp_gt_u32 vcc, s52, v55
  v_lshl_add_u32 v55, v55, 4, v54
  s_nop 0
  v_cndmask_b32 v36, v58, v55, vcc
  v_add_u32 v37, 0x6c00, v36
  v_xor_b32 v55, 4, v53
  v_cmp_gt_u32 vcc, s52, v55
  v_lshl_add_u32 v55, v55, 4, v54
  s_nop 0
  v_cndmask_b32 v38, v58, v55, vcc
  v_add_u32 v39, 0x6c00, v38
  s_mul_i32 s47, s46, 0x6000
  s_add_u32 s47, s47, 0x10000
  s_waitcnt lgkmcnt(0)
  s_mov_b32 s4, s64
  s_mov_b32 s5, s65
  s_mov_b32 s6, 0x200000
  s_mov_b32 s7, 0x20000
  buffer_load_dwordx4 v[64:67], v52, s[4:7], 0 offen
  buffer_load_dwordx4 v[68:71], v52, s[4:7], 0 offen offset:64
  buffer_load_dwordx4 v[72:75], v52, s[4:7], 0 offen offset:128
  buffer_load_dwordx4 v[76:79], v52, s[4:7], 0 offen offset:192
  buffer_load_dwordx4 v[80:83], v52, s[4:7], 0 offen offset:256
  buffer_load_dwordx4 v[84:87], v52, s[4:7], 0 offen offset:320
  buffer_load_dwordx4 v[88:91], v52, s[4:7], 0 offen offset:384
  buffer_load_dwordx4 v[92:95], v52, s[4:7], 0 offen offset:448
  buffer_load_dwordx4 v[96:99], v52, s[4:7], 0 offen offset:512
  buffer_load_dwordx4 v[100:103], v52, s[4:7], 0 offen offset:576
  buffer_load_dwordx4 v[104:107], v52, s[4:7], 0 offen offset:640
  buffer_load_dwordx4 v[108:111], v52, s[4:7], 0 offen offset:704
  buffer_load_dwordx4 v[112:115], v52, s[4:7], 0 offen offset:768
  buffer_load_dwordx4 v[116:119], v52, s[4:7], 0 offen offset:832
  buffer_load_dwordx4 v[120:123], v52, s[4:7], 0 offen offset:896
  buffer_load_dwordx4 v[124:127], v52, s[4:7], 0 offen offset:960
  s_mov_b32 s24, s76
  s_mov_b32 s25, s77
  s_mov_b32 s26, 0x1c0000
  s_mov_b32 s27, 0x20000
  s_mov_b32 s28, s78
  s_mov_b32 s29, s79
  s_mov_b32 s30, 0x1c0000
  s_mov_b32 s31, 0x20000
  s_lshl_b32 s51, s44, 19
  s_add_u32 s8, s66, s51
  s_addc_u32 s9, s67, 0
  s_add_u32 s8, s8, 0x60000
  s_addc_u32 s9, s9, 0
  s_mov_b32 s10, 0x20000
  s_mov_b32 s11, 0x20000
  s_add_u32 s12, s68, s51
  s_addc_u32 s13, s69, 0
  s_add_u32 s12, s12, 0x60000
  s_addc_u32 s13, s13, 0
  s_mov_b32 s14, 0x20000
  s_mov_b32 s15, 0x20000
  s_mov_b32 s16, s70
  s_mov_b32 s17, s71
  s_mov_b32 s18, 0x400000
  s_mov_b32 s19, 0x20000
  s_add_u32 s20, s72, s51
  s_addc_u32 s21, s73, 0
  s_mov_b32 s22, 0x80000
  s_mov_b32 s23, 0x20000
  s_mul_i32 s51, s44, 0x38000
  s_add_u32 s32, s80, s51
  s_addc_u32 s33, s81, 0
  s_mov_b32 s34, 0x38000
  s_mov_b32 s35, 0x20000
  s_lshl_b32 s51, s45, 19
  s_add_u32 s36, s86, s51
  s_addc_u32 s37, s87, 0
  s_mov_b32 s38, 0x80000
  s_mov_b32 s39, 0x20000
  s_add_u32 s40, s86, s51
  s_addc_u32 s41, s87, 0
  s_add_u32 s40, s40, 0x1000000
  s_addc_u32 s41, s41, 0
  s_mov_b32 s42, 0x80000
  s_mov_b32 s43, 0x20000
  s_mov_b32 s64, s82
  s_mov_b32 s65, s83
  s_mov_b32 s66, 0x200000
  s_mov_b32 s67, 0x20000
  s_lshl_b32 s51, s45, 2
  s_add_u32 s68, s84, s51
  s_addc_u32 s69, s85, 0
  s_mov_b32 s70, 4
  s_mov_b32 s71, 0x20000
  s_lshl_b32 s51, s45, 10
  s_add_u32 s72, s86, s51
  s_addc_u32 s73, s87, 0
  s_add_u32 s72, s72, 0x2000000
  s_addc_u32 s73, s73, 0
  s_mov_b32 s74, 0x400
  s_mov_b32 s75, 0x20000
  s_cmp_eq_u32 s44, 0
  s_cselect_b32 s51, s46, 1
  s_cmp_eq_u32 s51, 0
  s_cbranch_scc0 L_no_nonce
  s_memrealtime s[90:91]
  s_waitcnt lgkmcnt(0)
  s_or_b32 s90, s90, 1
  v_mov_b32 v60, s90
  v_mov_b32 v61, 0
  buffer_store_dword v60, v61, s[68:71], 0 offen sc1
L_no_nonce:
  s_mov_b32 s54, 0x3f803f80
  s_mov_b32 s50, 0x4b800000
  s_mov_b32 s101, 0x3f803f80
  s_mov_b32 s63, 0x3e0293ee
  s_mov_b32 s62, s100
  s_sub_u32 s51, s62, 28
  s_cmp_ge_u32 s62, 28
  s_cselect_b32 s62, s51, s62
  s_sub_u32 s51, s62, 14
  s_cmp_ge_u32 s62, 14
  s_cselect_b32 s62, s51, s62
  v_lshlrev_b32 v2, 4, v1
  v_add_u32 v3, 0, v2
  v_lshlrev_b32 v53, 2, v47
  v_xor_b32 v53, v53, v48
  v_lshlrev_b32 v53, 4, v53
  v_lshl_add_u32 v26, v47, 8, v53
  s_lshl_b32 s51, s46, 8
  v_lshl_add_u32 v54, v47, 10, v53
  v_add_u32 v20, s51, v54
  v_add_u32 v21, 0xc00, v20
  v_add_u32 v22, 0x1800, v20
  v_add_u32 v23, 0x2400, v20
  s_lshl_b32 s52, s44, 10
  s_add_u32 s51, s51, s52
  v_lshl_add_u32 v54, v47, 13, v53
  v_add_u32 v40, s51, v54
  v_add_u32 v41, 0x7c00, v40
  v_add_u32 v42, 0xf800, v40
  v_add_u32 v43, 0x17400, v40
  s_lshl_b32 s51, s46, 3
  v_add_u32 v54, s51, v47
  v_and_b32 v54, 15, v54
  v_xor_b32 v54, v54, v48
  v_lshlrev_b32 v54, 4, v54
  v_lshl_add_u32 v24, v47, 8, v54
  v_add_u32 v54, s51, v47
  v_add_u32 v54, 4, v54
  v_and_b32 v54, 15, v54
  v_xor_b32 v54, v54, v48
  v_lshlrev_b32 v54, 4, v54
  v_lshl_add_u32 v25, v47, 8, v54
  v_and_b32 v49, 1, v47
  v_lshrrev_b32 v50, 5, v1
  v_bfe_u32 v59, v1, 2, 2
  v_and_b32 v51, 3, v1
  v_lshl_add_u32 v53, v50, 2, v59
  v_lshlrev_b32 v53, 8, v53
  v_lshl_add_u32 v53, v49, 5, v53
  v_lshl_add_u32 v54, v51, 3, v53
  v_xor_b32 v55, 0, v59
  v_lshl_add_u32 v55, v55, 6, v54
  v_add_u32 v4, s47, v55
  v_add_u32 v8, 0, v55
  v_xor_b32 v55, 1, v59
  v_lshl_add_u32 v55, v55, 6, v54
  v_add_u32 v5, s47, v55
  v_add_u32 v9, 0, v55
  v_xor_b32 v55, 2, v59
  v_lshl_add_u32 v55, v55, 6, v54
  v_add_u32 v6, s47, v55
  v_add_u32 v10, 0, v55
  v_xor_b32 v55, 3, v59
  v_lshl_add_u32 v55, v55, 6, v54
  v_add_u32 v7, s47, v55
  v_add_u32 v11, 0, v55
  v_lshl_add_u32 v53, v50, 3, v59
  v_lshlrev_b32 v53, 8, v53
  v_lshl_add_u32 v53, v49, 5, v53
  v_lshrrev_b32 v54, 1, v51
  v_and_b32 v55, 1, v51
  v_lshl_or_b32 v54, v55, 1, v54
  v_lshl_add_u32 v54, v54, 3, v53
  v_xor_b32 v55, 0, v59
  v_lshl_add_u32 v55, v55, 6, v54
  v_add_u32 v28, s47, v55
  v_xor_b32 v55, 1, v59
  v_lshl_add_u32 v55, v55, 6, v54
  v_add_u32 v29, s47, v55
  v_xor_b32 v55, 2, v59
  v_lshl_add_u32 v55, v55, 6, v54
  v_add_u32 v30, s47, v55
  v_xor_b32 v55, 3, v59
  v_lshl_add_u32 v55, v55, 6, v54
  v_add_u32 v31, s47, v55
  v_lshl_add_u32 v53, v50, 3, v59
  v_lshlrev_b32 v53, 7, v53
  v_lshl_add_u32 v53, v49, 11, v53
  v_lshl_add_u32 v53, v51, 3, v53
  v_lshrrev_b32 v54, 1, v59
  v_lshl_or_b32 v54, v49, 1, v54
  v_xor_b32 v55, 0, v54
  v_lshl_add_u32 v55, v55, 5, v53
  v_add_u32 v32, s47, v55
  v_xor_b32 v55, 1, v54
  v_lshl_add_u32 v55, v55, 5, v53
  v_add_u32 v33, s47, v55
  v_xor_b32 v55, 2, v54
  v_lshl_add_u32 v55, v55, 5, v53
  v_add_u32 v34, s47, v55
  v_xor_b32 v55, 3, v54
  v_lshl_add_u32 v55, v55, 5, v53
  v_add_u32 v35, s47, v55
  v_and_b32 v53, 31, v1
  v_and_b32 v54, 15, v1
  v_xor_b32 v54, v54, v50
  v_lshlrev_b32 v54, 4, v54
  v_lshlrev_b32 v53, 8, v53
  v_add_u32 v53, 0, v53
  v_xor_b32 v55, 0, v54
  v_add_u32 v12, v53, v55
  v_xor_b32 v55, 32, v54
  v_add_u32 v13, v53, v55
  v_xor_b32 v55, 64, v54
  v_add_u32 v14, v53, v55
  v_xor_b32 v55, 0x60, v54
  v_add_u32 v15, v53, v55
  v_xor_b32 v55, 0x80, v54
  v_add_u32 v16, v53, v55
  v_xor_b32 v55, 0xa0, v54
  v_add_u32 v17, v53, v55
  v_xor_b32 v55, 0xc0, v54
  v_add_u32 v18, v53, v55
  v_xor_b32 v55, 0xe0, v54
  v_add_u32 v19, v53, v55
  s_lshl_b32 s51, s46, 14
  s_lshl_b32 s52, s44, 11
  s_add_u32 s51, s51, s52
  v_add_u32 v27, s51, v2
  s_lshl_b32 s51, s98, 6
  v_add_u32 v44, s51, v3
  s_add_u32 s51, s51, 0x1000
  s_cmp_eq_u32 s99, 1
  s_cselect_b32 s51, 28672, s51
  v_add_u32 v45, s51, v3
  s_lshr_b32 s51, s46, 1
  s_lshl_b32 s51, s51, 10
  s_and_b32 s52, s46, 1
  s_lshl_b32 s52, s52, 4
  v_lshrrev_b32 v53, 2, v1
  v_add_u32 v53, s52, v53
  v_and_b32 v54, 3, v1
  v_lshrrev_b32 v55, 1, v54
  v_and_b32 v54, 1, v54
  v_lshlrev_b32 v62, 11, v55
  v_lshl_add_u32 v62, v54, 9, v62
  v_lshlrev_b32 v55, 2, v55
  v_lshl_or_b32 v55, v54, 1, v55
  v_xor_b32 v53, v53, v55
  v_lshl_add_u32 v62, v53, 4, v62
  v_add_u32 v62, s51, v62
  v_and_b32 v53, 31, v1
  v_lshlrev_b32 v54, 1, v50
  v_xor_b32 v53, v53, v54
  v_lshlrev_b32 v53, 4, v53
  v_lshl_add_u32 v63, v50, 9, v53
  v_mov_b32 v46, 0
  v_mov_b32 v47, 0
  v_mov_b32 v48, 0
  v_mov_b32 v49, 0
  s_waitcnt vmcnt(15)
  v_dot2_f32_bf16 v47, v64, s54, v47
  v_dot2_f32_bf16 v49, v64, v64, v49
  v_dot2_f32_bf16 v46, v65, s54, v46
  v_dot2_f32_bf16 v48, v65, v65, v48
  v_dot2_f32_bf16 v47, v66, s54, v47
  v_dot2_f32_bf16 v49, v66, v66, v49
  v_dot2_f32_bf16 v46, v67, s54, v46
  v_dot2_f32_bf16 v48, v67, v67, v48
  s_mul_i32 s48, s100, 0xe000
  s_add_u32 m0, s47, 0
  s_nop 0
  buffer_load_dwordx4 v36, s[24:27], s48 offen lds
  buffer_load_dwordx4 v37, s[24:27], s48 offen offset:1024 lds
  s_add_u32 m0, s47, 0x800
  s_nop 0
  buffer_load_dwordx4 v38, s[28:31], s48 offen lds
  buffer_load_dwordx4 v39, s[28:31], s48 offen offset:1024 lds
  s_add_u32 s48, s48, 0xe000
  s_cmp_eq_u32 s48, 0x1c0000
  s_cselect_b32 s48, 0, s48
  s_waitcnt vmcnt(18)
  v_dot2_f32_bf16 v47, v68, s54, v47
  v_dot2_f32_bf16 v49, v68, v68, v49
  v_dot2_f32_bf16 v46, v69, s54, v46
  v_dot2_f32_bf16 v48, v69, v69, v48
  v_dot2_f32_bf16 v47, v70, s54, v47
  v_dot2_f32_bf16 v49, v70, v70, v49
  v_dot2_f32_bf16 v46, v71, s54, v46
  v_dot2_f32_bf16 v48, v71, v71, v48
  s_waitcnt vmcnt(17)
  v_dot2_f32_bf16 v47, v72, s54, v47
  v_dot2_f32_bf16 v49, v72, v72, v49
  v_dot2_f32_bf16 v46, v73, s54, v46
  v_dot2_f32_bf16 v48, v73, v73, v48
  v_dot2_f32_bf16 v47, v74, s54, v47
  v_dot2_f32_bf16 v49, v74, v74, v49
  v_dot2_f32_bf16 v46, v75, s54, v46
  v_dot2_f32_bf16 v48, v75, v75, v48
  s_waitcnt vmcnt(16)
  v_dot2_f32_bf16 v47, v76, s54, v47
  v_dot2_f32_bf16 v49, v76, v76, v49
  v_dot2_f32_bf16 v46, v77, s54, v46
  v_dot2_f32_bf16 v48, v77, v77, v48
  v_dot2_f32_bf16 v47, v78, s54, v47
  v_dot2_f32_bf16 v49, v78, v78, v49
  v_dot2_f32_bf16 v46, v79, s54, v46
  v_dot2_f32_bf16 v48, v79, v79, v48
  s_waitcnt vmcnt(15)
  v_dot2_f32_bf16 v47, v80, s54, v47
  v_dot2_f32_bf16 v49, v80, v80, v49
  v_dot2_f32_bf16 v46, v81, s54, v46
  v_dot2_f32_bf16 v48, v81, v81, v48
  v_dot2_f32_bf16 v47, v82, s54, v47
  v_dot2_f32_bf16 v49, v82, v82, v49
  v_dot2_f32_bf16 v46, v83, s54, v46
  v_dot2_f32_bf16 v48, v83, v83, v48
  s_waitcnt vmcnt(14)
  v_dot2_f32_bf16 v47, v84, s54, v47
  v_dot2_f32_bf16 v49, v84, v84, v49
  v_dot2_f32_bf16 v46, v85, s54, v46
  v_dot2_f32_bf16 v48, v85, v85, v48
  v_dot2_f32_bf16 v47, v86, s54, v47
  v_dot2_f32_bf16 v49, v86, v86, v49
  v_dot2_f32_bf16 v46, v87, s54, v46
  v_dot2_f32_bf16 v48, v87, v87, v48
  s_waitcnt vmcnt(13)
  v_dot2_f32_bf16 v47, v88, s54, v47
  v_dot2_f32_bf16 v49, v88, v88, v49
  v_dot2_f32_bf16 v46, v89, s54, v46
  v_dot2_f32_bf16 v48, v89, v89, v48
  v_dot2_f32_bf16 v47, v90, s54, v47
  v_dot2_f32_bf16 v49, v90, v90, v49
  v_dot2_f32_bf16 v46, v91, s54, v46
  v_dot2_f32_bf16 v48, v91, v91, v48
  s_waitcnt vmcnt(12)
  v_dot2_f32_bf16 v47, v92, s54, v47
  v_dot2_f32_bf16 v49, v92, v92, v49
  v_dot2_f32_bf16 v46, v93, s54, v46
  v_dot2_f32_bf16 v48, v93, v93, v48
  v_dot2_f32_bf16 v47, v94, s54, v47
  v_dot2_f32_bf16 v49, v94, v94, v49
  v_dot2_f32_bf16 v46, v95, s54, v46
  v_dot2_f32_bf16 v48, v95, v95, v48
  s_waitcnt vmcnt(11)
  v_dot2_f32_bf16 v47, v96, s54, v47
  v_dot2_f32_bf16 v49, v96, v96, v49
  v_dot2_f32_bf16 v46, v97, s54, v46
  v_dot2_f32_bf16 v48, v97, v97, v48
  v_dot2_f32_bf16 v47, v98, s54, v47
  v_dot2_f32_bf16 v49, v98, v98, v49
  v_dot2_f32_bf16 v46, v99, s54, v46
  v_dot2_f32_bf16 v48, v99, v99, v48
  s_waitcnt vmcnt(10)
  v_dot2_f32_bf16 v47, v100, s54, v47
  v_dot2_f32_bf16 v49, v100, v100, v49
  v_dot2_f32_bf16 v46, v101, s54, v46
  v_dot2_f32_bf16 v48, v101, v101, v48
  v_dot2_f32_bf16 v47, v102, s54, v47
  v_dot2_f32_bf16 v49, v102, v102, v49
  v_dot2_f32_bf16 v46, v103, s54, v46
  v_dot2_f32_bf16 v48, v103, v103, v48
  s_waitcnt vmcnt(9)
  v_dot2_f32_bf16 v47, v104, s54, v47
  v_dot2_f32_bf16 v49, v104, v104, v49
  v_dot2_f32_bf16 v46, v105, s54, v46
  v_dot2_f32_bf16 v48, v105, v105, v48
  v_dot2_f32_bf16 v47, v106, s54, v47
  v_dot2_f32_bf16 v49, v106, v106, v49
  v_dot2_f32_bf16 v46, v107, s54, v46
  v_dot2_f32_bf16 v48, v107, v107, v48
  s_waitcnt vmcnt(8)
  v_dot2_f32_bf16 v47, v108, s54, v47
  v_dot2_f32_bf16 v49, v108, v108, v49
  v_dot2_f32_bf16 v46, v109, s54, v46
  v_dot2_f32_bf16 v48, v109, v109, v48
  v_dot2_f32_bf16 v47, v110, s54, v47
  v_dot2_f32_bf16 v49, v110, v110, v49
  v_dot2_f32_bf16 v46, v111, s54, v46
  v_dot2_f32_bf16 v48, v111, v111, v48
  s_waitcnt vmcnt(7)
  v_dot2_f32_bf16 v47, v112, s54, v47
  v_dot2_f32_bf16 v49, v112, v112, v49
  v_dot2_f32_bf16 v46, v113, s54, v46
  v_dot2_f32_bf16 v48, v113, v113, v48
  v_dot2_f32_bf16 v47, v114, s54, v47
  v_dot2_f32_bf16 v49, v114, v114, v49
  v_dot2_f32_bf16 v46, v115, s54, v46
  v_dot2_f32_bf16 v48, v115, v115, v48
  s_waitcnt vmcnt(6)
  v_dot2_f32_bf16 v47, v116, s54, v47
  v_dot2_f32_bf16 v49, v116, v116, v49
  v_dot2_f32_bf16 v46, v117, s54, v46
  v_dot2_f32_bf16 v48, v117, v117, v48
  v_dot2_f32_bf16 v47, v118, s54, v47
  v_dot2_f32_bf16 v49, v118, v118, v49
  v_dot2_f32_bf16 v46, v119, s54, v46
  v_dot2_f32_bf16 v48, v119, v119, v48
  s_waitcnt vmcnt(5)
  v_dot2_f32_bf16 v47, v120, s54, v47
  v_dot2_f32_bf16 v49, v120, v120, v49
  v_dot2_f32_bf16 v46, v121, s54, v46
  v_dot2_f32_bf16 v48, v121, v121, v48
  v_dot2_f32_bf16 v47, v122, s54, v47
  v_dot2_f32_bf16 v49, v122, v122, v49
  v_dot2_f32_bf16 v46, v123, s54, v46
  v_dot2_f32_bf16 v48, v123, v123, v48
  s_waitcnt vmcnt(4)
  v_dot2_f32_bf16 v47, v124, s54, v47
  v_dot2_f32_bf16 v49, v124, v124, v49
  v_dot2_f32_bf16 v46, v125, s54, v46
  v_dot2_f32_bf16 v48, v125, v125, v48
  v_dot2_f32_bf16 v47, v126, s54, v47
  v_dot2_f32_bf16 v49, v126, v126, v49
  v_dot2_f32_bf16 v46, v127, s54, v46
  v_dot2_f32_bf16 v48, v127, v127, v48
  s_nop 2
  v_add_f32 v46, v46, v47
  v_add_f32 v48, v48, v49
  s_nop 0
  v_add_f32_dpp v47, v46, v46 quad_perm:[1,0,3,2] row_mask:0xf bank_mask:0xf
  v_add_f32_dpp v49, v48, v48 quad_perm:[1,0,3,2] row_mask:0xf bank_mask:0xf
  s_nop 0
  v_add_f32_dpp v46, v47, v47 quad_perm:[2,3,0,1] row_mask:0xf bank_mask:0xf
  v_add_f32_dpp v48, v49, v49 quad_perm:[2,3,0,1] row_mask:0xf bank_mask:0xf
  v_mul_f32 v50, 0x3b000000, v46
  v_mul_f32 v48, 0x3b000000, v48
  v_fma_f32 v48, -v50, v50, v48
  v_max_f32 v48, 0, v48
  v_add_f32 v48, 0x3727c5ac, v48
  v_rsq_f32 v52, v48
  s_nop 0
  v_mul_f32 v52, 0x3e0293ee, v52
  v_mul_f32 v54, v50, v52
  v_sub_f32 v54, 0, v54
  v_lshlrev_b32 v192, 16, v64
  v_and_b32 v193, 0xffff0000, v64
  v_lshlrev_b32 v194, 16, v65
  v_and_b32 v195, 0xffff0000, v65
  v_lshlrev_b32 v196, 16, v66
  v_and_b32 v197, 0xffff0000, v66
  v_lshlrev_b32 v198, 16, v67
  v_and_b32 v199, 0xffff0000, v67
  v_pk_fma_f32 v[192:193], v[192:193], v[52:53], v[54:55] op_sel_hi:[1,0,0]
  v_pk_fma_f32 v[194:195], v[194:195], v[52:53], v[54:55] op_sel_hi:[1,0,0]
  v_pk_fma_f32 v[196:197], v[196:197], v[52:53], v[54:55] op_sel_hi:[1,0,0]
  v_pk_fma_f32 v[198:199], v[198:199], v[52:53], v[54:55] op_sel_hi:[1,0,0]
  v_cvt_pk_bf16_f32 v64, v192, v193
  v_cvt_pk_bf16_f32 v65, v194, v195
  v_cvt_pk_bf16_f32 v66, v196, v197
  v_cvt_pk_bf16_f32 v67, v198, v199
  ds_write_b128 v62, v[64:67]
  s_add_u32 m0, s47, 0x1000
  s_nop 0
  buffer_load_dwordx4 v36, s[24:27], s48 offen lds
  v_lshlrev_b32 v200, 16, v68
  v_and_b32 v201, 0xffff0000, v68
  v_lshlrev_b32 v202, 16, v69
  v_and_b32 v203, 0xffff0000, v69
  v_lshlrev_b32 v204, 16, v70
  v_and_b32 v205, 0xffff0000, v70
  v_lshlrev_b32 v206, 16, v71
  v_and_b32 v207, 0xffff0000, v71
  v_pk_fma_f32 v[200:201], v[200:201], v[52:53], v[54:55] op_sel_hi:[1,0,0]
  v_pk_fma_f32 v[202:203], v[202:203], v[52:53], v[54:55] op_sel_hi:[1,0,0]
  v_pk_fma_f32 v[204:205], v[204:205], v[52:53], v[54:55] op_sel_hi:[1,0,0]
  v_pk_fma_f32 v[206:207], v[206:207], v[52:53], v[54:55] op_sel_hi:[1,0,0]
  v_cvt_pk_bf16_f32 v68, v200, v201
  v_cvt_pk_bf16_f32 v69, v202, v203
  v_cvt_pk_bf16_f32 v70, v204, v205
  v_cvt_pk_bf16_f32 v71, v206, v207
  ds_write_b128 v62, v[68:71] offset:4096
  buffer_load_dwordx4 v37, s[24:27], s48 offen offset:1024 lds
  s_add_u32 m0, s47, 0x1800
  v_lshlrev_b32 v192, 16, v72
  v_and_b32 v193, 0xffff0000, v72
  v_lshlrev_b32 v194, 16, v73
  v_and_b32 v195, 0xffff0000, v73
  v_lshlrev_b32 v196, 16, v74
  v_and_b32 v197, 0xffff0000, v74
  v_lshlrev_b32 v198, 16, v75
  v_and_b32 v199, 0xffff0000, v75
  v_pk_fma_f32 v[192:193], v[192:193], v[52:53], v[54:55] op_sel_hi:[1,0,0]
  v_pk_fma_f32 v[194:195], v[194:195], v[52:53], v[54:55] op_sel_hi:[1,0,0]
  v_pk_fma_f32 v[196:197], v[196:197], v[52:53], v[54:55] op_sel_hi:[1,0,0]
  v_pk_fma_f32 v[198:199], v[198:199], v[52:53], v[54:55] op_sel_hi:[1,0,0]
  v_cvt_pk_bf16_f32 v72, v192, v193
  v_cvt_pk_bf16_f32 v73, v194, v195
  v_cvt_pk_bf16_f32 v74, v196, v197
  v_cvt_pk_bf16_f32 v75, v198, v199
  ds_write_b128 v62, v[72:75] offset:8192
  buffer_load_dwordx4 v38, s[28:31], s48 offen lds
  buffer_load_dwordx4 v39, s[28:31], s48 offen offset:1024 lds
  v_lshlrev_b32 v200, 16, v76
  v_and_b32 v201, 0xffff0000, v76
  v_lshlrev_b32 v202, 16, v77
  v_and_b32 v203, 0xffff0000, v77
  v_lshlrev_b32 v204, 16, v78
  v_and_b32 v205, 0xffff0000, v78
  v_lshlrev_b32 v206, 16, v79
  v_and_b32 v207, 0xffff0000, v79
  v_pk_fma_f32 v[200:201], v[200:201], v[52:53], v[54:55] op_sel_hi:[1,0,0]
  v_pk_fma_f32 v[202:203], v[202:203], v[52:53], v[54:55] op_sel_hi:[1,0,0]
  v_pk_fma_f32 v[204:205], v[204:205], v[52:53], v[54:55] op_sel_hi:[1,0,0]
  v_pk_fma_f32 v[206:207], v[206:207], v[52:53], v[54:55] op_sel_hi:[1,0,0]
  v_cvt_pk_bf16_f32 v76, v200, v201
  v_cvt_pk_bf16_f32 v77, v202, v203
  v_cvt_pk_bf16_f32 v78, v204, v205
  v_cvt_pk_bf16_f32 v79, v206, v207
  ds_write_b128 v62, v[76:79] offset:12288
  s_add_u32 s48, s48, 0xe000
  s_cmp_eq_u32 s48, 0x1c0000
  s_cselect_b32 s48, 0, s48
  v_lshlrev_b32 v192, 16, v80
  v_and_b32 v193, 0xffff0000, v80
  v_lshlrev_b32 v194, 16, v81
  v_and_b32 v195, 0xffff0000, v81
  v_lshlrev_b32 v196, 16, v82
  v_and_b32 v197, 0xffff0000, v82
  v_lshlrev_b32 v198, 16, v83
  v_and_b32 v199, 0xffff0000, v83
  v_pk_fma_f32 v[192:193], v[192:193], v[52:53], v[54:55] op_sel_hi:[1,0,0]
  v_pk_fma_f32 v[194:195], v[194:195], v[52:53], v[54:55] op_sel_hi:[1,0,0]
  v_pk_fma_f32 v[196:197], v[196:197], v[52:53], v[54:55] op_sel_hi:[1,0,0]
  v_pk_fma_f32 v[198:199], v[198:199], v[52:53], v[54:55] op_sel_hi:[1,0,0]
  v_cvt_pk_bf16_f32 v80, v192, v193
  v_cvt_pk_bf16_f32 v81, v194, v195
  v_cvt_pk_bf16_f32 v82, v196, v197
  v_cvt_pk_bf16_f32 v83, v198, v199
  ds_write_b128 v62, v[80:83] offset:16384
  s_add_u32 m0, s47, 0x2000
  s_nop 0
  buffer_load_dwordx4 v36, s[24:27], s48 offen lds
  v_lshlrev_b32 v200, 16, v84
  v_and_b32 v201, 0xffff0000, v84
  v_lshlrev_b32 v202, 16, v85
  v_and_b32 v203, 0xffff0000, v85
  v_lshlrev_b32 v204, 16, v86
  v_and_b32 v205, 0xffff0000, v86
  v_lshlrev_b32 v206, 16, v87
  v_and_b32 v207, 0xffff0000, v87
  v_pk_fma_f32 v[200:201], v[200:201], v[52:53], v[54:55] op_sel_hi:[1,0,0]
  v_pk_fma_f32 v[202:203], v[202:203], v[52:53], v[54:55] op_sel_hi:[1,0,0]
  v_pk_fma_f32 v[204:205], v[204:205], v[52:53], v[54:55] op_sel_hi:[1,0,0]
  v_pk_fma_f32 v[206:207], v[206:207], v[52:53], v[54:55] op_sel_hi:[1,0,0]
  v_cvt_pk_bf16_f32 v84, v200, v201
  v_cvt_pk_bf16_f32 v85, v202, v203
  v_cvt_pk_bf16_f32 v86, v204, v205
  v_cvt_pk_bf16_f32 v87, v206, v207
  ds_write_b128 v62, v[84:87] offset:20480
  buffer_load_dwordx4 v37, s[24:27], s48 offen offset:1024 lds
  s_add_u32 m0, s47, 0x2800
  v_lshlrev_b32 v192, 16, v88
  v_and_b32 v193, 0xffff0000, v88
  v_lshlrev_b32 v194, 16, v89
  v_and_b32 v195, 0xffff0000, v89
  v_lshlrev_b32 v196, 16, v90
  v_and_b32 v197, 0xffff0000, v90
  v_lshlrev_b32 v198, 16, v91
  v_and_b32 v199, 0xffff0000, v91
  v_pk_fma_f32 v[192:193], v[192:193], v[52:53], v[54:55] op_sel_hi:[1,0,0]
  v_pk_fma_f32 v[194:195], v[194:195], v[52:53], v[54:55] op_sel_hi:[1,0,0]
  v_pk_fma_f32 v[196:197], v[196:197], v[52:53], v[54:55] op_sel_hi:[1,0,0]
  v_pk_fma_f32 v[198:199], v[198:199], v[52:53], v[54:55] op_sel_hi:[1,0,0]
  v_cvt_pk_bf16_f32 v88, v192, v193
  v_cvt_pk_bf16_f32 v89, v194, v195
  v_cvt_pk_bf16_f32 v90, v196, v197
  v_cvt_pk_bf16_f32 v91, v198, v199
  ds_write_b128 v62, v[88:91] offset:24576
  buffer_load_dwordx4 v38, s[28:31], s48 offen lds
  buffer_load_dwordx4 v39, s[28:31], s48 offen offset:1024 lds
  v_lshlrev_b32 v200, 16, v92
  v_and_b32 v201, 0xffff0000, v92
  v_lshlrev_b32 v202, 16, v93
  v_and_b32 v203, 0xffff0000, v93
  v_lshlrev_b32 v204, 16, v94
  v_and_b32 v205, 0xffff0000, v94
  v_lshlrev_b32 v206, 16, v95
  v_and_b32 v207, 0xffff0000, v95
  v_pk_fma_f32 v[200:201], v[200:201], v[52:53], v[54:55] op_sel_hi:[1,0,0]
  v_pk_fma_f32 v[202:203], v[202:203], v[52:53], v[54:55] op_sel_hi:[1,0,0]
  v_pk_fma_f32 v[204:205], v[204:205], v[52:53], v[54:55] op_sel_hi:[1,0,0]
  v_pk_fma_f32 v[206:207], v[206:207], v[52:53], v[54:55] op_sel_hi:[1,0,0]
  v_cvt_pk_bf16_f32 v92, v200, v201
  v_cvt_pk_bf16_f32 v93, v202, v203
  v_cvt_pk_bf16_f32 v94, v204, v205
  v_cvt_pk_bf16_f32 v95, v206, v207
  ds_write_b128 v62, v[92:95] offset:28672
  s_add_u32 s48, s48, 0xe000
  s_cmp_eq_u32 s48, 0x1c0000
  s_cselect_b32 s48, 0, s48
  v_lshlrev_b32 v192, 16, v96
  v_and_b32 v193, 0xffff0000, v96
  v_lshlrev_b32 v194, 16, v97
  v_and_b32 v195, 0xffff0000, v97
  v_lshlrev_b32 v196, 16, v98
  v_and_b32 v197, 0xffff0000, v98
  v_lshlrev_b32 v198, 16, v99
  v_and_b32 v199, 0xffff0000, v99
  v_pk_fma_f32 v[192:193], v[192:193], v[52:53], v[54:55] op_sel_hi:[1,0,0]
  v_pk_fma_f32 v[194:195], v[194:195], v[52:53], v[54:55] op_sel_hi:[1,0,0]
  v_pk_fma_f32 v[196:197], v[196:197], v[52:53], v[54:55] op_sel_hi:[1,0,0]
  v_pk_fma_f32 v[198:199], v[198:199], v[52:53], v[54:55] op_sel_hi:[1,0,0]
  v_cvt_pk_bf16_f32 v96, v192, v193
  v_cvt_pk_bf16_f32 v97, v194, v195
  v_cvt_pk_bf16_f32 v98, v196, v197
  v_cvt_pk_bf16_f32 v99, v198, v199
  ds_write_b128 v62, v[96:99] offset:32768
  s_add_u32 m0, s47, 0x3000
  s_nop 0
  buffer_load_dwordx4 v36, s[24:27], s48 offen lds
  v_lshlrev_b32 v200, 16, v100
  v_and_b32 v201, 0xffff0000, v100
  v_lshlrev_b32 v202, 16, v101
  v_and_b32 v203, 0xffff0000, v101
  v_lshlrev_b32 v204, 16, v102
  v_and_b32 v205, 0xffff0000, v102
  v_lshlrev_b32 v206, 16, v103
  v_and_b32 v207, 0xffff0000, v103
  v_pk_fma_f32 v[200:201], v[200:201], v[52:53], v[54:55] op_sel_hi:[1,0,0]
  v_pk_fma_f32 v[202:203], v[202:203], v[52:53], v[54:55] op_sel_hi:[1,0,0]
  v_pk_fma_f32 v[204:205], v[204:205], v[52:53], v[54:55] op_sel_hi:[1,0,0]
  v_pk_fma_f32 v[206:207], v[206:207], v[52:53], v[54:55] op_sel_hi:[1,0,0]
  v_cvt_pk_bf16_f32 v100, v200, v201
  v_cvt_pk_bf16_f32 v101, v202, v203
  v_cvt_pk_bf16_f32 v102, v204, v205
  v_cvt_pk_bf16_f32 v103, v206, v207
  ds_write_b128 v62, v[100:103] offset:36864
  buffer_load_dwordx4 v37, s[24:27], s48 offen offset:1024 lds
  s_add_u32 m0, s47, 0x3800
  v_lshlrev_b32 v192, 16, v104
  v_and_b32 v193, 0xffff0000, v104
  v_lshlrev_b32 v194, 16, v105
  v_and_b32 v195, 0xffff0000, v105
  v_lshlrev_b32 v196, 16, v106
  v_and_b32 v197, 0xffff0000, v106
  v_lshlrev_b32 v198, 16, v107
  v_and_b32 v199, 0xffff0000, v107
  v_pk_fma_f32 v[192:193], v[192:193], v[52:53], v[54:55] op_sel_hi:[1,0,0]
  v_pk_fma_f32 v[194:195], v[194:195], v[52:53], v[54:55] op_sel_hi:[1,0,0]
  v_pk_fma_f32 v[196:197], v[196:197], v[52:53], v[54:55] op_sel_hi:[1,0,0]
  v_pk_fma_f32 v[198:199], v[198:199], v[52:53], v[54:55] op_sel_hi:[1,0,0]
  v_cvt_pk_bf16_f32 v104, v192, v193
  v_cvt_pk_bf16_f32 v105, v194, v195
  v_cvt_pk_bf16_f32 v106, v196, v197
  v_cvt_pk_bf16_f32 v107, v198, v199
  ds_write_b128 v62, v[104:107] offset:40960
  buffer_load_dwordx4 v38, s[28:31], s48 offen lds
  buffer_load_dwordx4 v39, s[28:31], s48 offen offset:1024 lds
  v_lshlrev_b32 v200, 16, v108
  v_and_b32 v201, 0xffff0000, v108
  v_lshlrev_b32 v202, 16, v109
  v_and_b32 v203, 0xffff0000, v109
  v_lshlrev_b32 v204, 16, v110
  v_and_b32 v205, 0xffff0000, v110
  v_lshlrev_b32 v206, 16, v111
  v_and_b32 v207, 0xffff0000, v111
  v_pk_fma_f32 v[200:201], v[200:201], v[52:53], v[54:55] op_sel_hi:[1,0,0]
  v_pk_fma_f32 v[202:203], v[202:203], v[52:53], v[54:55] op_sel_hi:[1,0,0]
  v_pk_fma_f32 v[204:205], v[204:205], v[52:53], v[54:55] op_sel_hi:[1,0,0]
  v_pk_fma_f32 v[206:207], v[206:207], v[52:53], v[54:55] op_sel_hi:[1,0,0]
  v_cvt_pk_bf16_f32 v108, v200, v201
  v_cvt_pk_bf16_f32 v109, v202, v203
  v_cvt_pk_bf16_f32 v110, v204, v205
  v_cvt_pk_bf16_f32 v111, v206, v207
  ds_write_b128 v62, v[108:111] offset:45056
  s_add_u32 s48, s48, 0xe000
  s_cmp_eq_u32 s48, 0x1c0000
  s_cselect_b32 s48, 0, s48
  v_lshlrev_b32 v192, 16, v112
  v_and_b32 v193, 0xffff0000, v112
  v_lshlrev_b32 v194, 16, v113
  v_and_b32 v195, 0xffff0000, v113
  v_lshlrev_b32 v196, 16, v114
  v_and_b32 v197, 0xffff0000, v114
  v_lshlrev_b32 v198, 16, v115
  v_and_b32 v199, 0xffff0000, v115
  v_pk_fma_f32 v[192:193], v[192:193], v[52:53], v[54:55] op_sel_hi:[1,0,0]
  v_pk_fma_f32 v[194:195], v[194:195], v[52:53], v[54:55] op_sel_hi:[1,0,0]
  v_pk_fma_f32 v[196:197], v[196:197], v[52:53], v[54:55] op_sel_hi:[1,0,0]
  v_pk_fma_f32 v[198:199], v[198:199], v[52:53], v[54:55] op_sel_hi:[1,0,0]
  v_cvt_pk_bf16_f32 v112, v192, v193
  v_cvt_pk_bf16_f32 v113, v194, v195
  v_cvt_pk_bf16_f32 v114, v196, v197
  v_cvt_pk_bf16_f32 v115, v198, v199
  ds_write_b128 v62, v[112:115] offset:49152
  s_add_u32 m0, s47, 0x4000
  s_nop 0
  buffer_load_dwordx4 v36, s[24:27], s48 offen lds
  v_lshlrev_b32 v200, 16, v116
  v_and_b32 v201, 0xffff0000, v116
  v_lshlrev_b32 v202, 16, v117
  v_and_b32 v203, 0xffff0000, v117
  v_lshlrev_b32 v204, 16, v118
  v_and_b32 v205, 0xffff0000, v118
  v_lshlrev_b32 v206, 16, v119
  v_and_b32 v207, 0xffff0000, v119
  v_pk_fma_f32 v[200:201], v[200:201], v[52:53], v[54:55] op_sel_hi:[1,0,0]
  v_pk_fma_f32 v[202:203], v[202:203], v[52:53], v[54:55] op_sel_hi:[1,0,0]
  v_pk_fma_f32 v[204:205], v[204:205], v[52:53], v[54:55] op_sel_hi:[1,0,0]
  v_pk_fma_f32 v[206:207], v[206:207], v[52:53], v[54:55] op_sel_hi:[1,0,0]
  v_cvt_pk_bf16_f32 v116, v200, v201
  v_cvt_pk_bf16_f32 v117, v202, v203
  v_cvt_pk_bf16_f32 v118, v204, v205
  v_cvt_pk_bf16_f32 v119, v206, v207
  ds_write_b128 v62, v[116:119] offset:53248
  buffer_load_dwordx4 v37, s[24:27], s48 offen offset:1024 lds
  s_add_u32 m0, s47, 0x4800
  v_lshlrev_b32 v192, 16, v120
  v_and_b32 v193, 0xffff0000, v120
  v_lshlrev_b32 v194, 16, v121
  v_and_b32 v195, 0xffff0000, v121
  v_lshlrev_b32 v196, 16, v122
  v_and_b32 v197, 0xffff0000, v122
  v_lshlrev_b32 v198, 16, v123
  v_and_b32 v199, 0xffff0000, v123
  v_pk_fma_f32 v[192:193], v[192:193], v[52:53], v[54:55] op_sel_hi:[1,0,0]
  v_pk_fma_f32 v[194:195], v[194:195], v[52:53], v[54:55] op_sel_hi:[1,0,0]
  v_pk_fma_f32 v[196:197], v[196:197], v[52:53], v[54:55] op_sel_hi:[1,0,0]
  v_pk_fma_f32 v[198:199], v[198:199], v[52:53], v[54:55] op_sel_hi:[1,0,0]
  v_cvt_pk_bf16_f32 v120, v192, v193
  v_cvt_pk_bf16_f32 v121, v194, v195
  v_cvt_pk_bf16_f32 v122, v196, v197
  v_cvt_pk_bf16_f32 v123, v198, v199
  ds_write_b128 v62, v[120:123] offset:57344
  buffer_load_dwordx4 v38, s[28:31], s48 offen lds
  buffer_load_dwordx4 v39, s[28:31], s48 offen offset:1024 lds
  v_lshlrev_b32 v200, 16, v124
  v_and_b32 v201, 0xffff0000, v124
  v_lshlrev_b32 v202, 16, v125
  v_and_b32 v203, 0xffff0000, v125
  v_lshlrev_b32 v204, 16, v126
  v_and_b32 v205, 0xffff0000, v126
  v_lshlrev_b32 v206, 16, v127
  v_and_b32 v207, 0xffff0000, v127
  v_pk_fma_f32 v[200:201], v[200:201], v[52:53], v[54:55] op_sel_hi:[1,0,0]
  v_pk_fma_f32 v[202:203], v[202:203], v[52:53], v[54:55] op_sel_hi:[1,0,0]
  v_pk_fma_f32 v[204:205], v[204:205], v[52:53], v[54:55] op_sel_hi:[1,0,0]
  v_pk_fma_f32 v[206:207], v[206:207], v[52:53], v[54:55] op_sel_hi:[1,0,0]
  v_cvt_pk_bf16_f32 v124, v200, v201
  v_cvt_pk_bf16_f32 v125, v202, v203
  v_cvt_pk_bf16_f32 v126, v204, v205
  v_cvt_pk_bf16_f32 v127, v206, v207
  ds_write_b128 v62, v[124:127] offset:61440
  s_add_u32 s48, s48, 0xe000
  s_cmp_eq_u32 s48, 0x1c0000
  s_cselect_b32 s48, 0, s48
  s_waitcnt lgkmcnt(0)
  s_barrier
  s_cmp_eq_u32 s99, 1
  s_cbranch_scc1 L_f1b
  s_lshl_b32 s58, s100, 11
  s_lshr_b32 s59, s58, 5
  s_and_b32 s59, s59, 64
  s_or_b32 s58, s58, s59
  v_xor_b32 v0, s58, v63
  s_waitcnt vmcnt(16)
  ds_read_b64_tr_b16 a[128:129], v32
  ds_read_b64_tr_b16 a[130:131], v32 offset:512
  ds_read_b128 a[160:163], v0
  ds_read_b128 a[164:167], v0 offset:1024
  ds_read_b64_tr_b16 a[132:133], v33
  ds_read_b64_tr_b16 a[134:135], v33 offset:512
  ds_read_b64_tr_b16 a[136:137], v34
  ds_read_b64_tr_b16 a[138:139], v34 offset:512
  ds_read_b64_tr_b16 a[140:141], v35
  ds_read_b64_tr_b16 a[142:143], v35 offset:512
  s_add_u32 s58, s58, 0x800
  s_and_b32 s58, s58, 0xffff
  s_xor_b32 s58, s58, 64
  v_xor_b32 v0, s58, v63
  s_waitcnt lgkmcnt(0)
  v_mfma_f32_32x32x16_bf16 v[128:143], a[128:131], a[160:163], 0
  s_waitcnt vmcnt(12)
  ds_read_b64_tr_b16 a[144:145], v32 offset:4096
  ds_read_b64_tr_b16 a[146:147], v32 offset:4608
  s_add_u32 m0, s47, 0x5000
  v_mfma_f32_32x32x16_bf16 v[144:159], a[128:131], a[164:167], 0
  ds_read_b128 a[168:171], v0
  ds_read_b128 a[172:175], v0 offset:1024
  buffer_load_dwordx4 v36, s[24:27], s48 offen lds
  v_mfma_f32_32x32x16_bf16 v[160:175], a[132:135], a[160:163], 0
  ds_read_b64_tr_b16 a[148:149], v33 offset:4096
  ds_read_b64_tr_b16 a[150:151], v33 offset:4608
  v_mfma_f32_32x32x16_bf16 v[176:191], a[132:135], a[164:167], 0
  buffer_load_dwordx4 v37, s[24:27], s48 offen offset:1024 lds
  v_mfma_f32_32x32x16_bf16 v[192:207], a[136:139], a[160:163], 0
  ds_read_b64_tr_b16 a[152:153], v34 offset:4096
  ds_read_b64_tr_b16 a[154:155], v34 offset:4608
  s_add_u32 m0, s47, 0x5800
  v_mfma_f32_32x32x16_bf16 v[208:223], a[136:139], a[164:167], 0
  s_add_u32 s58, s58, 0x800
  s_and_b32 s58, s58, 0xffff
  buffer_load_dwordx4 v38, s[28:31], s48 offen lds
  v_mfma_f32_32x32x16_bf16 v[224:239], a[140:143], a[160:163], 0
  ds_read_b64_tr_b16 a[156:157], v35 offset:4096
  ds_read_b64_tr_b16 a[158:159], v35 offset:4608
  s_xor_b32 s58, s58, 64
  v_mfma_f32_32x32x16_bf16 v[240:255], a[140:143], a[164:167], 0
  buffer_load_dwordx4 v39, s[28:31], s48 offen offset:1024 lds
  s_add_u32 s48, s48, 0xe000
  s_cmp_eq_u32 s48, 0x1c0000
  s_cselect_b32 s48, 0, s48
  v_xor_b32 v0, s58, v63
  s_waitcnt lgkmcnt(0)
  v_mfma_f32_32x32x16_bf16 v[128:143], a[144:147], a[168:171], v[128:143]
  s_waitcnt vmcnt(12)
  ds_read_b64_tr_b16 a[128:129], v32 offset:8192
  ds_read_b64_tr_b16 a[130:131], v32 offset:8704
  s_add_u32 m0, s47, 0
  v_mfma_f32_32x32x16_bf16 v[144:159], a[144:147], a[172:175], v[144:159]
  ds_read_b128 a[160:163], v0
  ds_read_b128 a[164:167], v0 offset:1024
  buffer_load_dwordx4 v36, s[24:27], s48 offen lds
  v_mfma_f32_32x32x16_bf16 v[160:175], a[148:151], a[168:171], v[160:175]
  ds_read_b64_tr_b16 a[132:133], v33 offset:8192
  ds_read_b64_tr_b16 a[134:135], v33 offset:8704
  v_mfma_f32_32x32x16_bf16 v[176:191], a[148:151], a[172:175], v[176:191]
  buffer_load_dwordx4 v37, s[24:27], s48 offen offset:1024 lds
  v_mfma_f32_32x32x16_bf16 v[192:207], a[152:155], a[168:171], v[192:207]
  ds_read_b64_tr_b16 a[136:137], v34 offset:8192
  ds_read_b64_tr_b16 a[138:139], v34 offset:8704
  s_add_u32 m0, s47, 0x800
  v_mfma_f32_32x32x16_bf16 v[208:223], a[152:155], a[172:175], v[208:223]
  s_add_u32 s58, s58, 0x800
  s_and_b32 s58, s58, 0xffff
  buffer_load_dwordx4 v38, s[28:31], s48 offen lds
  v_mfma_f32_32x32x16_bf16 v[224:239], a[156:159], a[168:171], v[224:239]
  ds_read_b64_tr_b16 a[140:141], v35 offset:8192
  ds_read_b64_tr_b16 a[142:143], v35 offset:8704
  s_xor_b32 s58, s58, 64
  v_mfma_f32_32x32x16_bf16 v[240:255], a[156:159], a[172:175], v[240:255]
  buffer_load_dwordx4 v39, s[28:31], s48 offen offset:1024 lds
  s_add_u32 s48, s48, 0xe000
  s_cmp_eq_u32 s48, 0x1c0000
  s_cselect_b32 s48, 0, s48
  v_xor_b32 v0, s58, v63
  s_waitcnt lgkmcnt(0)
  v_mfma_f32_32x32x16_bf16 v[128:143], a[128:131], a[160:163], v[128:143]
  s_waitcnt vmcnt(12)
  ds_read_b64_tr_b16 a[144:145], v32 offset:12288
  ds_read_b64_tr_b16 a[146:147], v32 offset:12800
  s_add_u32 m0, s47, 0x1000
  v_mfma_f32_32x32x16_bf16 v[144:159], a[128:131], a[164:167], v[144:159]
  ds_read_b128 a[168:171], v0
  ds_read_b128 a[172:175], v0 offset:1024
  buffer_load_dwordx4 v36, s[24:27], s48 offen lds
  v_mfma_f32_32x32x16_bf16 v[160:175], a[132:135], a[160:163], v[160:175]
  ds_read_b64_tr_b16 a[148:149], v33 offset:12288
  ds_read_b64_tr_b16 a[150:151], v33 offset:12800
  v_mfma_f32_32x32x16_bf16 v[176:191], a[132:135], a[164:167], v[176:191]
  buffer_load_dwordx4 v37, s[24:27], s48 offen offset:1024 lds
  v_mfma_f32_32x32x16_bf16 v[192:207], a[136:139], a[160:163], v[192:207]
  ds_read_b64_tr_b16 a[152:153], v34 offset:12288
  ds_read_b64_tr_b16 a[154:155], v34 offset:12800
  s_add_u32 m0, s47, 0x1800
  v_mfma_f32_32x32x16_bf16 v[208:223], a[136:139], a[164:167], v[208:223]
  s_add_u32 s58, s58, 0x800
  s_and_b32 s58, s58, 0xffff
  buffer_load_dwordx4 v38, s[28:31], s48 offen lds
  v_mfma_f32_32x32x16_bf16 v[224:239], a[140:143], a[160:163], v[224:239]
  ds_read_b64_tr_b16 a[156:157], v35 offset:12288
  ds_read_b64_tr_b16 a[158:159], v35 offset:12800
  s_xor_b32 s58, s58, 64
  v_mfma_f32_32x32x16_bf16 v[240:255], a[140:143], a[164:167], v[240:255]
  buffer_load_dwordx4 v39, s[28:31], s48 offen offset:1024 lds
  s_add_u32 s48, s48, 0xe000
  s_cmp_eq_u32 s48, 0x1c0000
  s_cselect_b32 s48, 0, s48
  v_xor_b32 v0, s58, v63
  s_waitcnt lgkmcnt(0)
  v_mfma_f32_32x32x16_bf16 v[128:143], a[144:147], a[168:171], v[128:143]
  s_waitcnt vmcnt(12)
  ds_read_b64_tr_b16 a[128:129], v32 offset:16384
  ds_read_b64_tr_b16 a[130:131], v32 offset:16896
  s_add_u32 m0, s47, 0x2000
  v_mfma_f32_32x32x16_bf16 v[144:159], a[144:147], a[172:175], v[144:159]
  ds_read_b128 a[160:163], v0
  ds_read_b128 a[164:167], v0 offset:1024
  buffer_load_dwordx4 v36, s[24:27], s48 offen lds
  v_mfma_f32_32x32x16_bf16 v[160:175], a[148:151], a[168:171], v[160:175]
  ds_read_b64_tr_b16 a[132:133], v33 offset:16384
  ds_read_b64_tr_b16 a[134:135], v33 offset:16896
  v_mfma_f32_32x32x16_bf16 v[176:191], a[148:151], a[172:175], v[176:191]
  buffer_load_dwordx4 v37, s[24:27], s48 offen offset:1024 lds
  v_mfma_f32_32x32x16_bf16 v[192:207], a[152:155], a[168:171], v[192:207]
  ds_read_b64_tr_b16 a[136:137], v34 offset:16384
  ds_read_b64_tr_b16 a[138:139], v34 offset:16896
  s_add_u32 m0, s47, 0x2800
  v_mfma_f32_32x32x16_bf16 v[208:223], a[152:155], a[172:175], v[208:223]
  s_add_u32 s58, s58, 0x800
  s_and_b32 s58, s58, 0xffff
  buffer_load_dwordx4 v38, s[28:31], s48 offen lds
  v_mfma_f32_32x32x16_bf16 v[224:239], a[156:159], a[168:171], v[224:239]
  ds_read_b64_tr_b16 a[140:141], v35 offset:16384
  ds_read_b64_tr_b16 a[142:143], v35 offset:16896
  s_xor_b32 s58, s58, 64
  v_mfma_f32_32x32x16_bf16 v[240:255], a[156:159], a[172:175], v[240:255]
  buffer_load_dwordx4 v39, s[28:31], s48 offen offset:1024 lds
  s_add_u32 s48, s48, 0xe000
  s_cmp_eq_u32 s48, 0x1c0000
  s_cselect_b32 s48, 0, s48
  v_xor_b32 v0, s58, v63
  s_waitcnt lgkmcnt(0)
  v_mfma_f32_32x32x16_bf16 v[128:143], a[128:131], a[160:163], v[128:143]
  s_waitcnt vmcnt(12)
  ds_read_b64_tr_b16 a[144:145], v32 offset:20480
  ds_read_b64_tr_b16 a[146:147], v32 offset:20992
  s_add_u32 m0, s47, 0x3000
  v_mfma_f32_32x32x16_bf16 v[144:159], a[128:131], a[164:167], v[144:159]
  ds_read_b128 a[168:171], v0
  ds_read_b128 a[172:175], v0 offset:1024
  buffer_load_dwordx4 v36, s[24:27], s48 offen lds
  v_mfma_f32_32x32x16_bf16 v[160:175], a[132:135], a[160:163], v[160:175]
  ds_read_b64_tr_b16 a[148:149], v33 offset:20480
  ds_read_b64_tr_b16 a[150:151], v33 offset:20992
  v_mfma_f32_32x32x16_bf16 v[176:191], a[132:135], a[164:167], v[176:191]
  buffer_load_dwordx4 v37, s[24:27], s48 offen offset:1024 lds
  v_mfma_f32_32x32x16_bf16 v[192:207], a[136:139], a[160:163], v[192:207]
  ds_read_b64_tr_b16 a[152:153], v34 offset:20480
  ds_read_b64_tr_b16 a[154:155], v34 offset:20992
  s_add_u32 m0, s47, 0x3800
  v_mfma_f32_32x32x16_bf16 v[208:223], a[136:139], a[164:167], v[208:223]
  s_add_u32 s58, s58, 0x800
  s_and_b32 s58, s58, 0xffff
  buffer_load_dwordx4 v38, s[28:31], s48 offen lds
  v_mfma_f32_32x32x16_bf16 v[224:239], a[140:143], a[160:163], v[224:239]
  ds_read_b64_tr_b16 a[156:157], v35 offset:20480
  ds_read_b64_tr_b16 a[158:159], v35 offset:20992
  s_xor_b32 s58, s58, 64
  v_mfma_f32_32x32x16_bf16 v[240:255], a[140:143], a[164:167], v[240:255]
  buffer_load_dwordx4 v39, s[28:31], s48 offen offset:1024 lds
  s_add_u32 s48, s48, 0xe000
  s_cmp_eq_u32 s48, 0x1c0000
  s_cselect_b32 s48, 0, s48
  v_xor_b32 v0, s58, v63
  s_waitcnt lgkmcnt(0)
  v_mfma_f32_32x32x16_bf16 v[128:143], a[144:147], a[168:171], v[128:143]
  s_waitcnt vmcnt(12)
  ds_read_b64_tr_b16 a[128:129], v32
  ds_read_b64_tr_b16 a[130:131], v32 offset:512
  s_add_u32 m0, s47, 0x4000
  v_mfma_f32_32x32x16_bf16 v[144:159], a[144:147], a[172:175], v[144:159]
  ds_read_b128 a[160:163], v0
  ds_read_b128 a[164:167], v0 offset:1024
  buffer_load_dwordx4 v36, s[24:27], s48 offen lds
  v_mfma_f32_32x32x16_bf16 v[160:175], a[148:151], a[168:171], v[160:175]
  ds_read_b64_tr_b16 a[132:133], v33
  ds_read_b64_tr_b16 a[134:135], v33 offset:512
  v_mfma_f32_32x32x16_bf16 v[176:191], a[148:151], a[172:175], v[176:191]
  buffer_load_dwordx4 v37, s[24:27], s48 offen offset:1024 lds
  v_mfma_f32_32x32x16_bf16 v[192:207], a[152:155], a[168:171], v[192:207]
  ds_read_b64_tr_b16 a[136:137], v34
  ds_read_b64_tr_b16 a[138:139], v34 offset:512
  s_add_u32 m0, s47, 0x4800
  v_mfma_f32_32x32x16_bf16 v[208:223], a[152:155], a[172:175], v[208:223]
  s_add_u32 s58, s58, 0x800
  s_and_b32 s58, s58, 0xffff
  buffer_load_dwordx4 v38, s[28:31], s48 offen lds
  v_mfma_f32_32x32x16_bf16 v[224:239], a[156:159], a[168:171], v[224:239]
  ds_read_b64_tr_b16 a[140:141], v35
  ds_read_b64_tr_b16 a[142:143], v35 offset:512
  s_xor_b32 s58, s58, 64
  v_mfma_f32_32x32x16_bf16 v[240:255], a[156:159], a[172:175], v[240:255]
  buffer_load_dwordx4 v39, s[28:31], s48 offen offset:1024 lds
  s_add_u32 s48, s48, 0xe000
  s_cmp_eq_u32 s48, 0x1c0000
  s_cselect_b32 s48, 0, s48
  v_xor_b32 v0, s58, v63
  s_waitcnt lgkmcnt(0)
  v_mfma_f32_32x32x16_bf16 v[128:143], a[128:131], a[160:163], v[128:143]
  s_waitcnt vmcnt(12)
  ds_read_b64_tr_b16 a[144:145], v32 offset:4096
  ds_read_b64_tr_b16 a[146:147], v32 offset:4608
  s_add_u32 m0, s47, 0x5000
  v_mfma_f32_32x32x16_bf16 v[144:159], a[128:131], a[164:167], v[144:159]
  ds_read_b128 a[168:171], v0
  ds_read_b128 a[172:175], v0 offset:1024
  buffer_load_dwordx4 v36, s[24:27], s48 offen lds
  v_mfma_f32_32x32x16_bf16 v[160:175], a[132:135], a[160:163], v[160:175]
  ds_read_b64_tr_b16 a[148:149], v33 offset:4096
  ds_read_b64_tr_b16 a[150:151], v33 offset:4608
  v_mfma_f32_32x32x16_bf16 v[176:191], a[132:135], a[164:167], v[176:191]
  buffer_load_dwordx4 v37, s[24:27], s48 offen offset:1024 lds
  v_mfma_f32_32x32x16_bf16 v[192:207], a[136:139], a[160:163], v[192:207]
  ds_read_b64_tr_b16 a[152:153], v34 offset:4096
  ds_read_b64_tr_b16 a[154:155], v34 offset:4608
  s_add_u32 m0, s47, 0x5800
  v_mfma_f32_32x32x16_bf16 v[208:223], a[136:139], a[164:167], v[208:223]
  s_add_u32 s58, s58, 0x800
  s_and_b32 s58, s58, 0xffff
  buffer_load_dwordx4 v38, s[28:31], s48 offen lds
  v_mfma_f32_32x32x16_bf16 v[224:239], a[140:143], a[160:163], v[224:239]
  ds_read_b64_tr_b16 a[156:157], v35 offset:4096
  ds_read_b64_tr_b16 a[158:159], v35 offset:4608
  s_xor_b32 s58, s58, 64
  v_mfma_f32_32x32x16_bf16 v[240:255], a[140:143], a[164:167], v[240:255]
  buffer_load_dwordx4 v39, s[28:31], s48 offen offset:1024 lds
  s_add_u32 s48, s48, 0xe000
  s_cmp_eq_u32 s48, 0x1c0000
  s_cselect_b32 s48, 0, s48
  v_xor_b32 v0, s58, v63
  s_waitcnt lgkmcnt(0)
  v_mfma_f32_32x32x16_bf16 v[128:143], a[144:147], a[168:171], v[128:143]
  s_waitcnt vmcnt(12)
  ds_read_b64_tr_b16 a[128:129], v32 offset:8192
  ds_read_b64_tr_b16 a[130:131], v32 offset:8704
  s_add_u32 m0, s47, 0
  v_mfma_f32_32x32x16_bf16 v[144:159], a[144:147], a[172:175], v[144:159]
  ds_read_b128 a[160:163], v0
  ds_read_b128 a[164:167], v0 offset:1024
  buffer_load_dwordx4 v36, s[24:27], s48 offen lds
  v_mfma_f32_32x32x16_bf16 v[160:175], a[148:151], a[168:171], v[160:175]
  ds_read_b64_tr_b16 a[132:133], v33 offset:8192
  ds_read_b64_tr_b16 a[134:135], v33 offset:8704
  v_mfma_f32_32x32x16_bf16 v[176:191], a[148:151], a[172:175], v[176:191]
  buffer_load_dwordx4 v37, s[24:27], s48 offen offset:1024 lds
  v_mfma_f32_32x32x16_bf16 v[192:207], a[152:155], a[168:171], v[192:207]
  ds_read_b64_tr_b16 a[136:137], v34 offset:8192
  ds_read_b64_tr_b16 a[138:139], v34 offset:8704
  s_add_u32 m0, s47, 0x800
  v_mfma_f32_32x32x16_bf16 v[208:223], a[152:155], a[172:175], v[208:223]
  s_add_u32 s58, s58, 0x800
  s_and_b32 s58, s58, 0xffff
  buffer_load_dwordx4 v38, s[28:31], s48 offen lds
  v_mfma_f32_32x32x16_bf16 v[224:239], a[156:159], a[168:171], v[224:239]
  ds_read_b64_tr_b16 a[140:141], v35 offset:8192
  ds_read_b64_tr_b16 a[142:143], v35 offset:8704
  s_xor_b32 s58, s58, 64
  v_mfma_f32_32x32x16_bf16 v[240:255], a[156:159], a[172:175], v[240:255]
  buffer_load_dwordx4 v39, s[28:31], s48 offen offset:1024 lds
  s_add_u32 s48, s48, 0xe000
  s_cmp_eq_u32 s48, 0x1c0000
  s_cselect_b32 s48, 0, s48
  v_xor_b32 v0, s58, v63
  s_waitcnt lgkmcnt(0)
  v_mfma_f32_32x32x16_bf16 v[128:143], a[128:131], a[160:163], v[128:143]
  s_waitcnt vmcnt(12)
  ds_read_b64_tr_b16 a[144:145], v32 offset:12288
  ds_read_b64_tr_b16 a[146:147], v32 offset:12800
  s_add_u32 m0, s47, 0x1000
  v_mfma_f32_32x32x16_bf16 v[144:159], a[128:131], a[164:167], v[144:159]
  ds_read_b128 a[168:171], v0
  ds_read_b128 a[172:175], v0 offset:1024
  buffer_load_dwordx4 v36, s[24:27], s48 offen lds
  v_mfma_f32_32x32x16_bf16 v[160:175], a[132:135], a[160:163], v[160:175]
  ds_read_b64_tr_b16 a[148:149], v33 offset:12288
  ds_read_b64_tr_b16 a[150:151], v33 offset:12800
  v_mfma_f32_32x32x16_bf16 v[176:191], a[132:135], a[164:167], v[176:191]
  buffer_load_dwordx4 v37, s[24:27], s48 offen offset:1024 lds
  v_mfma_f32_32x32x16_bf16 v[192:207], a[136:139], a[160:163], v[192:207]
  ds_read_b64_tr_b16 a[152:153], v34 offset:12288
  ds_read_b64_tr_b16 a[154:155], v34 offset:12800
  s_add_u32 m0, s47, 0x1800
  v_mfma_f32_32x32x16_bf16 v[208:223], a[136:139], a[164:167], v[208:223]
  s_add_u32 s58, s58, 0x800
  s_and_b32 s58, s58, 0xffff
  buffer_load_dwordx4 v38, s[28:31], s48 offen lds
  v_mfma_f32_32x32x16_bf16 v[224:239], a[140:143], a[160:163], v[224:239]
  ds_read_b64_tr_b16 a[156:157], v35 offset:12288
  ds_read_b64_tr_b16 a[158:159], v35 offset:12800
  s_xor_b32 s58, s58, 64
  v_mfma_f32_32x32x16_bf16 v[240:255], a[140:143], a[164:167], v[240:255]
  buffer_load_dwordx4 v39, s[28:31], s48 offen offset:1024 lds
  s_add_u32 s48, s48, 0xe000
  s_cmp_eq_u32 s48, 0x1c0000
  s_cselect_b32 s48, 0, s48
  v_xor_b32 v0, s58, v63
  s_waitcnt lgkmcnt(0)
  v_mfma_f32_32x32x16_bf16 v[128:143], a[144:147], a[168:171], v[128:143]
  s_waitcnt vmcnt(12)
  ds_read_b64_tr_b16 a[128:129], v32 offset:16384
  ds_read_b64_tr_b16 a[130:131], v32 offset:16896
  s_add_u32 m0, s47, 0x2000
  v_mfma_f32_32x32x16_bf16 v[144:159], a[144:147], a[172:175], v[144:159]
  ds_read_b128 a[160:163], v0
  ds_read_b128 a[164:167], v0 offset:1024
  buffer_load_dwordx4 v36, s[24:27], s48 offen lds
  v_mfma_f32_32x32x16_bf16 v[160:175], a[148:151], a[168:171], v[160:175]
  ds_read_b64_tr_b16 a[132:133], v33 offset:16384
  ds_read_b64_tr_b16 a[134:135], v33 offset:16896
  v_mfma_f32_32x32x16_bf16 v[176:191], a[148:151], a[172:175], v[176:191]
  buffer_load_dwordx4 v37, s[24:27], s48 offen offset:1024 lds
  v_mfma_f32_32x32x16_bf16 v[192:207], a[152:155], a[168:171], v[192:207]
  ds_read_b64_tr_b16 a[136:137], v34 offset:16384
  ds_read_b64_tr_b16 a[138:139], v34 offset:16896
  s_add_u32 m0, s47, 0x2800
  v_mfma_f32_32x32x16_bf16 v[208:223], a[152:155], a[172:175], v[208:223]
  s_add_u32 s58, s58, 0x800
  s_and_b32 s58, s58, 0xffff
  buffer_load_dwordx4 v38, s[28:31], s48 offen lds
  v_mfma_f32_32x32x16_bf16 v[224:239], a[156:159], a[168:171], v[224:239]
  ds_read_b64_tr_b16 a[140:141], v35 offset:16384
  ds_read_b64_tr_b16 a[142:143], v35 offset:16896
  s_xor_b32 s58, s58, 64
  v_mfma_f32_32x32x16_bf16 v[240:255], a[156:159], a[172:175], v[240:255]
  buffer_load_dwordx4 v39, s[28:31], s48 offen offset:1024 lds
  s_add_u32 s48, s48, 0xe000
  s_cmp_eq_u32 s48, 0x1c0000
  s_cselect_b32 s48, 0, s48
  v_xor_b32 v0, s58, v63
  s_waitcnt lgkmcnt(0)
  v_mfma_f32_32x32x16_bf16 v[128:143], a[128:131], a[160:163], v[128:143]
  s_waitcnt vmcnt(12)
  ds_read_b64_tr_b16 a[144:145], v32 offset:20480
  ds_read_b64_tr_b16 a[146:147], v32 offset:20992
  s_add_u32 m0, s47, 0x3000
  v_mfma_f32_32x32x16_bf16 v[144:159], a[128:131], a[164:167], v[144:159]
  ds_read_b128 a[168:171], v0
  ds_read_b128 a[172:175], v0 offset:1024
  buffer_load_dwordx4 v36, s[24:27], s48 offen lds
  v_mfma_f32_32x32x16_bf16 v[160:175], a[132:135], a[160:163], v[160:175]
  ds_read_b64_tr_b16 a[148:149], v33 offset:20480
  ds_read_b64_tr_b16 a[150:151], v33 offset:20992
  v_mfma_f32_32x32x16_bf16 v[176:191], a[132:135], a[164:167], v[176:191]
  buffer_load_dwordx4 v37, s[24:27], s48 offen offset:1024 lds
  v_mfma_f32_32x32x16_bf16 v[192:207], a[136:139], a[160:163], v[192:207]
  ds_read_b64_tr_b16 a[152:153], v34 offset:20480
  ds_read_b64_tr_b16 a[154:155], v34 offset:20992
  s_add_u32 m0, s47, 0x3800
  v_mfma_f32_32x32x16_bf16 v[208:223], a[136:139], a[164:167], v[208:223]
  s_add_u32 s58, s58, 0x800
  s_and_b32 s58, s58, 0xffff
  buffer_load_dwordx4 v38, s[28:31], s48 offen lds
  v_mfma_f32_32x32x16_bf16 v[224:239], a[140:143], a[160:163], v[224:239]
  ds_read_b64_tr_b16 a[156:157], v35 offset:20480
  ds_read_b64_tr_b16 a[158:159], v35 offset:20992
  s_xor_b32 s58, s58, 64
  v_mfma_f32_32x32x16_bf16 v[240:255], a[140:143], a[164:167], v[240:255]
  buffer_load_dwordx4 v39, s[28:31], s48 offen offset:1024 lds
  s_add_u32 s48, s48, 0xe000
  s_cmp_eq_u32 s48, 0x1c0000
  s_cselect_b32 s48, 0, s48
  v_xor_b32 v0, s58, v63
  s_waitcnt lgkmcnt(0)
  v_mfma_f32_32x32x16_bf16 v[128:143], a[144:147], a[168:171], v[128:143]
  s_waitcnt vmcnt(12)
  ds_read_b64_tr_b16 a[128:129], v32
  ds_read_b64_tr_b16 a[130:131], v32 offset:512
  s_add_u32 m0, s47, 0x4000
  v_mfma_f32_32x32x16_bf16 v[144:159], a[144:147], a[172:175], v[144:159]
  ds_read_b128 a[160:163], v0
  ds_read_b128 a[164:167], v0 offset:1024
  buffer_load_dwordx4 v36, s[24:27], s48 offen lds
  v_mfma_f32_32x32x16_bf16 v[160:175], a[148:151], a[168:171], v[160:175]
  ds_read_b64_tr_b16 a[132:133], v33
  ds_read_b64_tr_b16 a[134:135], v33 offset:512
  v_mfma_f32_32x32x16_bf16 v[176:191], a[148:151], a[172:175], v[176:191]
  buffer_load_dwordx4 v37, s[24:27], s48 offen offset:1024 lds
  v_mfma_f32_32x32x16_bf16 v[192:207], a[152:155], a[168:171], v[192:207]
  ds_read_b64_tr_b16 a[136:137], v34
  ds_read_b64_tr_b16 a[138:139], v34 offset:512
  s_add_u32 m0, s47, 0x4800
  v_mfma_f32_32x32x16_bf16 v[208:223], a[152:155], a[172:175], v[208:223]
  s_add_u32 s58, s58, 0x800
  s_and_b32 s58, s58, 0xffff
  buffer_load_dwordx4 v38, s[28:31], s48 offen lds
  v_mfma_f32_32x32x16_bf16 v[224:239], a[156:159], a[168:171], v[224:239]
  ds_read_b64_tr_b16 a[140:141], v35
  ds_read_b64_tr_b16 a[142:143], v35 offset:512
  s_xor_b32 s58, s58, 64
  v_mfma_f32_32x32x16_bf16 v[240:255], a[156:159], a[172:175], v[240:255]
  buffer_load_dwordx4 v39, s[28:31], s48 offen offset:1024 lds
  s_add_u32 s48, s48, 0xe000
  s_cmp_eq_u32 s48, 0x1c0000
  s_cselect_b32 s48, 0, s48
  v_xor_b32 v0, s58, v63
  s_waitcnt lgkmcnt(0)
  v_mfma_f32_32x32x16_bf16 v[128:143], a[128:131], a[160:163], v[128:143]
  s_waitcnt vmcnt(12)
  ds_read_b64_tr_b16 a[144:145], v32 offset:4096
  ds_read_b64_tr_b16 a[146:147], v32 offset:4608
  s_add_u32 m0, s47, 0x5000
  v_mfma_f32_32x32x16_bf16 v[144:159], a[128:131], a[164:167], v[144:159]
  ds_read_b128 a[168:171], v0
  ds_read_b128 a[172:175], v0 offset:1024
  buffer_load_dwordx4 v36, s[24:27], s48 offen lds
  v_mfma_f32_32x32x16_bf16 v[160:175], a[132:135], a[160:163], v[160:175]
  ds_read_b64_tr_b16 a[148:149], v33 offset:4096
  ds_read_b64_tr_b16 a[150:151], v33 offset:4608
  v_mfma_f32_32x32x16_bf16 v[176:191], a[132:135], a[164:167], v[176:191]
  buffer_load_dwordx4 v37, s[24:27], s48 offen offset:1024 lds
  v_mfma_f32_32x32x16_bf16 v[192:207], a[136:139], a[160:163], v[192:207]
  ds_read_b64_tr_b16 a[152:153], v34 offset:4096
  ds_read_b64_tr_b16 a[154:155], v34 offset:4608
  s_add_u32 m0, s47, 0x5800
  v_mfma_f32_32x32x16_bf16 v[208:223], a[136:139], a[164:167], v[208:223]
  s_add_u32 s58, s58, 0x800
  s_and_b32 s58, s58, 0xffff
  buffer_load_dwordx4 v38, s[28:31], s48 offen lds
  v_mfma_f32_32x32x16_bf16 v[224:239], a[140:143], a[160:163], v[224:239]
  ds_read_b64_tr_b16 a[156:157], v35 offset:4096
  ds_read_b64_tr_b16 a[158:159], v35 offset:4608
  s_xor_b32 s58, s58, 64
  v_mfma_f32_32x32x16_bf16 v[240:255], a[140:143], a[164:167], v[240:255]
  buffer_load_dwordx4 v39, s[28:31], s48 offen offset:1024 lds
  s_add_u32 s48, s48, 0xe000
  s_cmp_eq_u32 s48, 0x1c0000
  s_cselect_b32 s48, 0, s48
  v_xor_b32 v0, s58, v63
  s_waitcnt lgkmcnt(0)
  v_mfma_f32_32x32x16_bf16 v[128:143], a[144:147], a[168:171], v[128:143]
  s_waitcnt vmcnt(12)
  ds_read_b64_tr_b16 a[128:129], v32 offset:8192
  ds_read_b64_tr_b16 a[130:131], v32 offset:8704
  s_add_u32 m0, s47, 0
  v_mfma_f32_32x32x16_bf16 v[144:159], a[144:147], a[172:175], v[144:159]
  ds_read_b128 a[160:163], v0
  ds_read_b128 a[164:167], v0 offset:1024
  buffer_load_dwordx4 v36, s[24:27], s48 offen lds
  v_mfma_f32_32x32x16_bf16 v[160:175], a[148:151], a[168:171], v[160:175]
  ds_read_b64_tr_b16 a[132:133], v33 offset:8192
  ds_read_b64_tr_b16 a[134:135], v33 offset:8704
  v_mfma_f32_32x32x16_bf16 v[176:191], a[148:151], a[172:175], v[176:191]
  buffer_load_dwordx4 v37, s[24:27], s48 offen offset:1024 lds
  v_mfma_f32_32x32x16_bf16 v[192:207], a[152:155], a[168:171], v[192:207]
  ds_read_b64_tr_b16 a[136:137], v34 offset:8192
  ds_read_b64_tr_b16 a[138:139], v34 offset:8704
  s_add_u32 m0, s47, 0x800
  v_mfma_f32_32x32x16_bf16 v[208:223], a[152:155], a[172:175], v[208:223]
  s_add_u32 s58, s58, 0x800
  s_and_b32 s58, s58, 0xffff
  buffer_load_dwordx4 v38, s[28:31], s48 offen lds
  v_mfma_f32_32x32x16_bf16 v[224:239], a[156:159], a[168:171], v[224:239]
  ds_read_b64_tr_b16 a[140:141], v35 offset:8192
  ds_read_b64_tr_b16 a[142:143], v35 offset:8704
  s_xor_b32 s58, s58, 64
  v_mfma_f32_32x32x16_bf16 v[240:255], a[156:159], a[172:175], v[240:255]
  buffer_load_dwordx4 v39, s[28:31], s48 offen offset:1024 lds
  s_add_u32 s48, s48, 0xe000
  s_cmp_eq_u32 s48, 0x1c0000
  s_cselect_b32 s48, 0, s48
  v_xor_b32 v0, s58, v63
  s_waitcnt lgkmcnt(0)
  v_mfma_f32_32x32x16_bf16 v[128:143], a[128:131], a[160:163], v[128:143]
  s_waitcnt vmcnt(12)
  ds_read_b64_tr_b16 a[144:145], v32 offset:12288
  ds_read_b64_tr_b16 a[146:147], v32 offset:12800
  s_add_u32 m0, s47, 0x1000
  v_mfma_f32_32x32x16_bf16 v[144:159], a[128:131], a[164:167], v[144:159]
  ds_read_b128 a[168:171], v0
  ds_read_b128 a[172:175], v0 offset:1024
  buffer_load_dwordx4 v36, s[24:27], s48 offen lds
  v_mfma_f32_32x32x16_bf16 v[160:175], a[132:135], a[160:163], v[160:175]
  ds_read_b64_tr_b16 a[148:149], v33 offset:12288
  ds_read_b64_tr_b16 a[150:151], v33 offset:12800
  v_mfma_f32_32x32x16_bf16 v[176:191], a[132:135], a[164:167], v[176:191]
  buffer_load_dwordx4 v37, s[24:27], s48 offen offset:1024 lds
  v_mfma_f32_32x32x16_bf16 v[192:207], a[136:139], a[160:163], v[192:207]
  ds_read_b64_tr_b16 a[152:153], v34 offset:12288
  ds_read_b64_tr_b16 a[154:155], v34 offset:12800
  s_add_u32 m0, s47, 0x1800
  v_mfma_f32_32x32x16_bf16 v[208:223], a[136:139], a[164:167], v[208:223]
  s_add_u32 s58, s58, 0x800
  s_and_b32 s58, s58, 0xffff
  buffer_load_dwordx4 v38, s[28:31], s48 offen lds
  v_mfma_f32_32x32x16_bf16 v[224:239], a[140:143], a[160:163], v[224:239]
  ds_read_b64_tr_b16 a[156:157], v35 offset:12288
  ds_read_b64_tr_b16 a[158:159], v35 offset:12800
  s_xor_b32 s58, s58, 64
  v_mfma_f32_32x32x16_bf16 v[240:255], a[140:143], a[164:167], v[240:255]
  buffer_load_dwordx4 v39, s[28:31], s48 offen offset:1024 lds
  s_add_u32 s48, s48, 0xe000
  s_cmp_eq_u32 s48, 0x1c0000
  s_cselect_b32 s48, 0, s48
  v_xor_b32 v0, s58, v63
  s_waitcnt lgkmcnt(0)
  v_mfma_f32_32x32x16_bf16 v[128:143], a[144:147], a[168:171], v[128:143]
  s_waitcnt vmcnt(12)
  ds_read_b64_tr_b16 a[128:129], v32 offset:16384
  ds_read_b64_tr_b16 a[130:131], v32 offset:16896
  s_add_u32 m0, s47, 0x2000
  v_mfma_f32_32x32x16_bf16 v[144:159], a[144:147], a[172:175], v[144:159]
  ds_read_b128 a[160:163], v0
  ds_read_b128 a[164:167], v0 offset:1024
  buffer_load_dwordx4 v36, s[24:27], s48 offen lds
  v_mfma_f32_32x32x16_bf16 v[160:175], a[148:151], a[168:171], v[160:175]
  ds_read_b64_tr_b16 a[132:133], v33 offset:16384
  ds_read_b64_tr_b16 a[134:135], v33 offset:16896
  v_mfma_f32_32x32x16_bf16 v[176:191], a[148:151], a[172:175], v[176:191]
  buffer_load_dwordx4 v37, s[24:27], s48 offen offset:1024 lds
  v_mfma_f32_32x32x16_bf16 v[192:207], a[152:155], a[168:171], v[192:207]
  ds_read_b64_tr_b16 a[136:137], v34 offset:16384
  ds_read_b64_tr_b16 a[138:139], v34 offset:16896
  s_add_u32 m0, s47, 0x2800
  v_mfma_f32_32x32x16_bf16 v[208:223], a[152:155], a[172:175], v[208:223]
  s_add_u32 s58, s58, 0x800
  s_and_b32 s58, s58, 0xffff
  buffer_load_dwordx4 v38, s[28:31], s48 offen lds
  v_mfma_f32_32x32x16_bf16 v[224:239], a[156:159], a[168:171], v[224:239]
  ds_read_b64_tr_b16 a[140:141], v35 offset:16384
  ds_read_b64_tr_b16 a[142:143], v35 offset:16896
  s_xor_b32 s58, s58, 64
  v_mfma_f32_32x32x16_bf16 v[240:255], a[156:159], a[172:175], v[240:255]
  buffer_load_dwordx4 v39, s[28:31], s48 offen offset:1024 lds
  s_add_u32 s48, s48, 0xe000
  s_cmp_eq_u32 s48, 0x1c0000
  s_cselect_b32 s48, 0, s48
  v_xor_b32 v0, s58, v63
  s_waitcnt lgkmcnt(0)
  v_mfma_f32_32x32x16_bf16 v[128:143], a[128:131], a[160:163], v[128:143]
  s_waitcnt vmcnt(12)
  ds_read_b64_tr_b16 a[144:145], v32 offset:20480
  ds_read_b64_tr_b16 a[146:147], v32 offset:20992
  s_add_u32 m0, s47, 0x3000
  v_mfma_f32_32x32x16_bf16 v[144:159], a[128:131], a[164:167], v[144:159]
  ds_read_b128 a[168:171], v0
  ds_read_b128 a[172:175], v0 offset:1024
  buffer_load_dwordx4 v36, s[24:27], s48 offen lds
  v_mfma_f32_32x32x16_bf16 v[160:175], a[132:135], a[160:163], v[160:175]
  ds_read_b64_tr_b16 a[148:149], v33 offset:20480
  ds_read_b64_tr_b16 a[150:151], v33 offset:20992
  v_mfma_f32_32x32x16_bf16 v[176:191], a[132:135], a[164:167], v[176:191]
  buffer_load_dwordx4 v37, s[24:27], s48 offen offset:1024 lds
  v_mfma_f32_32x32x16_bf16 v[192:207], a[136:139], a[160:163], v[192:207]
  ds_read_b64_tr_b16 a[152:153], v34 offset:20480
  ds_read_b64_tr_b16 a[154:155], v34 offset:20992
  s_add_u32 m0, s47, 0x3800
  v_mfma_f32_32x32x16_bf16 v[208:223], a[136:139], a[164:167], v[208:223]
  s_add_u32 s58, s58, 0x800
  s_and_b32 s58, s58, 0xffff
  buffer_load_dwordx4 v38, s[28:31], s48 offen lds
  v_mfma_f32_32x32x16_bf16 v[224:239], a[140:143], a[160:163], v[224:239]
  ds_read_b64_tr_b16 a[156:157], v35 offset:20480
  ds_read_b64_tr_b16 a[158:159], v35 offset:20992
  s_xor_b32 s58, s58, 64
  v_mfma_f32_32x32x16_bf16 v[240:255], a[140:143], a[164:167], v[240:255]
  buffer_load_dwordx4 v39, s[28:31], s48 offen offset:1024 lds
  s_add_u32 s48, s48, 0xe000
  s_cmp_eq_u32 s48, 0x1c0000
  s_cselect_b32 s48, 0, s48
  v_xor_b32 v0, s58, v63
  s_waitcnt lgkmcnt(0)
  v_mfma_f32_32x32x16_bf16 v[128:143], a[144:147], a[168:171], v[128:143]
  s_waitcnt vmcnt(12)
  ds_read_b64_tr_b16 a[128:129], v32
  ds_read_b64_tr_b16 a[130:131], v32 offset:512
  s_add_u32 m0, s47, 0x4000
  v_mfma_f32_32x32x16_bf16 v[144:159], a[144:147], a[172:175], v[144:159]
  ds_read_b128 a[160:163], v0
  ds_read_b128 a[164:167], v0 offset:1024
  buffer_load_dwordx4 v36, s[24:27], s48 offen lds
  v_mfma_f32_32x32x16_bf16 v[160:175], a[148:151], a[168:171], v[160:175]
  ds_read_b64_tr_b16 a[132:133], v33
  ds_read_b64_tr_b16 a[134:135], v33 offset:512
  v_mfma_f32_32x32x16_bf16 v[176:191], a[148:151], a[172:175], v[176:191]
  buffer_load_dwordx4 v37, s[24:27], s48 offen offset:1024 lds
  v_mfma_f32_32x32x16_bf16 v[192:207], a[152:155], a[168:171], v[192:207]
  ds_read_b64_tr_b16 a[136:137], v34
  ds_read_b64_tr_b16 a[138:139], v34 offset:512
  s_add_u32 m0, s47, 0x4800
  v_mfma_f32_32x32x16_bf16 v[208:223], a[152:155], a[172:175], v[208:223]
  s_add_u32 s58, s58, 0x800
  s_and_b32 s58, s58, 0xffff
  buffer_load_dwordx4 v38, s[28:31], s48 offen lds
  v_mfma_f32_32x32x16_bf16 v[224:239], a[156:159], a[168:171], v[224:239]
  ds_read_b64_tr_b16 a[140:141], v35
  ds_read_b64_tr_b16 a[142:143], v35 offset:512
  s_xor_b32 s58, s58, 64
  v_mfma_f32_32x32x16_bf16 v[240:255], a[156:159], a[172:175], v[240:255]
  buffer_load_dwordx4 v39, s[28:31], s48 offen offset:1024 lds
  s_add_u32 s48, s48, 0xe000
  s_cmp_eq_u32 s48, 0x1c0000
  s_cselect_b32 s48, 0, s48
  v_xor_b32 v0, s58, v63
  s_waitcnt lgkmcnt(0)
  v_mfma_f32_32x32x16_bf16 v[128:143], a[128:131], a[160:163], v[128:143]
  s_waitcnt vmcnt(12)
  ds_read_b64_tr_b16 a[144:145], v32 offset:4096
  ds_read_b64_tr_b16 a[146:147], v32 offset:4608
  s_add_u32 m0, s47, 0x5000
  v_mfma_f32_32x32x16_bf16 v[144:159], a[128:131], a[164:167], v[144:159]
  ds_read_b128 a[168:171], v0
  ds_read_b128 a[172:175], v0 offset:1024
  buffer_load_dwordx4 v36, s[24:27], s48 offen lds
  v_mfma_f32_32x32x16_bf16 v[160:175], a[132:135], a[160:163], v[160:175]
  ds_read_b64_tr_b16 a[148:149], v33 offset:4096
  ds_read_b64_tr_b16 a[150:151], v33 offset:4608
  v_mfma_f32_32x32x16_bf16 v[176:191], a[132:135], a[164:167], v[176:191]
  buffer_load_dwordx4 v37, s[24:27], s48 offen offset:1024 lds
  v_mfma_f32_32x32x16_bf16 v[192:207], a[136:139], a[160:163], v[192:207]
  ds_read_b64_tr_b16 a[152:153], v34 offset:4096
  ds_read_b64_tr_b16 a[154:155], v34 offset:4608
  s_add_u32 m0, s47, 0x5800
  v_mfma_f32_32x32x16_bf16 v[208:223], a[136:139], a[164:167], v[208:223]
  s_add_u32 s58, s58, 0x800
  s_and_b32 s58, s58, 0xffff
  buffer_load_dwordx4 v38, s[28:31], s48 offen lds
  v_mfma_f32_32x32x16_bf16 v[224:239], a[140:143], a[160:163], v[224:239]
  ds_read_b64_tr_b16 a[156:157], v35 offset:4096
  ds_read_b64_tr_b16 a[158:159], v35 offset:4608
  s_xor_b32 s58, s58, 64
  v_mfma_f32_32x32x16_bf16 v[240:255], a[140:143], a[164:167], v[240:255]
  buffer_load_dwordx4 v39, s[28:31], s48 offen offset:1024 lds
  s_add_u32 s48, s48, 0xe000
  s_cmp_eq_u32 s48, 0x1c0000
  s_cselect_b32 s48, 0, s48
  v_xor_b32 v0, s58, v63
  s_waitcnt lgkmcnt(0)
  v_mfma_f32_32x32x16_bf16 v[128:143], a[144:147], a[168:171], v[128:143]
  s_waitcnt vmcnt(12)
  ds_read_b64_tr_b16 a[128:129], v32 offset:8192
  ds_read_b64_tr_b16 a[130:131], v32 offset:8704
  s_add_u32 m0, s47, 0
  v_mfma_f32_32x32x16_bf16 v[144:159], a[144:147], a[172:175], v[144:159]
  ds_read_b128 a[160:163], v0
  ds_read_b128 a[164:167], v0 offset:1024
  buffer_load_dwordx4 v36, s[24:27], s48 offen lds
  v_mfma_f32_32x32x16_bf16 v[160:175], a[148:151], a[168:171], v[160:175]
  ds_read_b64_tr_b16 a[132:133], v33 offset:8192
  ds_read_b64_tr_b16 a[134:135], v33 offset:8704
  v_mfma_f32_32x32x16_bf16 v[176:191], a[148:151], a[172:175], v[176:191]
  buffer_load_dwordx4 v37, s[24:27], s48 offen offset:1024 lds
  v_mfma_f32_32x32x16_bf16 v[192:207], a[152:155], a[168:171], v[192:207]
  ds_read_b64_tr_b16 a[136:137], v34 offset:8192
  ds_read_b64_tr_b16 a[138:139], v34 offset:8704
  s_add_u32 m0, s47, 0x800
  v_mfma_f32_32x32x16_bf16 v[208:223], a[152:155], a[172:175], v[208:223]
  s_add_u32 s58, s58, 0x800
  s_and_b32 s58, s58, 0xffff
  buffer_load_dwordx4 v38, s[28:31], s48 offen lds
  v_mfma_f32_32x32x16_bf16 v[224:239], a[156:159], a[168:171], v[224:239]
  ds_read_b64_tr_b16 a[140:141], v35 offset:8192
  ds_read_b64_tr_b16 a[142:143], v35 offset:8704
  s_xor_b32 s58, s58, 64
  v_mfma_f32_32x32x16_bf16 v[240:255], a[156:159], a[172:175], v[240:255]
  buffer_load_dwordx4 v39, s[28:31], s48 offen offset:1024 lds
  s_add_u32 s48, s48, 0xe000
  s_cmp_eq_u32 s48, 0x1c0000
  s_cselect_b32 s48, 0, s48
  v_xor_b32 v0, s58, v63
  s_waitcnt lgkmcnt(0)
  v_mfma_f32_32x32x16_bf16 v[128:143], a[128:131], a[160:163], v[128:143]
  s_waitcnt vmcnt(12)
  ds_read_b64_tr_b16 a[144:145], v32 offset:12288
  ds_read_b64_tr_b16 a[146:147], v32 offset:12800
  s_add_u32 m0, s47, 0x1000
  v_mfma_f32_32x32x16_bf16 v[144:159], a[128:131], a[164:167], v[144:159]
  ds_read_b128 a[168:171], v0
  ds_read_b128 a[172:175], v0 offset:1024
  buffer_load_dwordx4 v36, s[24:27], s48 offen lds
  v_mfma_f32_32x32x16_bf16 v[160:175], a[132:135], a[160:163], v[160:175]
  ds_read_b64_tr_b16 a[148:149], v33 offset:12288
  ds_read_b64_tr_b16 a[150:151], v33 offset:12800
  v_mfma_f32_32x32x16_bf16 v[176:191], a[132:135], a[164:167], v[176:191]
  buffer_load_dwordx4 v37, s[24:27], s48 offen offset:1024 lds
  v_mfma_f32_32x32x16_bf16 v[192:207], a[136:139], a[160:163], v[192:207]
  ds_read_b64_tr_b16 a[152:153], v34 offset:12288
  ds_read_b64_tr_b16 a[154:155], v34 offset:12800
  s_add_u32 m0, s47, 0x1800
  v_mfma_f32_32x32x16_bf16 v[208:223], a[136:139], a[164:167], v[208:223]
  s_add_u32 s58, s58, 0x800
  s_and_b32 s58, s58, 0xffff
  buffer_load_dwordx4 v38, s[28:31], s48 offen lds
  v_mfma_f32_32x32x16_bf16 v[224:239], a[140:143], a[160:163], v[224:239]
  ds_read_b64_tr_b16 a[156:157], v35 offset:12288
  ds_read_b64_tr_b16 a[158:159], v35 offset:12800
  s_xor_b32 s58, s58, 64
  v_mfma_f32_32x32x16_bf16 v[240:255], a[140:143], a[164:167], v[240:255]
  buffer_load_dwordx4 v39, s[28:31], s48 offen offset:1024 lds
  s_add_u32 s48, s48, 0xe000
  s_cmp_eq_u32 s48, 0x1c0000
  s_cselect_b32 s48, 0, s48
  v_xor_b32 v0, s58, v63
  s_waitcnt lgkmcnt(0)
  v_mfma_f32_32x32x16_bf16 v[128:143], a[144:147], a[168:171], v[128:143]
  s_waitcnt vmcnt(12)
  ds_read_b64_tr_b16 a[128:129], v32 offset:16384
  ds_read_b64_tr_b16 a[130:131], v32 offset:16896
  s_add_u32 m0, s47, 0x2000
  v_mfma_f32_32x32x16_bf16 v[144:159], a[144:147], a[172:175], v[144:159]
  ds_read_b128 a[160:163], v0
  ds_read_b128 a[164:167], v0 offset:1024
  buffer_load_dwordx4 v36, s[24:27], s48 offen lds
  v_mfma_f32_32x32x16_bf16 v[160:175], a[148:151], a[168:171], v[160:175]
  ds_read_b64_tr_b16 a[132:133], v33 offset:16384
  ds_read_b64_tr_b16 a[134:135], v33 offset:16896
  v_mfma_f32_32x32x16_bf16 v[176:191], a[148:151], a[172:175], v[176:191]
  buffer_load_dwordx4 v37, s[24:27], s48 offen offset:1024 lds
  v_mfma_f32_32x32x16_bf16 v[192:207], a[152:155], a[168:171], v[192:207]
  ds_read_b64_tr_b16 a[136:137], v34 offset:16384
  ds_read_b64_tr_b16 a[138:139], v34 offset:16896
  s_add_u32 m0, s47, 0x2800
  v_mfma_f32_32x32x16_bf16 v[208:223], a[152:155], a[172:175], v[208:223]
  s_add_u32 s58, s58, 0x800
  s_and_b32 s58, s58, 0xffff
  buffer_load_dwordx4 v38, s[28:31], s48 offen lds
  v_mfma_f32_32x32x16_bf16 v[224:239], a[156:159], a[168:171], v[224:239]
  ds_read_b64_tr_b16 a[140:141], v35 offset:16384
  ds_read_b64_tr_b16 a[142:143], v35 offset:16896
  s_xor_b32 s58, s58, 64
  v_mfma_f32_32x32x16_bf16 v[240:255], a[156:159], a[172:175], v[240:255]
  buffer_load_dwordx4 v39, s[28:31], s48 offen offset:1024 lds
  s_add_u32 s48, s48, 0xe000
  s_cmp_eq_u32 s48, 0x1c0000
  s_cselect_b32 s48, 0, s48
  v_xor_b32 v0, s58, v63
  s_waitcnt lgkmcnt(0)
  v_mfma_f32_32x32x16_bf16 v[128:143], a[128:131], a[160:163], v[128:143]
  s_waitcnt vmcnt(12)
  ds_read_b64_tr_b16 a[144:145], v32 offset:20480
  ds_read_b64_tr_b16 a[146:147], v32 offset:20992
  s_add_u32 m0, s47, 0x3000
  v_mfma_f32_32x32x16_bf16 v[144:159], a[128:131], a[164:167], v[144:159]
  ds_read_b128 a[168:171], v0
  ds_read_b128 a[172:175], v0 offset:1024
  buffer_load_dwordx4 v36, s[24:27], s48 offen lds
  v_mfma_f32_32x32x16_bf16 v[160:175], a[132:135], a[160:163], v[160:175]
  ds_read_b64_tr_b16 a[148:149], v33 offset:20480
  ds_read_b64_tr_b16 a[150:151], v33 offset:20992
  v_mfma_f32_32x32x16_bf16 v[176:191], a[132:135], a[164:167], v[176:191]
  buffer_load_dwordx4 v37, s[24:27], s48 offen offset:1024 lds
  v_mfma_f32_32x32x16_bf16 v[192:207], a[136:139], a[160:163], v[192:207]
  ds_read_b64_tr_b16 a[152:153], v34 offset:20480
  ds_read_b64_tr_b16 a[154:155], v34 offset:20992
  s_add_u32 m0, s47, 0x3800
  v_mfma_f32_32x32x16_bf16 v[208:223], a[136:139], a[164:167], v[208:223]
  s_add_u32 s58, s58, 0x800
  s_and_b32 s58, s58, 0xffff
  buffer_load_dwordx4 v38, s[28:31], s48 offen lds
  v_mfma_f32_32x32x16_bf16 v[224:239], a[140:143], a[160:163], v[224:239]
  ds_read_b64_tr_b16 a[156:157], v35 offset:20480
  ds_read_b64_tr_b16 a[158:159], v35 offset:20992
  s_xor_b32 s58, s58, 64
  v_mfma_f32_32x32x16_bf16 v[240:255], a[140:143], a[164:167], v[240:255]
  buffer_load_dwordx4 v39, s[28:31], s48 offen offset:1024 lds
  s_add_u32 s48, s48, 0xe000
  s_cmp_eq_u32 s48, 0x1c0000
  s_cselect_b32 s48, 0, s48
  v_xor_b32 v0, s58, v63
  s_waitcnt lgkmcnt(0)
  v_mfma_f32_32x32x16_bf16 v[128:143], a[144:147], a[168:171], v[128:143]
  s_waitcnt vmcnt(12)
  ds_read_b64_tr_b16 a[128:129], v32
  ds_read_b64_tr_b16 a[130:131], v32 offset:512
  s_add_u32 m0, s47, 0x4000
  v_mfma_f32_32x32x16_bf16 v[144:159], a[144:147], a[172:175], v[144:159]
  ds_read_b128 a[160:163], v0
  ds_read_b128 a[164:167], v0 offset:1024
  buffer_load_dwordx4 v36, s[24:27], s48 offen lds
  v_mfma_f32_32x32x16_bf16 v[160:175], a[148:151], a[168:171], v[160:175]
  ds_read_b64_tr_b16 a[132:133], v33
  ds_read_b64_tr_b16 a[134:135], v33 offset:512
  v_mfma_f32_32x32x16_bf16 v[176:191], a[148:151], a[172:175], v[176:191]
  buffer_load_dwordx4 v37, s[24:27], s48 offen offset:1024 lds
  v_mfma_f32_32x32x16_bf16 v[192:207], a[152:155], a[168:171], v[192:207]
  ds_read_b64_tr_b16 a[136:137], v34
  ds_read_b64_tr_b16 a[138:139], v34 offset:512
  s_add_u32 m0, s47, 0x4800
  v_mfma_f32_32x32x16_bf16 v[208:223], a[152:155], a[172:175], v[208:223]
  s_add_u32 s58, s58, 0x800
  s_and_b32 s58, s58, 0xffff
  buffer_load_dwordx4 v38, s[28:31], s48 offen lds
  v_mfma_f32_32x32x16_bf16 v[224:239], a[156:159], a[168:171], v[224:239]
  ds_read_b64_tr_b16 a[140:141], v35
  ds_read_b64_tr_b16 a[142:143], v35 offset:512
  s_xor_b32 s58, s58, 64
  v_mfma_f32_32x32x16_bf16 v[240:255], a[156:159], a[172:175], v[240:255]
  buffer_load_dwordx4 v39, s[28:31], s48 offen offset:1024 lds
  s_add_u32 s48, s48, 0xe000
  s_cmp_eq_u32 s48, 0x1c0000
  s_cselect_b32 s48, 0, s48
  v_xor_b32 v0, s58, v63
  s_waitcnt lgkmcnt(0)
  v_mfma_f32_32x32x16_bf16 v[128:143], a[128:131], a[160:163], v[128:143]
  s_waitcnt vmcnt(12)
  ds_read_b64_tr_b16 a[144:145], v32 offset:4096
  ds_read_b64_tr_b16 a[146:147], v32 offset:4608
  s_add_u32 m0, s47, 0x5000
  v_mfma_f32_32x32x16_bf16 v[144:159], a[128:131], a[164:167], v[144:159]
  ds_read_b128 a[168:171], v0
  ds_read_b128 a[172:175], v0 offset:1024
  buffer_load_dwordx4 v36, s[24:27], s48 offen lds
  v_mfma_f32_32x32x16_bf16 v[160:175], a[132:135], a[160:163], v[160:175]
  ds_read_b64_tr_b16 a[148:149], v33 offset:4096
  ds_read_b64_tr_b16 a[150:151], v33 offset:4608
  v_mfma_f32_32x32x16_bf16 v[176:191], a[132:135], a[164:167], v[176:191]
  buffer_load_dwordx4 v37, s[24:27], s48 offen offset:1024 lds
  v_mfma_f32_32x32x16_bf16 v[192:207], a[136:139], a[160:163], v[192:207]
  ds_read_b64_tr_b16 a[152:153], v34 offset:4096
  ds_read_b64_tr_b16 a[154:155], v34 offset:4608
  s_add_u32 m0, s47, 0x5800
  v_mfma_f32_32x32x16_bf16 v[208:223], a[136:139], a[164:167], v[208:223]
  s_add_u32 s58, s58, 0x800
  s_and_b32 s58, s58, 0xffff
  buffer_load_dwordx4 v38, s[28:31], s48 offen lds
  v_mfma_f32_32x32x16_bf16 v[224:239], a[140:143], a[160:163], v[224:239]
  ds_read_b64_tr_b16 a[156:157], v35 offset:4096
  ds_read_b64_tr_b16 a[158:159], v35 offset:4608
  s_xor_b32 s58, s58, 64
  v_mfma_f32_32x32x16_bf16 v[240:255], a[140:143], a[164:167], v[240:255]
  buffer_load_dwordx4 v39, s[28:31], s48 offen offset:1024 lds
  s_add_u32 s48, s48, 0xe000
  s_cmp_eq_u32 s48, 0x1c0000
  s_cselect_b32 s48, 0, s48
  v_xor_b32 v0, s58, v63
  s_waitcnt lgkmcnt(0)
  v_mfma_f32_32x32x16_bf16 v[128:143], a[144:147], a[168:171], v[128:143]
  s_waitcnt vmcnt(12)
  ds_read_b64_tr_b16 a[128:129], v32 offset:8192
  ds_read_b64_tr_b16 a[130:131], v32 offset:8704
  s_add_u32 m0, s47, 0
  v_mfma_f32_32x32x16_bf16 v[144:159], a[144:147], a[172:175], v[144:159]
  ds_read_b128 a[160:163], v0
  ds_read_b128 a[164:167], v0 offset:1024
  buffer_load_dwordx4 v36, s[24:27], s48 offen lds
  v_mfma_f32_32x32x16_bf16 v[160:175], a[148:151], a[168:171], v[160:175]
  ds_read_b64_tr_b16 a[132:133], v33 offset:8192
  ds_read_b64_tr_b16 a[134:135], v33 offset:8704
  v_mfma_f32_32x32x16_bf16 v[176:191], a[148:151], a[172:175], v[176:191]
  buffer_load_dwordx4 v37, s[24:27], s48 offen offset:1024 lds
  v_mfma_f32_32x32x16_bf16 v[192:207], a[152:155], a[168:171], v[192:207]
  ds_read_b64_tr_b16 a[136:137], v34 offset:8192
  ds_read_b64_tr_b16 a[138:139], v34 offset:8704
  s_add_u32 m0, s47, 0x800
  v_mfma_f32_32x32x16_bf16 v[208:223], a[152:155], a[172:175], v[208:223]
  s_add_u32 s58, s58, 0x800
  s_and_b32 s58, s58, 0xffff
  buffer_load_dwordx4 v38, s[28:31], s48 offen lds
  v_mfma_f32_32x32x16_bf16 v[224:239], a[156:159], a[168:171], v[224:239]
  ds_read_b64_tr_b16 a[140:141], v35 offset:8192
  ds_read_b64_tr_b16 a[142:143], v35 offset:8704
  s_xor_b32 s58, s58, 64
  v_mfma_f32_32x32x16_bf16 v[240:255], a[156:159], a[172:175], v[240:255]
  buffer_load_dwordx4 v39, s[28:31], s48 offen offset:1024 lds
  s_add_u32 s48, s48, 0xe000
  s_cmp_eq_u32 s48, 0x1c0000
  s_cselect_b32 s48, 0, s48
  v_xor_b32 v0, s58, v63
  s_waitcnt lgkmcnt(0)
  v_mfma_f32_32x32x16_bf16 v[128:143], a[128:131], a[160:163], v[128:143]
  s_waitcnt vmcnt(12)
  ds_read_b64_tr_b16 a[144:145], v32 offset:12288
  ds_read_b64_tr_b16 a[146:147], v32 offset:12800
  s_add_u32 m0, s47, 0x1000
  v_mfma_f32_32x32x16_bf16 v[144:159], a[128:131], a[164:167], v[144:159]
  ds_read_b128 a[168:171], v0
  ds_read_b128 a[172:175], v0 offset:1024
  buffer_load_dwordx4 v36, s[24:27], s48 offen lds
  v_mfma_f32_32x32x16_bf16 v[160:175], a[132:135], a[160:163], v[160:175]
  ds_read_b64_tr_b16 a[148:149], v33 offset:12288
  ds_read_b64_tr_b16 a[150:151], v33 offset:12800
  v_mfma_f32_32x32x16_bf16 v[176:191], a[132:135], a[164:167], v[176:191]
  buffer_load_dwordx4 v37, s[24:27], s48 offen offset:1024 lds
  v_mfma_f32_32x32x16_bf16 v[192:207], a[136:139], a[160:163], v[192:207]
  ds_read_b64_tr_b16 a[152:153], v34 offset:12288
  ds_read_b64_tr_b16 a[154:155], v34 offset:12800
  s_add_u32 m0, s47, 0x1800
  v_mfma_f32_32x32x16_bf16 v[208:223], a[136:139], a[164:167], v[208:223]
  s_add_u32 s58, s58, 0x800
  s_and_b32 s58, s58, 0xffff
  buffer_load_dwordx4 v38, s[28:31], s48 offen lds
  v_mfma_f32_32x32x16_bf16 v[224:239], a[140:143], a[160:163], v[224:239]
  ds_read_b64_tr_b16 a[156:157], v35 offset:12288
  ds_read_b64_tr_b16 a[158:159], v35 offset:12800
  s_xor_b32 s58, s58, 64
  v_mfma_f32_32x32x16_bf16 v[240:255], a[140:143], a[164:167], v[240:255]
  buffer_load_dwordx4 v39, s[28:31], s48 offen offset:1024 lds
  v_xor_b32 v0, s58, v63
  s_waitcnt lgkmcnt(0)
  v_mfma_f32_32x32x16_bf16 v[128:143], a[144:147], a[168:171], v[128:143]
  s_waitcnt vmcnt(12)
  ds_read_b64_tr_b16 a[128:129], v32 offset:16384
  ds_read_b64_tr_b16 a[130:131], v32 offset:16896
  s_mul_i32 s48, s100, 0x20000
  s_add_u32 m0, s47, 0x2000
  v_mfma_f32_32x32x16_bf16 v[144:159], a[144:147], a[172:175], v[144:159]
  ds_read_b128 a[160:163], v0
  ds_read_b128 a[164:167], v0 offset:1024
  buffer_load_dwordx4 v40, s[16:19], s48 offen lds
  v_mfma_f32_32x32x16_bf16 v[160:175], a[148:151], a[168:171], v[160:175]
  ds_read_b64_tr_b16 a[132:133], v33 offset:16384
  ds_read_b64_tr_b16 a[134:135], v33 offset:16896
  v_mfma_f32_32x32x16_bf16 v[176:191], a[148:151], a[172:175], v[176:191]
  buffer_load_dwordx4 v41, s[16:19], s48 offen offset:1024 lds
  v_mfma_f32_32x32x16_bf16 v[192:207], a[152:155], a[168:171], v[192:207]
  ds_read_b64_tr_b16 a[136:137], v34 offset:16384
  ds_read_b64_tr_b16 a[138:139], v34 offset:16896
  v_mfma_f32_32x32x16_bf16 v[208:223], a[152:155], a[172:175], v[208:223]
  s_add_u32 s58, s58, 0x800
  s_and_b32 s58, s58, 0xffff
  buffer_load_dwordx4 v42, s[16:19], s48 offen offset:2048 lds
  v_mfma_f32_32x32x16_bf16 v[224:239], a[156:159], a[168:171], v[224:239]
  ds_read_b64_tr_b16 a[140:141], v35 offset:16384
  ds_read_b64_tr_b16 a[142:143], v35 offset:16896
  s_xor_b32 s58, s58, 64
  v_mfma_f32_32x32x16_bf16 v[240:255], a[156:159], a[172:175], v[240:255]
  buffer_load_dwordx4 v43, s[16:19], s48 offen offset:3072 lds
  s_add_u32 s48, s48, 0x20000
  s_and_b32 s48, s48, 0x3fffff
  v_xor_b32 v0, s58, v63
  s_waitcnt lgkmcnt(0)
  v_mfma_f32_32x32x16_bf16 v[128:143], a[128:131], a[160:163], v[128:143]
  s_waitcnt vmcnt(12)
  ds_read_b64_tr_b16 a[144:145], v32 offset:20480
  ds_read_b64_tr_b16 a[146:147], v32 offset:20992
  s_add_u32 m0, s47, 0x3000
  v_mfma_f32_32x32x16_bf16 v[144:159], a[128:131], a[164:167], v[144:159]
  ds_read_b128 a[168:171], v0
  ds_read_b128 a[172:175], v0 offset:1024
  buffer_load_dwordx4 v40, s[16:19], s48 offen lds
  v_mfma_f32_32x32x16_bf16 v[160:175], a[132:135], a[160:163], v[160:175]
  ds_read_b64_tr_b16 a[148:149], v33 offset:20480
  ds_read_b64_tr_b16 a[150:151], v33 offset:20992
  v_mfma_f32_32x32x16_bf16 v[176:191], a[132:135], a[164:167], v[176:191]
  buffer_load_dwordx4 v41, s[16:19], s48 offen offset:1024 lds
  v_mfma_f32_32x32x16_bf16 v[192:207], a[136:139], a[160:163], v[192:207]
  ds_read_b64_tr_b16 a[152:153], v34 offset:20480
  ds_read_b64_tr_b16 a[154:155], v34 offset:20992
  v_mfma_f32_32x32x16_bf16 v[208:223], a[136:139], a[164:167], v[208:223]
  s_add_u32 s58, s58, 0x800
  s_and_b32 s58, s58, 0xffff
  buffer_load_dwordx4 v42, s[16:19], s48 offen offset:2048 lds
  v_mfma_f32_32x32x16_bf16 v[224:239], a[140:143], a[160:163], v[224:239]
  ds_read_b64_tr_b16 a[156:157], v35 offset:20480
  ds_read_b64_tr_b16 a[158:159], v35 offset:20992
  s_xor_b32 s58, s58, 64
  v_mfma_f32_32x32x16_bf16 v[240:255], a[140:143], a[164:167], v[240:255]
  buffer_load_dwordx4 v43, s[16:19], s48 offen offset:3072 lds
  s_add_u32 s48, s48, 0x20000
  s_and_b32 s48, s48, 0x3fffff
  v_xor_b32 v0, s58, v63
  s_waitcnt lgkmcnt(0)
  v_mfma_f32_32x32x16_bf16 v[128:143], a[144:147], a[168:171], v[128:143]
  s_waitcnt vmcnt(12)
  ds_read_b64_tr_b16 a[128:129], v32
  ds_read_b64_tr_b16 a[130:131], v32 offset:512
  s_add_u32 m0, s47, 0x4000
  v_mfma_f32_32x32x16_bf16 v[144:159], a[144:147], a[172:175], v[144:159]
  ds_read_b128 a[160:163], v0
  ds_read_b128 a[164:167], v0 offset:1024
  buffer_load_dwordx4 v40, s[16:19], s48 offen lds
  v_mfma_f32_32x32x16_bf16 v[160:175], a[148:151], a[168:171], v[160:175]
  ds_read_b64_tr_b16 a[132:133], v33
  ds_read_b64_tr_b16 a[134:135], v33 offset:512
  v_mfma_f32_32x32x16_bf16 v[176:191], a[148:151], a[172:175], v[176:191]
  buffer_load_dwordx4 v41, s[16:19], s48 offen offset:1024 lds
  v_mfma_f32_32x32x16_bf16 v[192:207], a[152:155], a[168:171], v[192:207]
  ds_read_b64_tr_b16 a[136:137], v34
  ds_read_b64_tr_b16 a[138:139], v34 offset:512
  v_mfma_f32_32x32x16_bf16 v[208:223], a[152:155], a[172:175], v[208:223]
  s_add_u32 s58, s58, 0x800
  s_and_b32 s58, s58, 0xffff
  buffer_load_dwordx4 v42, s[16:19], s48 offen offset:2048 lds
  v_mfma_f32_32x32x16_bf16 v[224:239], a[156:159], a[168:171], v[224:239]
  ds_read_b64_tr_b16 a[140:141], v35
  ds_read_b64_tr_b16 a[142:143], v35 offset:512
  s_xor_b32 s58, s58, 64
  v_mfma_f32_32x32x16_bf16 v[240:255], a[156:159], a[172:175], v[240:255]
  buffer_load_dwordx4 v43, s[16:19], s48 offen offset:3072 lds
  s_add_u32 s48, s48, 0x20000
  s_and_b32 s48, s48, 0x3fffff
  v_xor_b32 v0, s58, v63
  s_waitcnt lgkmcnt(0)
  v_mfma_f32_32x32x16_bf16 v[128:143], a[128:131], a[160:163], v[128:143]
  s_waitcnt vmcnt(12)
  ds_read_b64_tr_b16 a[144:145], v32 offset:4096
  ds_read_b64_tr_b16 a[146:147], v32 offset:4608
  s_add_u32 m0, s47, 0x5000
  v_mfma_f32_32x32x16_bf16 v[144:159], a[128:131], a[164:167], v[144:159]
  ds_read_b128 a[168:171], v0
  ds_read_b128 a[172:175], v0 offset:1024
  buffer_load_dwordx4 v40, s[16:19], s48 offen lds
  v_mfma_f32_32x32x16_bf16 v[160:175], a[132:135], a[160:163], v[160:175]
  ds_read_b64_tr_b16 a[148:149], v33 offset:4096
  ds_read_b64_tr_b16 a[150:151], v33 offset:4608
  v_mfma_f32_32x32x16_bf16 v[176:191], a[132:135], a[164:167], v[176:191]
  buffer_load_dwordx4 v41, s[16:19], s48 offen offset:1024 lds
  v_mfma_f32_32x32x16_bf16 v[192:207], a[136:139], a[160:163], v[192:207]
  ds_read_b64_tr_b16 a[152:153], v34 offset:4096
  ds_read_b64_tr_b16 a[154:155], v34 offset:4608
  v_mfma_f32_32x32x16_bf16 v[208:223], a[136:139], a[164:167], v[208:223]
  buffer_load_dwordx4 v42, s[16:19], s48 offen offset:2048 lds
  v_mfma_f32_32x32x16_bf16 v[224:239], a[140:143], a[160:163], v[224:239]
  ds_read_b64_tr_b16 a[156:157], v35 offset:4096
  ds_read_b64_tr_b16 a[158:159], v35 offset:4608
  v_mfma_f32_32x32x16_bf16 v[240:255], a[140:143], a[164:167], v[240:255]
  buffer_load_dwordx4 v43, s[16:19], s48 offen offset:3072 lds
  s_add_u32 s48, s48, 0x20000
  s_and_b32 s48, s48, 0x3fffff
  s_waitcnt lgkmcnt(0)
  v_mfma_f32_32x32x16_bf16 v[128:143], a[144:147], a[168:171], v[128:143]
  s_add_u32 m0, s47, 0
  v_mfma_f32_32x32x16_bf16 v[144:159], a[144:147], a[172:175], v[144:159]
  buffer_load_dwordx4 v40, s[16:19], s48 offen lds
  v_mfma_f32_32x32x16_bf16 v[160:175], a[148:151], a[168:171], v[160:175]
  v_mfma_f32_32x32x16_bf16 v[176:191], a[148:151], a[172:175], v[176:191]
  buffer_load_dwordx4 v41, s[16:19], s48 offen offset:1024 lds
  v_mfma_f32_32x32x16_bf16 v[192:207], a[152:155], a[168:171], v[192:207]
  v_mfma_f32_32x32x16_bf16 v[208:223], a[152:155], a[172:175], v[208:223]
  buffer_load_dwordx4 v42, s[16:19], s48 offen offset:2048 lds
  v_mfma_f32_32x32x16_bf16 v[224:239], a[156:159], a[168:171], v[224:239]
  v_mfma_f32_32x32x16_bf16 v[240:255], a[156:159], a[172:175], v[240:255]
  buffer_load_dwordx4 v43, s[16:19], s48 offen offset:3072 lds
  s_add_u32 s48, s48, 0x20000
  s_and_b32 s48, s48, 0x3fffff
  s_waitcnt lgkmcnt(0)
  s_branch L_f1_join
L_f1b:
  s_lshl_b32 s58, s100, 11
  s_lshr_b32 s59, s58, 5
  s_and_b32 s59, s59, 64
  s_or_b32 s58, s58, s59
  v_xor_b32 v0, s58, v63
  s_waitcnt vmcnt(16)
  ds_read_b64_tr_b16 a[128:129], v32
  ds_read_b64_tr_b16 a[130:131], v32 offset:512
  ds_read_b128 a[160:163], v0
  ds_read_b128 a[164:167], v0 offset:1024
  ds_read_b64_tr_b16 a[132:133], v33
  ds_read_b64_tr_b16 a[134:135], v33 offset:512
  s_add_u32 s58, s58, 0x800
  s_and_b32 s58, s58, 0xffff
  s_xor_b32 s58, s58, 64
  v_xor_b32 v0, s58, v63
  s_waitcnt lgkmcnt(0)
  v_mfma_f32_32x32x16_bf16 v[128:143], a[128:131], a[160:163], 0
  s_waitcnt vmcnt(12)
  ds_read_b64_tr_b16 a[144:145], v32 offset:4096
  ds_read_b64_tr_b16 a[146:147], v32 offset:4608
  s_add_u32 m0, s47, 0x5000
  s_nop 0
  buffer_load_dwordx4 v36, s[24:27], s48 offen lds
  v_mfma_f32_32x32x16_bf16 v[144:159], a[128:131], a[164:167], 0
  ds_read_b128 a[168:171], v0
  ds_read_b128 a[172:175], v0 offset:1024
  buffer_load_dwordx4 v37, s[24:27], s48 offen offset:1024 lds
  s_add_u32 m0, s47, 0x5800
  v_mfma_f32_32x32x16_bf16 v[160:175], a[132:135], a[160:163], 0
  ds_read_b64_tr_b16 a[148:149], v33 offset:4096
  ds_read_b64_tr_b16 a[150:151], v33 offset:4608
  s_add_u32 s58, s58, 0x800
  s_and_b32 s58, s58, 0xffff
  s_xor_b32 s58, s58, 64
  buffer_load_dwordx4 v38, s[28:31], s48 offen lds
  v_mfma_f32_32x32x16_bf16 v[176:191], a[132:135], a[164:167], 0
  buffer_load_dwordx4 v39, s[28:31], s48 offen offset:1024 lds
  s_add_u32 s48, s48, 0xe000
  s_cmp_eq_u32 s48, 0x1c0000
  s_cselect_b32 s48, 0, s48
  v_xor_b32 v0, s58, v63
  s_waitcnt lgkmcnt(0)
  v_mfma_f32_32x32x16_bf16 v[128:143], a[144:147], a[168:171], v[128:143]
  s_waitcnt vmcnt(12)
  ds_read_b64_tr_b16 a[128:129], v32 offset:8192
  ds_read_b64_tr_b16 a[130:131], v32 offset:8704
  s_add_u32 m0, s47, 0
  s_nop 0
  buffer_load_dwordx4 v36, s[24:27], s48 offen lds
  v_mfma_f32_32x32x16_bf16 v[144:159], a[144:147], a[172:175], v[144:159]
  ds_read_b128 a[160:163], v0
  ds_read_b128 a[164:167], v0 offset:1024
  buffer_load_dwordx4 v37, s[24:27], s48 offen offset:1024 lds
  s_add_u32 m0, s47, 0x800
  v_mfma_f32_32x32x16_bf16 v[160:175], a[148:151], a[168:171], v[160:175]
  ds_read_b64_tr_b16 a[132:133], v33 offset:8192
  ds_read_b64_tr_b16 a[134:135], v33 offset:8704
  s_add_u32 s58, s58, 0x800
  s_and_b32 s58, s58, 0xffff
  s_xor_b32 s58, s58, 64
  buffer_load_dwordx4 v38, s[28:31], s48 offen lds
  v_mfma_f32_32x32x16_bf16 v[176:191], a[148:151], a[172:175], v[176:191]
  buffer_load_dwordx4 v39, s[28:31], s48 offen offset:1024 lds
  s_add_u32 s48, s48, 0xe000
  s_cmp_eq_u32 s48, 0x1c0000
  s_cselect_b32 s48, 0, s48
  v_xor_b32 v0, s58, v63
  s_waitcnt lgkmcnt(0)
  v_mfma_f32_32x32x16_bf16 v[128:143], a[128:131], a[160:163], v[128:143]
  s_waitcnt vmcnt(12)
  ds_read_b64_tr_b16 a[144:145], v32 offset:12288
  ds_read_b64_tr_b16 a[146:147], v32 offset:12800
  s_add_u32 m0, s47, 0x1000
  s_nop 0
  buffer_load_dwordx4 v36, s[24:27], s48 offen lds
  v_mfma_f32_32x32x16_bf16 v[144:159], a[128:131], a[164:167], v[144:159]
  ds_read_b128 a[168:171], v0
  ds_read_b128 a[172:175], v0 offset:1024
  buffer_load_dwordx4 v37, s[24:27], s48 offen offset:1024 lds
  s_add_u32 m0, s47, 0x1800
  v_mfma_f32_32x32x16_bf16 v[160:175], a[132:135], a[160:163], v[160:175]
  ds_read_b64_tr_b16 a[148:149], v33 offset:12288
  ds_read_b64_tr_b16 a[150:151], v33 offset:12800
  s_add_u32 s58, s58, 0x800
  s_and_b32 s58, s58, 0xffff
  s_xor_b32 s58, s58, 64
  buffer_load_dwordx4 v38, s[28:31], s48 offen lds
  v_mfma_f32_32x32x16_bf16 v[176:191], a[132:135], a[164:167], v[176:191]
  buffer_load_dwordx4 v39, s[28:31], s48 offen offset:1024 lds
  s_add_u32 s48, s48, 0xe000
  s_cmp_eq_u32 s48, 0x1c0000
  s_cselect_b32 s48, 0, s48
  v_xor_b32 v0, s58, v63
  s_waitcnt lgkmcnt(0)
  v_mfma_f32_32x32x16_bf16 v[128:143], a[144:147], a[168:171], v[128:143]
  s_waitcnt vmcnt(12)
  ds_read_b64_tr_b16 a[128:129], v32 offset:16384
  ds_read_b64_tr_b16 a[130:131], v32 offset:16896
  s_add_u32 m0, s47, 0x2000
  s_nop 0
  buffer_load_dwordx4 v36, s[24:27], s48 offen lds
  v_mfma_f32_32x32x16_bf16 v[144:159], a[144:147], a[172:175], v[144:159]
  ds_read_b128 a[160:163], v0
  ds_read_b128 a[164:167], v0 offset:1024
  buffer_load_dwordx4 v37, s[24:27], s48 offen offset:1024 lds
  s_add_u32 m0, s47, 0x2800
  v_mfma_f32_32x32x16_bf16 v[160:175], a[148:151], a[168:171], v[160:175]
  ds_read_b64_tr_b16 a[132:133], v33 offset:16384
  ds_read_b64_tr_b16 a[134:135], v33 offset:16896
  s_add_u32 s58, s58, 0x800
  s_and_b32 s58, s58, 0xffff
  s_xor_b32 s58, s58, 64
  buffer_load_dwordx4 v38, s[28:31], s48 offen lds
  v_mfma_f32_32x32x16_bf16 v[176:191], a[148:151], a[172:175], v[176:191]
  buffer_load_dwordx4 v39, s[28:31], s48 offen offset:1024 lds
  s_add_u32 s48, s48, 0xe000
  s_cmp_eq_u32 s48, 0x1c0000
  s_cselect_b32 s48, 0, s48
  v_xor_b32 v0, s58, v63
  s_waitcnt lgkmcnt(0)
  v_mfma_f32_32x32x16_bf16 v[128:143], a[128:131], a[160:163], v[128:143]
  s_waitcnt vmcnt(12)
  ds_read_b64_tr_b16 a[144:145], v32 offset:20480
  ds_read_b64_tr_b16 a[146:147], v32 offset:20992
  s_add_u32 m0, s47, 0x3000
  s_nop 0
  buffer_load_dwordx4 v36, s[24:27], s48 offen lds
  v_mfma_f32_32x32x16_bf16 v[144:159], a[128:131], a[164:167], v[144:159]
  ds_read_b128 a[168:171], v0
  ds_read_b128 a[172:175], v0 offset:1024
  buffer_load_dwordx4 v37, s[24:27], s48 offen offset:1024 lds
  s_add_u32 m0, s47, 0x3800
  v_mfma_f32_32x32x16_bf16 v[160:175], a[132:135], a[160:163], v[160:175]
  ds_read_b64_tr_b16 a[148:149], v33 offset:20480
  ds_read_b64_tr_b16 a[150:151], v33 offset:20992
  s_add_u32 s58, s58, 0x800
  s_and_b32 s58, s58, 0xffff
  s_xor_b32 s58, s58, 64
  buffer_load_dwordx4 v38, s[28:31], s48 offen lds
  v_mfma_f32_32x32x16_bf16 v[176:191], a[132:135], a[164:167], v[176:191]
  buffer_load_dwordx4 v39, s[28:31], s48 offen offset:1024 lds
  s_add_u32 s48, s48, 0xe000
  s_cmp_eq_u32 s48, 0x1c0000
  s_cselect_b32 s48, 0, s48
  v_xor_b32 v0, s58, v63
  s_waitcnt lgkmcnt(0)
  v_mfma_f32_32x32x16_bf16 v[128:143], a[144:147], a[168:171], v[128:143]
  s_waitcnt vmcnt(12)
  ds_read_b64_tr_b16 a[128:129], v32
  ds_read_b64_tr_b16 a[130:131], v32 offset:512
  s_add_u32 m0, s47, 0x4000
  s_nop 0
  buffer_load_dwordx4 v36, s[24:27], s48 offen lds
  v_mfma_f32_32x32x16_bf16 v[144:159], a[144:147], a[172:175], v[144:159]
  ds_read_b128 a[160:163], v0
  ds_read_b128 a[164:167], v0 offset:1024
  buffer_load_dwordx4 v37, s[24:27], s48 offen offset:1024 lds
  s_add_u32 m0, s47, 0x4800
  v_mfma_f32_32x32x16_bf16 v[160:175], a[148:151], a[168:171], v[160:175]
  ds_read_b64_tr_b16 a[132:133], v33
  ds_read_b64_tr_b16 a[134:135], v33 offset:512
  s_add_u32 s58, s58, 0x800
  s_and_b32 s58, s58, 0xffff
  s_xor_b32 s58, s58, 64
  buffer_load_dwordx4 v38, s[28:31], s48 offen lds
  v_mfma_f32_32x32x16_bf16 v[176:191], a[148:151], a[172:175], v[176:191]
  buffer_load_dwordx4 v39, s[28:31], s48 offen offset:1024 lds
  s_add_u32 s48, s48, 0xe000
  s_cmp_eq_u32 s48, 0x1c0000
  s_cselect_b32 s48, 0, s48
  v_xor_b32 v0, s58, v63
  s_waitcnt lgkmcnt(0)
  v_mfma_f32_32x32x16_bf16 v[128:143], a[128:131], a[160:163], v[128:143]
  s_waitcnt vmcnt(12)
  ds_read_b64_tr_b16 a[144:145], v32 offset:4096
  ds_read_b64_tr_b16 a[146:147], v32 offset:4608
  s_add_u32 m0, s47, 0x5000
  s_nop 0
  buffer_load_dwordx4 v36, s[24:27], s48 offen lds
  v_mfma_f32_32x32x16_bf16 v[144:159], a[128:131], a[164:167], v[144:159]
  ds_read_b128 a[168:171], v0
  ds_read_b128 a[172:175], v0 offset:1024
  buffer_load_dwordx4 v37, s[24:27], s48 offen offset:1024 lds
  s_add_u32 m0, s47, 0x5800
  v_mfma_f32_32x32x16_bf16 v[160:175], a[132:135], a[160:163], v[160:175]
  ds_read_b64_tr_b16 a[148:149], v33 offset:4096
  ds_read_b64_tr_b16 a[150:151], v33 offset:4608
  s_add_u32 s58, s58, 0x800
  s_and_b32 s58, s58, 0xffff
  s_xor_b32 s58, s58, 64
  buffer_load_dwordx4 v38, s[28:31], s48 offen lds
  v_mfma_f32_32x32x16_bf16 v[176:191], a[132:135], a[164:167], v[176:191]
  buffer_load_dwordx4 v39, s[28:31], s48 offen offset:1024 lds
  s_add_u32 s48, s48, 0xe000
  s_cmp_eq_u32 s48, 0x1c0000
  s_cselect_b32 s48, 0, s48
  v_xor_b32 v0, s58, v63
  s_waitcnt lgkmcnt(0)
  v_mfma_f32_32x32x16_bf16 v[128:143], a[144:147], a[168:171], v[128:143]
  s_waitcnt vmcnt(12)
  ds_read_b64_tr_b16 a[128:129], v32 offset:8192
  ds_read_b64_tr_b16 a[130:131], v32 offset:8704
  s_add_u32 m0, s47, 0
  s_nop 0
  buffer_load_dwordx4 v36, s[24:27], s48 offen lds
  v_mfma_f32_32x32x16_bf16 v[144:159], a[144:147], a[172:175], v[144:159]
  ds_read_b128 a[160:163], v0
  ds_read_b128 a[164:167], v0 offset:1024
  buffer_load_dwordx4 v37, s[24:27], s48 offen offset:1024 lds
  s_add_u32 m0, s47, 0x800
  v_mfma_f32_32x32x16_bf16 v[160:175], a[148:151], a[168:171], v[160:175]
  ds_read_b64_tr_b16 a[132:133], v33 offset:8192
  ds_read_b64_tr_b16 a[134:135], v33 offset:8704
  s_add_u32 s58, s58, 0x800
  s_and_b32 s58, s58, 0xffff
  s_xor_b32 s58, s58, 64
  buffer_load_dwordx4 v38, s[28:31], s48 offen lds
  v_mfma_f32_32x32x16_bf16 v[176:191], a[148:151], a[172:175], v[176:191]
  buffer_load_dwordx4 v39, s[28:31], s48 offen offset:1024 lds
  s_add_u32 s48, s48, 0xe000
  s_cmp_eq_u32 s48, 0x1c0000
  s_cselect_b32 s48, 0, s48
  v_xor_b32 v0, s58, v63
  s_waitcnt lgkmcnt(0)
  v_mfma_f32_32x32x16_bf16 v[128:143], a[128:131], a[160:163], v[128:143]
  s_waitcnt vmcnt(12)
  ds_read_b64_tr_b16 a[144:145], v32 offset:12288
  ds_read_b64_tr_b16 a[146:147], v32 offset:12800
  s_add_u32 m0, s47, 0x1000
  s_nop 0
  buffer_load_dwordx4 v36, s[24:27], s48 offen lds
  v_mfma_f32_32x32x16_bf16 v[144:159], a[128:131], a[164:167], v[144:159]
  ds_read_b128 a[168:171], v0
  ds_read_b128 a[172:175], v0 offset:1024
  buffer_load_dwordx4 v37, s[24:27], s48 offen offset:1024 lds
  s_add_u32 m0, s47, 0x1800
  v_mfma_f32_32x32x16_bf16 v[160:175], a[132:135], a[160:163], v[160:175]
  ds_read_b64_tr_b16 a[148:149], v33 offset:12288
  ds_read_b64_tr_b16 a[150:151], v33 offset:12800
  s_add_u32 s58, s58, 0x800
  s_and_b32 s58, s58, 0xffff
  s_xor_b32 s58, s58, 64
  buffer_load_dwordx4 v38, s[28:31], s48 offen lds
  v_mfma_f32_32x32x16_bf16 v[176:191], a[132:135], a[164:167], v[176:191]
  buffer_load_dwordx4 v39, s[28:31], s48 offen offset:1024 lds
  s_add_u32 s48, s48, 0xe000
  s_cmp_eq_u32 s48, 0x1c0000
  s_cselect_b32 s48, 0, s48
  v_xor_b32 v0, s58, v63
  s_waitcnt lgkmcnt(0)
  v_mfma_f32_32x32x16_bf16 v[128:143], a[144:147], a[168:171], v[128:143]
  s_waitcnt vmcnt(12)
  ds_read_b64_tr_b16 a[128:129], v32 offset:16384
  ds_read_b64_tr_b16 a[130:131], v32 offset:16896
  s_add_u32 m0, s47, 0x2000
  s_nop 0
  buffer_load_dwordx4 v36, s[24:27], s48 offen lds
  v_mfma_f32_32x32x16_bf16 v[144:159], a[144:147], a[172:175], v[144:159]
  ds_read_b128 a[160:163], v0
  ds_read_b128 a[164:167], v0 offset:1024
  buffer_load_dwordx4 v37, s[24:27], s48 offen offset:1024 lds
  s_add_u32 m0, s47, 0x2800
  v_mfma_f32_32x32x16_bf16 v[160:175], a[148:151], a[168:171], v[160:175]
  ds_read_b64_tr_b16 a[132:133], v33 offset:16384
  ds_read_b64_tr_b16 a[134:135], v33 offset:16896
  s_add_u32 s58, s58, 0x800
  s_and_b32 s58, s58, 0xffff
  s_xor_b32 s58, s58, 64
  buffer_load_dwordx4 v38, s[28:31], s48 offen lds
  v_mfma_f32_32x32x16_bf16 v[176:191], a[148:151], a[172:175], v[176:191]
  buffer_load_dwordx4 v39, s[28:31], s48 offen offset:1024 lds
  s_add_u32 s48, s48, 0xe000
  s_cmp_eq_u32 s48, 0x1c0000
  s_cselect_b32 s48, 0, s48
  v_xor_b32 v0, s58, v63
  s_waitcnt lgkmcnt(0)
  v_mfma_f32_32x32x16_bf16 v[128:143], a[128:131], a[160:163], v[128:143]
  s_waitcnt vmcnt(12)
  ds_read_b64_tr_b16 a[144:145], v32 offset:20480
  ds_read_b64_tr_b16 a[146:147], v32 offset:20992
  s_add_u32 m0, s47, 0x3000
  s_nop 0
  buffer_load_dwordx4 v36, s[24:27], s48 offen lds
  v_mfma_f32_32x32x16_bf16 v[144:159], a[128:131], a[164:167], v[144:159]
  ds_read_b128 a[168:171], v0
  ds_read_b128 a[172:175], v0 offset:1024
  buffer_load_dwordx4 v37, s[24:27], s48 offen offset:1024 lds
  s_add_u32 m0, s47, 0x3800
  v_mfma_f32_32x32x16_bf16 v[160:175], a[132:135], a[160:163], v[160:175]
  ds_read_b64_tr_b16 a[148:149], v33 offset:20480
  ds_read_b64_tr_b16 a[150:151], v33 offset:20992
  s_add_u32 s58, s58, 0x800
  s_and_b32 s58, s58, 0xffff
  s_xor_b32 s58, s58, 64
  buffer_load_dwordx4 v38, s[28:31], s48 offen lds
  v_mfma_f32_32x32x16_bf16 v[176:191], a[132:135], a[164:167], v[176:191]
  buffer_load_dwordx4 v39, s[28:31], s48 offen offset:1024 lds
  s_add_u32 s48, s48, 0xe000
  s_cmp_eq_u32 s48, 0x1c0000
  s_cselect_b32 s48, 0, s48
  v_xor_b32 v0, s58, v63
  s_waitcnt lgkmcnt(0)
  v_mfma_f32_32x32x16_bf16 v[128:143], a[144:147], a[168:171], v[128:143]
  s_waitcnt vmcnt(12)
  ds_read_b64_tr_b16 a[128:129], v32
  ds_read_b64_tr_b16 a[130:131], v32 offset:512
  s_add_u32 m0, s47, 0x4000
  s_nop 0
  buffer_load_dwordx4 v36, s[24:27], s48 offen lds
  v_mfma_f32_32x32x16_bf16 v[144:159], a[144:147], a[172:175], v[144:159]
  ds_read_b128 a[160:163], v0
  ds_read_b128 a[164:167], v0 offset:1024
  buffer_load_dwordx4 v37, s[24:27], s48 offen offset:1024 lds
  s_add_u32 m0, s47, 0x4800
  v_mfma_f32_32x32x16_bf16 v[160:175], a[148:151], a[168:171], v[160:175]
  ds_read_b64_tr_b16 a[132:133], v33
  ds_read_b64_tr_b16 a[134:135], v33 offset:512
  s_add_u32 s58, s58, 0x800
  s_and_b32 s58, s58, 0xffff
  s_xor_b32 s58, s58, 64
  buffer_load_dwordx4 v38, s[28:31], s48 offen lds
  v_mfma_f32_32x32x16_bf16 v[176:191], a[148:151], a[172:175], v[176:191]
  buffer_load_dwordx4 v39, s[28:31], s48 offen offset:1024 lds
  s_add_u32 s48, s48, 0xe000
  s_cmp_eq_u32 s48, 0x1c0000
  s_cselect_b32 s48, 0, s48
  v_xor_b32 v0, s58, v63
  s_waitcnt lgkmcnt(0)
  v_mfma_f32_32x32x16_bf16 v[128:143], a[128:131], a[160:163], v[128:143]
  s_waitcnt vmcnt(12)
  ds_read_b64_tr_b16 a[144:145], v32 offset:4096
  ds_read_b64_tr_b16 a[146:147], v32 offset:4608
  s_add_u32 m0, s47, 0x5000
  s_nop 0
  buffer_load_dwordx4 v36, s[24:27], s48 offen lds
  v_mfma_f32_32x32x16_bf16 v[144:159], a[128:131], a[164:167], v[144:159]
  ds_read_b128 a[168:171], v0
  ds_read_b128 a[172:175], v0 offset:1024
  buffer_load_dwordx4 v37, s[24:27], s48 offen offset:1024 lds
  s_add_u32 m0, s47, 0x5800
  v_mfma_f32_32x32x16_bf16 v[160:175], a[132:135], a[160:163], v[160:175]
  ds_read_b64_tr_b16 a[148:149], v33 offset:4096
  ds_read_b64_tr_b16 a[150:151], v33 offset:4608
  s_add_u32 s58, s58, 0x800
  s_and_b32 s58, s58, 0xffff
  s_xor_b32 s58, s58, 64
  buffer_load_dwordx4 v38, s[28:31], s48 offen lds
  v_mfma_f32_32x32x16_bf16 v[176:191], a[132:135], a[164:167], v[176:191]
  buffer_load_dwordx4 v39, s[28:31], s48 offen offset:1024 lds
  s_add_u32 s48, s48, 0xe000
  s_cmp_eq_u32 s48, 0x1c0000
  s_cselect_b32 s48, 0, s48
  v_xor_b32 v0, s58, v63
  s_waitcnt lgkmcnt(0)
  v_mfma_f32_32x32x16_bf16 v[128:143], a[144:147], a[168:171], v[128:143]
  s_waitcnt vmcnt(12)
  ds_read_b64_tr_b16 a[128:129], v32 offset:8192
  ds_read_b64_tr_b16 a[130:131], v32 offset:8704
  s_add_u32 m0, s47, 0
  s_nop 0
  buffer_load_dwordx4 v36, s[24:27], s48 offen lds
  v_mfma_f32_32x32x16_bf16 v[144:159], a[144:147], a[172:175], v[144:159]
  ds_read_b128 a[160:163], v0
  ds_read_b128 a[164:167], v0 offset:1024
  buffer_load_dwordx4 v37, s[24:27], s48 offen offset:1024 lds
  s_add_u32 m0, s47, 0x800
  v_mfma_f32_32x32x16_bf16 v[160:175], a[148:151], a[168:171], v[160:175]
  ds_read_b64_tr_b16 a[132:133], v33 offset:8192
  ds_read_b64_tr_b16 a[134:135], v33 offset:8704
  s_add_u32 s58, s58, 0x800
  s_and_b32 s58, s58, 0xffff
  s_xor_b32 s58, s58, 64
  buffer_load_dwordx4 v38, s[28:31], s48 offen lds
  v_mfma_f32_32x32x16_bf16 v[176:191], a[148:151], a[172:175], v[176:191]
  buffer_load_dwordx4 v39, s[28:31], s48 offen offset:1024 lds
  s_add_u32 s48, s48, 0xe000
  s_cmp_eq_u32 s48, 0x1c0000
  s_cselect_b32 s48, 0, s48
  v_xor_b32 v0, s58, v63
  s_waitcnt lgkmcnt(0)
  v_mfma_f32_32x32x16_bf16 v[128:143], a[128:131], a[160:163], v[128:143]
  s_waitcnt vmcnt(12)
  ds_read_b64_tr_b16 a[144:145], v32 offset:12288
  ds_read_b64_tr_b16 a[146:147], v32 offset:12800
  s_add_u32 m0, s47, 0x1000
  s_nop 0
  buffer_load_dwordx4 v36, s[24:27], s48 offen lds
  v_mfma_f32_32x32x16_bf16 v[144:159], a[128:131], a[164:167], v[144:159]
  ds_read_b128 a[168:171], v0
  ds_read_b128 a[172:175], v0 offset:1024
  buffer_load_dwordx4 v37, s[24:27], s48 offen offset:1024 lds
  s_add_u32 m0, s47, 0x1800
  v_mfma_f32_32x32x16_bf16 v[160:175], a[132:135], a[160:163], v[160:175]
  ds_read_b64_tr_b16 a[148:149], v33 offset:12288
  ds_read_b64_tr_b16 a[150:151], v33 offset:12800
  s_add_u32 s58, s58, 0x800
  s_and_b32 s58, s58, 0xffff
  s_xor_b32 s58, s58, 64
  buffer_load_dwordx4 v38, s[28:31], s48 offen lds
  v_mfma_f32_32x32x16_bf16 v[176:191], a[132:135], a[164:167], v[176:191]
  buffer_load_dwordx4 v39, s[28:31], s48 offen offset:1024 lds
  s_add_u32 s48, s48, 0xe000
  s_cmp_eq_u32 s48, 0x1c0000
  s_cselect_b32 s48, 0, s48
  v_xor_b32 v0, s58, v63
  s_waitcnt lgkmcnt(0)
  v_mfma_f32_32x32x16_bf16 v[128:143], a[144:147], a[168:171], v[128:143]
  s_waitcnt vmcnt(12)
  ds_read_b64_tr_b16 a[128:129], v32 offset:16384
  ds_read_b64_tr_b16 a[130:131], v32 offset:16896
  s_add_u32 m0, s47, 0x2000
  s_nop 0
  buffer_load_dwordx4 v36, s[24:27], s48 offen lds
  v_mfma_f32_32x32x16_bf16 v[144:159], a[144:147], a[172:175], v[144:159]
  ds_read_b128 a[160:163], v0
  ds_read_b128 a[164:167], v0 offset:1024
  buffer_load_dwordx4 v37, s[24:27], s48 offen offset:1024 lds
  s_add_u32 m0, s47, 0x2800
  v_mfma_f32_32x32x16_bf16 v[160:175], a[148:151], a[168:171], v[160:175]
  ds_read_b64_tr_b16 a[132:133], v33 offset:16384
  ds_read_b64_tr_b16 a[134:135], v33 offset:16896
  s_add_u32 s58, s58, 0x800
  s_and_b32 s58, s58, 0xffff
  s_xor_b32 s58, s58, 64
  buffer_load_dwordx4 v38, s[28:31], s48 offen lds
  v_mfma_f32_32x32x16_bf16 v[176:191], a[148:151], a[172:175], v[176:191]
  buffer_load_dwordx4 v39, s[28:31], s48 offen offset:1024 lds
  s_add_u32 s48, s48, 0xe000
  s_cmp_eq_u32 s48, 0x1c0000
  s_cselect_b32 s48, 0, s48
  v_xor_b32 v0, s58, v63
  s_waitcnt lgkmcnt(0)
  v_mfma_f32_32x32x16_bf16 v[128:143], a[128:131], a[160:163], v[128:143]
  s_waitcnt vmcnt(12)
  ds_read_b64_tr_b16 a[144:145], v32 offset:20480
  ds_read_b64_tr_b16 a[146:147], v32 offset:20992
  s_add_u32 m0, s47, 0x3000
  s_nop 0
  buffer_load_dwordx4 v36, s[24:27], s48 offen lds
  v_mfma_f32_32x32x16_bf16 v[144:159], a[128:131], a[164:167], v[144:159]
  ds_read_b128 a[168:171], v0
  ds_read_b128 a[172:175], v0 offset:1024
  buffer_load_dwordx4 v37, s[24:27], s48 offen offset:1024 lds
  s_add_u32 m0, s47, 0x3800
  v_mfma_f32_32x32x16_bf16 v[160:175], a[132:135], a[160:163], v[160:175]
  ds_read_b64_tr_b16 a[148:149], v33 offset:20480
  ds_read_b64_tr_b16 a[150:151], v33 offset:20992
  s_add_u32 s58, s58, 0x800
  s_and_b32 s58, s58, 0xffff
  s_xor_b32 s58, s58, 64
  buffer_load_dwordx4 v38, s[28:31], s48 offen lds
  v_mfma_f32_32x32x16_bf16 v[176:191], a[132:135], a[164:167], v[176:191]
  buffer_load_dwordx4 v39, s[28:31], s48 offen offset:1024 lds
  s_add_u32 s48, s48, 0xe000
  s_cmp_eq_u32 s48, 0x1c0000
  s_cselect_b32 s48, 0, s48
  v_xor_b32 v0, s58, v63
  s_waitcnt lgkmcnt(0)
  v_mfma_f32_32x32x16_bf16 v[128:143], a[144:147], a[168:171], v[128:143]
  s_waitcnt vmcnt(12)
  ds_read_b64_tr_b16 a[128:129], v32
  ds_read_b64_tr_b16 a[130:131], v32 offset:512
  s_add_u32 m0, s47, 0x4000
  s_nop 0
  buffer_load_dwordx4 v36, s[24:27], s48 offen lds
  v_mfma_f32_32x32x16_bf16 v[144:159], a[144:147], a[172:175], v[144:159]
  ds_read_b128 a[160:163], v0
  ds_read_b128 a[164:167], v0 offset:1024
  buffer_load_dwordx4 v37, s[24:27], s48 offen offset:1024 lds
  s_add_u32 m0, s47, 0x4800
  v_mfma_f32_32x32x16_bf16 v[160:175], a[148:151], a[168:171], v[160:175]
  ds_read_b64_tr_b16 a[132:133], v33
  ds_read_b64_tr_b16 a[134:135], v33 offset:512
  s_add_u32 s58, s58, 0x800
  s_and_b32 s58, s58, 0xffff
  s_xor_b32 s58, s58, 64
  buffer_load_dwordx4 v38, s[28:31], s48 offen lds
  v_mfma_f32_32x32x16_bf16 v[176:191], a[148:151], a[172:175], v[176:191]
  buffer_load_dwordx4 v39, s[28:31], s48 offen offset:1024 lds
  s_add_u32 s48, s48, 0xe000
  s_cmp_eq_u32 s48, 0x1c0000
  s_cselect_b32 s48, 0, s48
  v_xor_b32 v0, s58, v63
  s_waitcnt lgkmcnt(0)
  v_mfma_f32_32x32x16_bf16 v[128:143], a[128:131], a[160:163], v[128:143]
  s_waitcnt vmcnt(12)
  ds_read_b64_tr_b16 a[144:145], v32 offset:4096
  ds_read_b64_tr_b16 a[146:147], v32 offset:4608
  s_add_u32 m0, s47, 0x5000
  s_nop 0
  buffer_load_dwordx4 v36, s[24:27], s48 offen lds
  v_mfma_f32_32x32x16_bf16 v[144:159], a[128:131], a[164:167], v[144:159]
  ds_read_b128 a[168:171], v0
  ds_read_b128 a[172:175], v0 offset:1024
  buffer_load_dwordx4 v37, s[24:27], s48 offen offset:1024 lds
  s_add_u32 m0, s47, 0x5800
  v_mfma_f32_32x32x16_bf16 v[160:175], a[132:135], a[160:163], v[160:175]
  ds_read_b64_tr_b16 a[148:149], v33 offset:4096
  ds_read_b64_tr_b16 a[150:151], v33 offset:4608
  s_add_u32 s58, s58, 0x800
  s_and_b32 s58, s58, 0xffff
  s_xor_b32 s58, s58, 64
  buffer_load_dwordx4 v38, s[28:31], s48 offen lds
  v_mfma_f32_32x32x16_bf16 v[176:191], a[132:135], a[164:167], v[176:191]
  buffer_load_dwordx4 v39, s[28:31], s48 offen offset:1024 lds
  s_add_u32 s48, s48, 0xe000
  s_cmp_eq_u32 s48, 0x1c0000
  s_cselect_b32 s48, 0, s48
  v_xor_b32 v0, s58, v63
  s_waitcnt lgkmcnt(0)
  v_mfma_f32_32x32x16_bf16 v[128:143], a[144:147], a[168:171], v[128:143]
  s_waitcnt vmcnt(12)
  ds_read_b64_tr_b16 a[128:129], v32 offset:8192
  ds_read_b64_tr_b16 a[130:131], v32 offset:8704
  s_add_u32 m0, s47, 0
  s_nop 0
  buffer_load_dwordx4 v36, s[24:27], s48 offen lds
  v_mfma_f32_32x32x16_bf16 v[144:159], a[144:147], a[172:175], v[144:159]
  ds_read_b128 a[160:163], v0
  ds_read_b128 a[164:167], v0 offset:1024
  buffer_load_dwordx4 v37, s[24:27], s48 offen offset:1024 lds
  s_add_u32 m0, s47, 0x800
  v_mfma_f32_32x32x16_bf16 v[160:175], a[148:151], a[168:171], v[160:175]
  ds_read_b64_tr_b16 a[132:133], v33 offset:8192
  ds_read_b64_tr_b16 a[134:135], v33 offset:8704
  s_add_u32 s58, s58, 0x800
  s_and_b32 s58, s58, 0xffff
  s_xor_b32 s58, s58, 64
  buffer_load_dwordx4 v38, s[28:31], s48 offen lds
  v_mfma_f32_32x32x16_bf16 v[176:191], a[148:151], a[172:175], v[176:191]
  buffer_load_dwordx4 v39, s[28:31], s48 offen offset:1024 lds
  s_add_u32 s48, s48, 0xe000
  s_cmp_eq_u32 s48, 0x1c0000
  s_cselect_b32 s48, 0, s48
  v_xor_b32 v0, s58, v63
  s_waitcnt lgkmcnt(0)
  v_mfma_f32_32x32x16_bf16 v[128:143], a[128:131], a[160:163], v[128:143]
  s_waitcnt vmcnt(12)
  ds_read_b64_tr_b16 a[144:145], v32 offset:12288
  ds_read_b64_tr_b16 a[146:147], v32 offset:12800
  s_add_u32 m0, s47, 0x1000
  s_nop 0
  buffer_load_dwordx4 v36, s[24:27], s48 offen lds
  v_mfma_f32_32x32x16_bf16 v[144:159], a[128:131], a[164:167], v[144:159]
  ds_read_b128 a[168:171], v0
  ds_read_b128 a[172:175], v0 offset:1024
  buffer_load_dwordx4 v37, s[24:27], s48 offen offset:1024 lds
  s_add_u32 m0, s47, 0x1800
  v_mfma_f32_32x32x16_bf16 v[160:175], a[132:135], a[160:163], v[160:175]
  ds_read_b64_tr_b16 a[148:149], v33 offset:12288
  ds_read_b64_tr_b16 a[150:151], v33 offset:12800
  s_add_u32 s58, s58, 0x800
  s_and_b32 s58, s58, 0xffff
  s_xor_b32 s58, s58, 64
  buffer_load_dwordx4 v38, s[28:31], s48 offen lds
  v_mfma_f32_32x32x16_bf16 v[176:191], a[132:135], a[164:167], v[176:191]
  buffer_load_dwordx4 v39, s[28:31], s48 offen offset:1024 lds
  s_add_u32 s48, s48, 0xe000
  s_cmp_eq_u32 s48, 0x1c0000
  s_cselect_b32 s48, 0, s48
  v_xor_b32 v0, s58, v63
  s_waitcnt lgkmcnt(0)
  v_mfma_f32_32x32x16_bf16 v[128:143], a[144:147], a[168:171], v[128:143]
  s_waitcnt vmcnt(12)
  ds_read_b64_tr_b16 a[128:129], v32 offset:16384
  ds_read_b64_tr_b16 a[130:131], v32 offset:16896
  s_add_u32 m0, s47, 0x2000
  s_nop 0
  buffer_load_dwordx4 v36, s[24:27], s48 offen lds
  v_mfma_f32_32x32x16_bf16 v[144:159], a[144:147], a[172:175], v[144:159]
  ds_read_b128 a[160:163], v0
  ds_read_b128 a[164:167], v0 offset:1024
  buffer_load_dwordx4 v37, s[24:27], s48 offen offset:1024 lds
  s_add_u32 m0, s47, 0x2800
  v_mfma_f32_32x32x16_bf16 v[160:175], a[148:151], a[168:171], v[160:175]
  ds_read_b64_tr_b16 a[132:133], v33 offset:16384
  ds_read_b64_tr_b16 a[134:135], v33 offset:16896
  s_add_u32 s58, s58, 0x800
  s_and_b32 s58, s58, 0xffff
  s_xor_b32 s58, s58, 64
  buffer_load_dwordx4 v38, s[28:31], s48 offen lds
  v_mfma_f32_32x32x16_bf16 v[176:191], a[148:151], a[172:175], v[176:191]
  buffer_load_dwordx4 v39, s[28:31], s48 offen offset:1024 lds
  s_add_u32 s48, s48, 0xe000
  s_cmp_eq_u32 s48, 0x1c0000
  s_cselect_b32 s48, 0, s48
  v_xor_b32 v0, s58, v63
  s_waitcnt lgkmcnt(0)
  v_mfma_f32_32x32x16_bf16 v[128:143], a[128:131], a[160:163], v[128:143]
  s_waitcnt vmcnt(12)
  ds_read_b64_tr_b16 a[144:145], v32 offset:20480
  ds_read_b64_tr_b16 a[146:147], v32 offset:20992
  s_add_u32 m0, s47, 0x3000
  s_nop 0
  buffer_load_dwordx4 v36, s[24:27], s48 offen lds
  v_mfma_f32_32x32x16_bf16 v[144:159], a[128:131], a[164:167], v[144:159]
  ds_read_b128 a[168:171], v0
  ds_read_b128 a[172:175], v0 offset:1024
  buffer_load_dwordx4 v37, s[24:27], s48 offen offset:1024 lds
  s_add_u32 m0, s47, 0x3800
  v_mfma_f32_32x32x16_bf16 v[160:175], a[132:135], a[160:163], v[160:175]
  ds_read_b64_tr_b16 a[148:149], v33 offset:20480
  ds_read_b64_tr_b16 a[150:151], v33 offset:20992
  s_add_u32 s58, s58, 0x800
  s_and_b32 s58, s58, 0xffff
  s_xor_b32 s58, s58, 64
  buffer_load_dwordx4 v38, s[28:31], s48 offen lds
  v_mfma_f32_32x32x16_bf16 v[176:191], a[132:135], a[164:167], v[176:191]
  buffer_load_dwordx4 v39, s[28:31], s48 offen offset:1024 lds
  s_add_u32 s48, s48, 0xe000
  s_cmp_eq_u32 s48, 0x1c0000
  s_cselect_b32 s48, 0, s48
  v_xor_b32 v0, s58, v63
  s_waitcnt lgkmcnt(0)
  v_mfma_f32_32x32x16_bf16 v[128:143], a[144:147], a[168:171], v[128:143]
  s_waitcnt vmcnt(12)
  ds_read_b64_tr_b16 a[128:129], v32
  ds_read_b64_tr_b16 a[130:131], v32 offset:512
  s_add_u32 m0, s47, 0x4000
  s_nop 0
  buffer_load_dwordx4 v36, s[24:27], s48 offen lds
  v_mfma_f32_32x32x16_bf16 v[144:159], a[144:147], a[172:175], v[144:159]
  ds_read_b128 a[160:163], v0
  ds_read_b128 a[164:167], v0 offset:1024
  buffer_load_dwordx4 v37, s[24:27], s48 offen offset:1024 lds
  s_add_u32 m0, s47, 0x4800
  v_mfma_f32_32x32x16_bf16 v[160:175], a[148:151], a[168:171], v[160:175]
  ds_read_b64_tr_b16 a[132:133], v33
  ds_read_b64_tr_b16 a[134:135], v33 offset:512
  s_add_u32 s58, s58, 0x800
  s_and_b32 s58, s58, 0xffff
  s_xor_b32 s58, s58, 64
  buffer_load_dwordx4 v38, s[28:31], s48 offen lds
  v_mfma_f32_32x32x16_bf16 v[176:191], a[148:151], a[172:175], v[176:191]
  buffer_load_dwordx4 v39, s[28:31], s48 offen offset:1024 lds
  s_add_u32 s48, s48, 0xe000
  s_cmp_eq_u32 s48, 0x1c0000
  s_cselect_b32 s48, 0, s48
  v_xor_b32 v0, s58, v63
  s_waitcnt lgkmcnt(0)
  v_mfma_f32_32x32x16_bf16 v[128:143], a[128:131], a[160:163], v[128:143]
  s_waitcnt vmcnt(12)
  ds_read_b64_tr_b16 a[144:145], v32 offset:4096
  ds_read_b64_tr_b16 a[146:147], v32 offset:4608
  s_add_u32 m0, s47, 0x5000
  s_nop 0
  buffer_load_dwordx4 v36, s[24:27], s48 offen lds
  v_mfma_f32_32x32x16_bf16 v[144:159], a[128:131], a[164:167], v[144:159]
  ds_read_b128 a[168:171], v0
  ds_read_b128 a[172:175], v0 offset:1024
  buffer_load_dwordx4 v37, s[24:27], s48 offen offset:1024 lds
  s_add_u32 m0, s47, 0x5800
  v_mfma_f32_32x32x16_bf16 v[160:175], a[132:135], a[160:163], v[160:175]
  ds_read_b64_tr_b16 a[148:149], v33 offset:4096
  ds_read_b64_tr_b16 a[150:151], v33 offset:4608
  s_add_u32 s58, s58, 0x800
  s_and_b32 s58, s58, 0xffff
  s_xor_b32 s58, s58, 64
  buffer_load_dwordx4 v38, s[28:31], s48 offen lds
  v_mfma_f32_32x32x16_bf16 v[176:191], a[132:135], a[164:167], v[176:191]
  buffer_load_dwordx4 v39, s[28:31], s48 offen offset:1024 lds
  s_add_u32 s48, s48, 0xe000
  s_cmp_eq_u32 s48, 0x1c0000
  s_cselect_b32 s48, 0, s48
  v_xor_b32 v0, s58, v63
  s_waitcnt lgkmcnt(0)
  v_mfma_f32_32x32x16_bf16 v[128:143], a[144:147], a[168:171], v[128:143]
  s_waitcnt vmcnt(12)
  ds_read_b64_tr_b16 a[128:129], v32 offset:8192
  ds_read_b64_tr_b16 a[130:131], v32 offset:8704
  s_add_u32 m0, s47, 0
  s_nop 0
  buffer_load_dwordx4 v36, s[24:27], s48 offen lds
  v_mfma_f32_32x32x16_bf16 v[144:159], a[144:147], a[172:175], v[144:159]
  ds_read_b128 a[160:163], v0
  ds_read_b128 a[164:167], v0 offset:1024
  buffer_load_dwordx4 v37, s[24:27], s48 offen offset:1024 lds
  s_add_u32 m0, s47, 0x800
  v_mfma_f32_32x32x16_bf16 v[160:175], a[148:151], a[168:171], v[160:175]
  ds_read_b64_tr_b16 a[132:133], v33 offset:8192
  ds_read_b64_tr_b16 a[134:135], v33 offset:8704
  s_add_u32 s58, s58, 0x800
  s_and_b32 s58, s58, 0xffff
  s_xor_b32 s58, s58, 64
  buffer_load_dwordx4 v38, s[28:31], s48 offen lds
  v_mfma_f32_32x32x16_bf16 v[176:191], a[148:151], a[172:175], v[176:191]
  buffer_load_dwordx4 v39, s[28:31], s48 offen offset:1024 lds
  s_add_u32 s48, s48, 0xe000
  s_cmp_eq_u32 s48, 0x1c0000
  s_cselect_b32 s48, 0, s48
  v_xor_b32 v0, s58, v63
  s_waitcnt lgkmcnt(0)
  v_mfma_f32_32x32x16_bf16 v[128:143], a[128:131], a[160:163], v[128:143]
  s_waitcnt vmcnt(12)
  ds_read_b64_tr_b16 a[144:145], v32 offset:12288
  ds_read_b64_tr_b16 a[146:147], v32 offset:12800
  s_add_u32 m0, s47, 0x1000
  s_nop 0
  buffer_load_dwordx4 v36, s[24:27], s48 offen lds
  v_mfma_f32_32x32x16_bf16 v[144:159], a[128:131], a[164:167], v[144:159]
  ds_read_b128 a[168:171], v0
  ds_read_b128 a[172:175], v0 offset:1024
  buffer_load_dwordx4 v37, s[24:27], s48 offen offset:1024 lds
  s_add_u32 m0, s47, 0x1800
  v_mfma_f32_32x32x16_bf16 v[160:175], a[132:135], a[160:163], v[160:175]
  ds_read_b64_tr_b16 a[148:149], v33 offset:12288
  ds_read_b64_tr_b16 a[150:151], v33 offset:12800
  s_add_u32 s58, s58, 0x800
  s_and_b32 s58, s58, 0xffff
  s_xor_b32 s58, s58, 64
  buffer_load_dwordx4 v38, s[28:31], s48 offen lds
  v_mfma_f32_32x32x16_bf16 v[176:191], a[132:135], a[164:167], v[176:191]
  buffer_load_dwordx4 v39, s[28:31], s48 offen offset:1024 lds
  v_xor_b32 v0, s58, v63
  s_waitcnt lgkmcnt(0)
  v_mfma_f32_32x32x16_bf16 v[128:143], a[144:147], a[168:171], v[128:143]
  s_waitcnt vmcnt(12)
  ds_read_b64_tr_b16 a[128:129], v32 offset:16384
  ds_read_b64_tr_b16 a[130:131], v32 offset:16896
  s_mul_i32 s48, s100, 0x20000
  s_add_u32 m0, s47, 0x2000
  s_nop 0
  buffer_load_dwordx4 v40, s[16:19], s48 offen lds
  v_mfma_f32_32x32x16_bf16 v[144:159], a[144:147], a[172:175], v[144:159]
  ds_read_b128 a[160:163], v0
  ds_read_b128 a[164:167], v0 offset:1024
  buffer_load_dwordx4 v41, s[16:19], s48 offen offset:1024 lds
  v_mfma_f32_32x32x16_bf16 v[160:175], a[148:151], a[168:171], v[160:175]
  ds_read_b64_tr_b16 a[132:133], v33 offset:16384
  ds_read_b64_tr_b16 a[134:135], v33 offset:16896
  s_add_u32 s58, s58, 0x800
  s_and_b32 s58, s58, 0xffff
  s_xor_b32 s58, s58, 64
  buffer_load_dwordx4 v42, s[16:19], s48 offen offset:2048 lds
  v_mfma_f32_32x32x16_bf16 v[176:191], a[148:151], a[172:175], v[176:191]
  buffer_load_dwordx4 v43, s[16:19], s48 offen offset:3072 lds
  s_add_u32 s48, s48, 0x20000
  s_and_b32 s48, s48, 0x3fffff
  v_xor_b32 v0, s58, v63
  s_waitcnt lgkmcnt(0)
  v_mfma_f32_32x32x16_bf16 v[128:143], a[128:131], a[160:163], v[128:143]
  s_waitcnt vmcnt(12)
  ds_read_b64_tr_b16 a[144:145], v32 offset:20480
  ds_read_b64_tr_b16 a[146:147], v32 offset:20992
  s_add_u32 m0, s47, 0x3000
  s_nop 0
  buffer_load_dwordx4 v40, s[16:19], s48 offen lds
  v_mfma_f32_32x32x16_bf16 v[144:159], a[128:131], a[164:167], v[144:159]
  ds_read_b128 a[168:171], v0
  ds_read_b128 a[172:175], v0 offset:1024
  buffer_load_dwordx4 v41, s[16:19], s48 offen offset:1024 lds
  v_mfma_f32_32x32x16_bf16 v[160:175], a[132:135], a[160:163], v[160:175]
  ds_read_b64_tr_b16 a[148:149], v33 offset:20480
  ds_read_b64_tr_b16 a[150:151], v33 offset:20992
  s_add_u32 s58, s58, 0x800
  s_and_b32 s58, s58, 0xffff
  s_xor_b32 s58, s58, 64
  buffer_load_dwordx4 v42, s[16:19], s48 offen offset:2048 lds
  v_mfma_f32_32x32x16_bf16 v[176:191], a[132:135], a[164:167], v[176:191]
  buffer_load_dwordx4 v43, s[16:19], s48 offen offset:3072 lds
  s_add_u32 s48, s48, 0x20000
  s_and_b32 s48, s48, 0x3fffff
  v_xor_b32 v0, s58, v63
  s_waitcnt lgkmcnt(0)
  v_mfma_f32_32x32x16_bf16 v[128:143], a[144:147], a[168:171], v[128:143]
  s_waitcnt vmcnt(12)
  ds_read_b64_tr_b16 a[128:129], v32
  ds_read_b64_tr_b16 a[130:131], v32 offset:512
  s_add_u32 m0, s47, 0x4000
  s_nop 0
  buffer_load_dwordx4 v40, s[16:19], s48 offen lds
  v_mfma_f32_32x32x16_bf16 v[144:159], a[144:147], a[172:175], v[144:159]
  ds_read_b128 a[160:163], v0
  ds_read_b128 a[164:167], v0 offset:1024
  buffer_load_dwordx4 v41, s[16:19], s48 offen offset:1024 lds
  v_mfma_f32_32x32x16_bf16 v[160:175], a[148:151], a[168:171], v[160:175]
  ds_read_b64_tr_b16 a[132:133], v33
  ds_read_b64_tr_b16 a[134:135], v33 offset:512
  s_add_u32 s58, s58, 0x800
  s_and_b32 s58, s58, 0xffff
  s_xor_b32 s58, s58, 64
  buffer_load_dwordx4 v42, s[16:19], s48 offen offset:2048 lds
  v_mfma_f32_32x32x16_bf16 v[176:191], a[148:151], a[172:175], v[176:191]
  buffer_load_dwordx4 v43, s[16:19], s48 offen offset:3072 lds
  s_add_u32 s48, s48, 0x20000
  s_and_b32 s48, s48, 0x3fffff
  v_xor_b32 v0, s58, v63
  s_waitcnt lgkmcnt(0)
  v_mfma_f32_32x32x16_bf16 v[128:143], a[128:131], a[160:163], v[128:143]
  s_waitcnt vmcnt(12)
  ds_read_b64_tr_b16 a[144:145], v32 offset:4096
  ds_read_b64_tr_b16 a[146:147], v32 offset:4608
  s_add_u32 m0, s47, 0x5000
  s_nop 0
  buffer_load_dwordx4 v40, s[16:19], s48 offen lds
  v_mfma_f32_32x32x16_bf16 v[144:159], a[128:131], a[164:167], v[144:159]
  ds_read_b128 a[168:171], v0
  ds_read_b128 a[172:175], v0 offset:1024
  buffer_load_dwordx4 v41, s[16:19], s48 offen offset:1024 lds
  v_mfma_f32_32x32x16_bf16 v[160:175], a[132:135], a[160:163], v[160:175]
  ds_read_b64_tr_b16 a[148:149], v33 offset:4096
  ds_read_b64_tr_b16 a[150:151], v33 offset:4608
  buffer_load_dwordx4 v42, s[16:19], s48 offen offset:2048 lds
  v_mfma_f32_32x32x16_bf16 v[176:191], a[132:135], a[164:167], v[176:191]
  buffer_load_dwordx4 v43, s[16:19], s48 offen offset:3072 lds
  s_add_u32 s48, s48, 0x20000
  s_and_b32 s48, s48, 0x3fffff
  s_waitcnt lgkmcnt(0)
  v_mfma_f32_32x32x16_bf16 v[128:143], a[144:147], a[168:171], v[128:143]
  s_add_u32 m0, s47, 0
  s_nop 0
  buffer_load_dwordx4 v40, s[16:19], s48 offen lds
  v_mfma_f32_32x32x16_bf16 v[144:159], a[144:147], a[172:175], v[144:159]
  buffer_load_dwordx4 v41, s[16:19], s48 offen offset:1024 lds
  v_mfma_f32_32x32x16_bf16 v[160:175], a[148:151], a[168:171], v[160:175]
  buffer_load_dwordx4 v42, s[16:19], s48 offen offset:2048 lds
  v_mfma_f32_32x32x16_bf16 v[176:191], a[148:151], a[172:175], v[176:191]
  buffer_load_dwordx4 v43, s[16:19], s48 offen offset:3072 lds
  s_add_u32 s48, s48, 0x20000
  s_and_b32 s48, s48, 0x3fffff
  s_waitcnt lgkmcnt(0)
L_f1_join:
  s_nop 11
  v_max_f32 v128, 0, v128
  v_max_f32 v129, 0, v129
  v_max_f32 v130, 0, v130
  v_max_f32 v131, 0, v131
  v_max_f32 v132, 0, v132
  v_max_f32 v133, 0, v133
  v_max_f32 v134, 0, v134
  v_max_f32 v135, 0, v135
  v_mul_f32 v128, v128, v136
  v_mul_f32 v129, v129, v137
  v_mul_f32 v130, v130, v138
  v_mul_f32 v131, v131, v139
  v_mul_f32 v132, v132, v140
  v_mul_f32 v133, v133, v141
  v_mul_f32 v134, v134, v142
  v_mul_f32 v135, v135, v143
  v_cvt_pk_bf16_f32 v64, v128, v129
  v_cvt_pk_bf16_f32 v65, v130, v131
  v_cvt_pk_bf16_f32 v66, v132, v133
  v_cvt_pk_bf16_f32 v67, v134, v135
  v_max_f32 v144, 0, v144
  v_max_f32 v145, 0, v145
  v_max_f32 v146, 0, v146
  v_max_f32 v147, 0, v147
  v_max_f32 v148, 0, v148
  v_max_f32 v149, 0, v149
  v_max_f32 v150, 0, v150
  v_max_f32 v151, 0, v151
  v_mul_f32 v144, v144, v152
  v_mul_f32 v145, v145, v153
  v_mul_f32 v146, v146, v154
  v_mul_f32 v147, v147, v155
  v_mul_f32 v148, v148, v156
  v_mul_f32 v149, v149, v157
  v_mul_f32 v150, v150, v158
  v_mul_f32 v151, v151, v159
  v_cvt_pk_bf16_f32 v68, v144, v145
  v_cvt_pk_bf16_f32 v69, v146, v147
  v_cvt_pk_bf16_f32 v70, v148, v149
  v_cvt_pk_bf16_f32 v71, v150, v151
  v_max_f32 v160, 0, v160
  v_max_f32 v161, 0, v161
  v_max_f32 v162, 0, v162
  v_max_f32 v163, 0, v163
  v_max_f32 v164, 0, v164
  v_max_f32 v165, 0, v165
  v_max_f32 v166, 0, v166
  v_max_f32 v167, 0, v167
  v_mul_f32 v160, v160, v168
  v_mul_f32 v161, v161, v169
  v_mul_f32 v162, v162, v170
  v_mul_f32 v163, v163, v171
  v_mul_f32 v164, v164, v172
  v_mul_f32 v165, v165, v173
  v_mul_f32 v166, v166, v174
  v_mul_f32 v167, v167, v175
  v_cvt_pk_bf16_f32 v72, v160, v161
  v_cvt_pk_bf16_f32 v73, v162, v163
  v_cvt_pk_bf16_f32 v74, v164, v165
  v_cvt_pk_bf16_f32 v75, v166, v167
  v_max_f32 v176, 0, v176
  v_max_f32 v177, 0, v177
  v_max_f32 v178, 0, v178
  v_max_f32 v179, 0, v179
  v_max_f32 v180, 0, v180
  v_max_f32 v181, 0, v181
  v_max_f32 v182, 0, v182
  v_max_f32 v183, 0, v183
  v_mul_f32 v176, v176, v184
  v_mul_f32 v177, v177, v185
  v_mul_f32 v178, v178, v186
  v_mul_f32 v179, v179, v187
  v_mul_f32 v180, v180, v188
  v_mul_f32 v181, v181, v189
  v_mul_f32 v182, v182, v190
  v_mul_f32 v183, v183, v191
  v_cvt_pk_bf16_f32 v76, v176, v177
  v_cvt_pk_bf16_f32 v77, v178, v179
  v_cvt_pk_bf16_f32 v78, v180, v181
  v_cvt_pk_bf16_f32 v79, v182, v183
  v_max_f32 v192, 0, v192
  v_max_f32 v193, 0, v193
  v_max_f32 v194, 0, v194
  v_max_f32 v195, 0, v195
  v_max_f32 v196, 0, v196
  v_max_f32 v197, 0, v197
  v_max_f32 v198, 0, v198
  v_max_f32 v199, 0, v199
  v_mul_f32 v192, v192, v200
  v_mul_f32 v193, v193, v201
  v_mul_f32 v194, v194, v202
  v_mul_f32 v195, v195, v203
  v_mul_f32 v196, v196, v204
  v_mul_f32 v197, v197, v205
  v_mul_f32 v198, v198, v206
  v_mul_f32 v199, v199, v207
  v_cvt_pk_bf16_f32 v80, v192, v193
  v_cvt_pk_bf16_f32 v81, v194, v195
  v_cvt_pk_bf16_f32 v82, v196, v197
  v_cvt_pk_bf16_f32 v83, v198, v199
  v_max_f32 v208, 0, v208
  v_max_f32 v209, 0, v209
  v_max_f32 v210, 0, v210
  v_max_f32 v211, 0, v211
  v_max_f32 v212, 0, v212
  v_max_f32 v213, 0, v213
  v_max_f32 v214, 0, v214
  v_max_f32 v215, 0, v215
  v_mul_f32 v208, v208, v216
  v_mul_f32 v209, v209, v217
  v_mul_f32 v210, v210, v218
  v_mul_f32 v211, v211, v219
  v_mul_f32 v212, v212, v220
  v_mul_f32 v213, v213, v221
  v_mul_f32 v214, v214, v222
  v_mul_f32 v215, v215, v223
  v_cvt_pk_bf16_f32 v84, v208, v209
  v_cvt_pk_bf16_f32 v85, v210, v211
  v_cvt_pk_bf16_f32 v86, v212, v213
  v_cvt_pk_bf16_f32 v87, v214, v215
  v_max_f32 v224, 0, v224
  v_max_f32 v225, 0, v225
  v_max_f32 v226, 0, v226
  v_max_f32 v227, 0, v227
  v_max_f32 v228, 0, v228
  v_max_f32 v229, 0, v229
  v_max_f32 v230, 0, v230
  v_max_f32 v231, 0, v231
  v_mul_f32 v224, v224, v232
  v_mul_f32 v225, v225, v233
  v_mul_f32 v226, v226, v234
  v_mul_f32 v227, v227, v235
  v_mul_f32 v228, v228, v236
  v_mul_f32 v229, v229, v237
  v_mul_f32 v230, v230, v238
  v_mul_f32 v231, v231, v239
  v_cvt_pk_bf16_f32 v88, v224, v225
  v_cvt_pk_bf16_f32 v89, v226, v227
  v_cvt_pk_bf16_f32 v90, v228, v229
  v_cvt_pk_bf16_f32 v91, v230, v231
  v_max_f32 v240, 0, v240
  v_max_f32 v241, 0, v241
  v_max_f32 v242, 0, v242
  v_max_f32 v243, 0, v243
  v_max_f32 v244, 0, v244
  v_max_f32 v245, 0, v245
  v_max_f32 v246, 0, v246
  v_max_f32 v247, 0, v247
  v_mul_f32 v240, v240, v248
  v_mul_f32 v241, v241, v249
  v_mul_f32 v242, v242, v250
  v_mul_f32 v243, v243, v251
  v_mul_f32 v244, v244, v252
  v_mul_f32 v245, v245, v253
  v_mul_f32 v246, v246, v254
  v_mul_f32 v247, v247, v255
  v_cvt_pk_bf16_f32 v92, v240, v241
  v_cvt_pk_bf16_f32 v93, v242, v243
  v_cvt_pk_bf16_f32 v94, v244, v245
  v_cvt_pk_bf16_f32 v95, v246, v247
  s_lshl_b32 s58, s100, 11
  s_lshr_b32 s59, s58, 5
  s_and_b32 s59, s59, 64
  s_or_b32 s58, s58, s59
  v_xor_b32 v0, s58, v63
  s_waitcnt vmcnt(16)
  ds_read_b64_tr_b16 a[128:129], v28 offset:8192
  ds_read_b64_tr_b16 a[130:131], v28 offset:9216
  ds_read_b128 a[160:163], v0
  ds_read_b128 a[164:167], v0 offset:1024
  ds_read_b64_tr_b16 a[132:133], v29 offset:8192
  ds_read_b64_tr_b16 a[134:135], v29 offset:9216
  ds_read_b64_tr_b16 a[136:137], v30 offset:8192
  ds_read_b64_tr_b16 a[138:139], v30 offset:9216
  ds_read_b64_tr_b16 a[140:141], v31 offset:8192
  ds_read_b64_tr_b16 a[142:143], v31 offset:9216
  s_add_u32 s58, s58, 0x800
  s_and_b32 s58, s58, 0xffff
  s_xor_b32 s58, s58, 64
  v_xor_b32 v0, s58, v63
  s_waitcnt lgkmcnt(0)
  v_mfma_f32_32x32x16_bf16 v[128:143], a[128:131], a[160:163], 0
  s_waitcnt vmcnt(12)
  ds_read_b64_tr_b16 a[144:145], v28 offset:12288
  ds_read_b64_tr_b16 a[146:147], v28 offset:13312
  s_add_u32 m0, s47, 0x1000
  v_mfma_f32_32x32x16_bf16 v[144:159], a[128:131], a[164:167], 0
  ds_read_b128 a[168:171], v0
  ds_read_b128 a[172:175], v0 offset:1024
  buffer_load_dwordx4 v40, s[16:19], s48 offen lds
  v_mfma_f32_32x32x16_bf16 v[160:175], a[132:135], a[160:163], 0
  ds_read_b64_tr_b16 a[148:149], v29 offset:12288
  ds_read_b64_tr_b16 a[150:151], v29 offset:13312
  v_mfma_f32_32x32x16_bf16 v[176:191], a[132:135], a[164:167], 0
  buffer_load_dwordx4 v41, s[16:19], s48 offen offset:1024 lds
  v_mfma_f32_32x32x16_bf16 v[192:207], a[136:139], a[160:163], 0
  ds_read_b64_tr_b16 a[152:153], v30 offset:12288
  ds_read_b64_tr_b16 a[154:155], v30 offset:13312
  v_mfma_f32_32x32x16_bf16 v[208:223], a[136:139], a[164:167], 0
  s_add_u32 s58, s58, 0x800
  s_and_b32 s58, s58, 0xffff
  buffer_load_dwordx4 v42, s[16:19], s48 offen offset:2048 lds
  v_mfma_f32_32x32x16_bf16 v[224:239], a[140:143], a[160:163], 0
  ds_read_b64_tr_b16 a[156:157], v31 offset:12288
  ds_read_b64_tr_b16 a[158:159], v31 offset:13312
  s_xor_b32 s58, s58, 64
  v_mfma_f32_32x32x16_bf16 v[240:255], a[140:143], a[164:167], 0
  buffer_load_dwordx4 v43, s[16:19], s48 offen offset:3072 lds
  s_add_u32 s48, s48, 0x20000
  s_and_b32 s48, s48, 0x3fffff
  v_xor_b32 v0, s58, v63
  s_waitcnt lgkmcnt(0)
  v_mfma_f32_32x32x16_bf16 v[128:143], a[144:147], a[168:171], v[128:143]
  s_waitcnt vmcnt(12)
  ds_read_b64_tr_b16 a[128:129], v28 offset:16384
  ds_read_b64_tr_b16 a[130:131], v28 offset:17408
  s_add_u32 m0, s47, 0x2000
  v_mfma_f32_32x32x16_bf16 v[144:159], a[144:147], a[172:175], v[144:159]
  ds_read_b128 a[160:163], v0
  ds_read_b128 a[164:167], v0 offset:1024
  buffer_load_dwordx4 v40, s[16:19], s48 offen lds
  v_mfma_f32_32x32x16_bf16 v[160:175], a[148:151], a[168:171], v[160:175]
  ds_read_b64_tr_b16 a[132:133], v29 offset:16384
  ds_read_b64_tr_b16 a[134:135], v29 offset:17408
  v_mfma_f32_32x32x16_bf16 v[176:191], a[148:151], a[172:175], v[176:191]
  buffer_load_dwordx4 v41, s[16:19], s48 offen offset:1024 lds
  v_mfma_f32_32x32x16_bf16 v[192:207], a[152:155], a[168:171], v[192:207]
  ds_read_b64_tr_b16 a[136:137], v30 offset:16384
  ds_read_b64_tr_b16 a[138:139], v30 offset:17408
  v_mfma_f32_32x32x16_bf16 v[208:223], a[152:155], a[172:175], v[208:223]
  s_add_u32 s58, s58, 0x800
  s_and_b32 s58, s58, 0xffff
  buffer_load_dwordx4 v42, s[16:19], s48 offen offset:2048 lds
  v_mfma_f32_32x32x16_bf16 v[224:239], a[156:159], a[168:171], v[224:239]
  ds_read_b64_tr_b16 a[140:141], v31 offset:16384
  ds_read_b64_tr_b16 a[142:143], v31 offset:17408
  s_xor_b32 s58, s58, 64
  v_mfma_f32_32x32x16_bf16 v[240:255], a[156:159], a[172:175], v[240:255]
  buffer_load_dwordx4 v43, s[16:19], s48 offen offset:3072 lds
  s_add_u32 s48, s48, 0x20000
  s_and_b32 s48, s48, 0x3fffff
  v_xor_b32 v0, s58, v63
  s_waitcnt lgkmcnt(0)
  v_mfma_f32_32x32x16_bf16 v[128:143], a[128:131], a[160:163], v[128:143]
  s_waitcnt vmcnt(12)
  ds_read_b64_tr_b16 a[144:145], v28 offset:20480
  ds_read_b64_tr_b16 a[146:147], v28 offset:21504
  s_add_u32 m0, s47, 0x3000
  v_mfma_f32_32x32x16_bf16 v[144:159], a[128:131], a[164:167], v[144:159]
  ds_read_b128 a[168:171], v0
  ds_read_b128 a[172:175], v0 offset:1024
  buffer_load_dwordx4 v40, s[16:19], s48 offen lds
  v_mfma_f32_32x32x16_bf16 v[160:175], a[132:135], a[160:163], v[160:175]
  ds_read_b64_tr_b16 a[148:149], v29 offset:20480
  ds_read_b64_tr_b16 a[150:151], v29 offset:21504
  v_mfma_f32_32x32x16_bf16 v[176:191], a[132:135], a[164:167], v[176:191]
  buffer_load_dwordx4 v41, s[16:19], s48 offen offset:1024 lds
  v_mfma_f32_32x32x16_bf16 v[192:207], a[136:139], a[160:163], v[192:207]
  ds_read_b64_tr_b16 a[152:153], v30 offset:20480
  ds_read_b64_tr_b16 a[154:155], v30 offset:21504
  v_mfma_f32_32x32x16_bf16 v[208:223], a[136:139], a[164:167], v[208:223]
  s_add_u32 s58, s58, 0x800
  s_and_b32 s58, s58, 0xffff
  buffer_load_dwordx4 v42, s[16:19], s48 offen offset:2048 lds
  v_mfma_f32_32x32x16_bf16 v[224:239], a[140:143], a[160:163], v[224:239]
  ds_read_b64_tr_b16 a[156:157], v31 offset:20480
  ds_read_b64_tr_b16 a[158:159], v31 offset:21504
  s_xor_b32 s58, s58, 64
  v_mfma_f32_32x32x16_bf16 v[240:255], a[140:143], a[164:167], v[240:255]
  buffer_load_dwordx4 v43, s[16:19], s48 offen offset:3072 lds
  s_add_u32 s48, s48, 0x20000
  s_and_b32 s48, s48, 0x3fffff
  v_xor_b32 v0, s58, v63
  s_waitcnt lgkmcnt(0)
  v_mfma_f32_32x32x16_bf16 v[128:143], a[144:147], a[168:171], v[128:143]
  s_waitcnt vmcnt(12)
  ds_read_b64_tr_b16 a[128:129], v28
  ds_read_b64_tr_b16 a[130:131], v28 offset:1024
  s_add_u32 m0, s47, 0x4000
  v_mfma_f32_32x32x16_bf16 v[144:159], a[144:147], a[172:175], v[144:159]
  ds_read_b128 a[160:163], v0
  ds_read_b128 a[164:167], v0 offset:1024
  buffer_load_dwordx4 v40, s[16:19], s48 offen lds
  v_mfma_f32_32x32x16_bf16 v[160:175], a[148:151], a[168:171], v[160:175]
  ds_read_b64_tr_b16 a[132:133], v29
  ds_read_b64_tr_b16 a[134:135], v29 offset:1024
  v_mfma_f32_32x32x16_bf16 v[176:191], a[148:151], a[172:175], v[176:191]
  buffer_load_dwordx4 v41, s[16:19], s48 offen offset:1024 lds
  v_mfma_f32_32x32x16_bf16 v[192:207], a[152:155], a[168:171], v[192:207]
  ds_read_b64_tr_b16 a[136:137], v30
  ds_read_b64_tr_b16 a[138:139], v30 offset:1024
  v_mfma_f32_32x32x16_bf16 v[208:223], a[152:155], a[172:175], v[208:223]
  s_add_u32 s58, s58, 0x800
  s_and_b32 s58, s58, 0xffff
  buffer_load_dwordx4 v42, s[16:19], s48 offen offset:2048 lds
  v_mfma_f32_32x32x16_bf16 v[224:239], a[156:159], a[168:171], v[224:239]
  ds_read_b64_tr_b16 a[140:141], v31
  ds_read_b64_tr_b16 a[142:143], v31 offset:1024
  s_xor_b32 s58, s58, 64
  v_mfma_f32_32x32x16_bf16 v[240:255], a[156:159], a[172:175], v[240:255]
  buffer_load_dwordx4 v43, s[16:19], s48 offen offset:3072 lds
  s_add_u32 s48, s48, 0x20000
  s_and_b32 s48, s48, 0x3fffff
  v_xor_b32 v0, s58, v63
  s_waitcnt lgkmcnt(0)
  v_mfma_f32_32x32x16_bf16 v[128:143], a[128:131], a[160:163], v[128:143]
  s_waitcnt vmcnt(12)
  ds_read_b64_tr_b16 a[144:145], v28 offset:4096
  ds_read_b64_tr_b16 a[146:147], v28 offset:5120
  s_add_u32 m0, s47, 0x5000
  v_mfma_f32_32x32x16_bf16 v[144:159], a[128:131], a[164:167], v[144:159]
  ds_read_b128 a[168:171], v0
  ds_read_b128 a[172:175], v0 offset:1024
  buffer_load_dwordx4 v40, s[16:19], s48 offen lds
  v_mfma_f32_32x32x16_bf16 v[160:175], a[132:135], a[160:163], v[160:175]
  ds_read_b64_tr_b16 a[148:149], v29 offset:4096
  ds_read_b64_tr_b16 a[150:151], v29 offset:5120
  v_mfma_f32_32x32x16_bf16 v[176:191], a[132:135], a[164:167], v[176:191]
  buffer_load_dwordx4 v41, s[16:19], s48 offen offset:1024 lds
  v_mfma_f32_32x32x16_bf16 v[192:207], a[136:139], a[160:163], v[192:207]
  ds_read_b64_tr_b16 a[152:153], v30 offset:4096
  ds_read_b64_tr_b16 a[154:155], v30 offset:5120
  v_mfma_f32_32x32x16_bf16 v[208:223], a[136:139], a[164:167], v[208:223]
  s_add_u32 s58, s58, 0x800
  s_and_b32 s58, s58, 0xffff
  buffer_load_dwordx4 v42, s[16:19], s48 offen offset:2048 lds
  v_mfma_f32_32x32x16_bf16 v[224:239], a[140:143], a[160:163], v[224:239]
  ds_read_b64_tr_b16 a[156:157], v31 offset:4096
  ds_read_b64_tr_b16 a[158:159], v31 offset:5120
  s_xor_b32 s58, s58, 64
  v_mfma_f32_32x32x16_bf16 v[240:255], a[140:143], a[164:167], v[240:255]
  buffer_load_dwordx4 v43, s[16:19], s48 offen offset:3072 lds
  s_add_u32 s48, s48, 0x20000
  s_and_b32 s48, s48, 0x3fffff
  v_xor_b32 v0, s58, v63
  s_waitcnt lgkmcnt(0)
  v_mfma_f32_32x32x16_bf16 v[128:143], a[144:147], a[168:171], v[128:143]
  s_waitcnt vmcnt(12)
  ds_read_b64_tr_b16 a[128:129], v28 offset:8192
  ds_read_b64_tr_b16 a[130:131], v28 offset:9216
  s_add_u32 m0, s47, 0
  v_mfma_f32_32x32x16_bf16 v[144:159], a[144:147], a[172:175], v[144:159]
  ds_read_b128 a[160:163], v0
  ds_read_b128 a[164:167], v0 offset:1024
  buffer_load_dwordx4 v40, s[16:19], s48 offen lds
  v_mfma_f32_32x32x16_bf16 v[160:175], a[148:151], a[168:171], v[160:175]
  ds_read_b64_tr_b16 a[132:133], v29 offset:8192
  ds_read_b64_tr_b16 a[134:135], v29 offset:9216
  v_mfma_f32_32x32x16_bf16 v[176:191], a[148:151], a[172:175], v[176:191]
  buffer_load_dwordx4 v41, s[16:19], s48 offen offset:1024 lds
  v_mfma_f32_32x32x16_bf16 v[192:207], a[152:155], a[168:171], v[192:207]
  ds_read_b64_tr_b16 a[136:137], v30 offset:8192
  ds_read_b64_tr_b16 a[138:139], v30 offset:9216
  v_mfma_f32_32x32x16_bf16 v[208:223], a[152:155], a[172:175], v[208:223]
  s_add_u32 s58, s58, 0x800
  s_and_b32 s58, s58, 0xffff
  buffer_load_dwordx4 v42, s[16:19], s48 offen offset:2048 lds
  v_mfma_f32_32x32x16_bf16 v[224:239], a[156:159], a[168:171], v[224:239]
  ds_read_b64_tr_b16 a[140:141], v31 offset:8192
  ds_read_b64_tr_b16 a[142:143], v31 offset:9216
  s_xor_b32 s58, s58, 64
  v_mfma_f32_32x32x16_bf16 v[240:255], a[156:159], a[172:175], v[240:255]
  buffer_load_dwordx4 v43, s[16:19], s48 offen offset:3072 lds
  s_add_u32 s48, s48, 0x20000
  s_and_b32 s48, s48, 0x3fffff
  v_xor_b32 v0, s58, v63
  s_waitcnt lgkmcnt(0)
  v_mfma_f32_32x32x16_bf16 v[128:143], a[128:131], a[160:163], v[128:143]
  s_waitcnt vmcnt(12)
  ds_read_b64_tr_b16 a[144:145], v28 offset:12288
  ds_read_b64_tr_b16 a[146:147], v28 offset:13312
  s_add_u32 m0, s47, 0x1000
  v_mfma_f32_32x32x16_bf16 v[144:159], a[128:131], a[164:167], v[144:159]
  ds_read_b128 a[168:171], v0
  ds_read_b128 a[172:175], v0 offset:1024
  buffer_load_dwordx4 v40, s[16:19], s48 offen lds
  v_mfma_f32_32x32x16_bf16 v[160:175], a[132:135], a[160:163], v[160:175]
  ds_read_b64_tr_b16 a[148:149], v29 offset:12288
  ds_read_b64_tr_b16 a[150:151], v29 offset:13312
  v_mfma_f32_32x32x16_bf16 v[176:191], a[132:135], a[164:167], v[176:191]
  buffer_load_dwordx4 v41, s[16:19], s48 offen offset:1024 lds
  v_mfma_f32_32x32x16_bf16 v[192:207], a[136:139], a[160:163], v[192:207]
  ds_read_b64_tr_b16 a[152:153], v30 offset:12288
  ds_read_b64_tr_b16 a[154:155], v30 offset:13312
  v_mfma_f32_32x32x16_bf16 v[208:223], a[136:139], a[164:167], v[208:223]
  s_add_u32 s58, s58, 0x800
  s_and_b32 s58, s58, 0xffff
  buffer_load_dwordx4 v42, s[16:19], s48 offen offset:2048 lds
  v_mfma_f32_32x32x16_bf16 v[224:239], a[140:143], a[160:163], v[224:239]
  ds_read_b64_tr_b16 a[156:157], v31 offset:12288
  ds_read_b64_tr_b16 a[158:159], v31 offset:13312
  s_xor_b32 s58, s58, 64
  v_mfma_f32_32x32x16_bf16 v[240:255], a[140:143], a[164:167], v[240:255]
  buffer_load_dwordx4 v43, s[16:19], s48 offen offset:3072 lds
  s_add_u32 s48, s48, 0x20000
  s_and_b32 s48, s48, 0x3fffff
  v_xor_b32 v0, s58, v63
  s_waitcnt lgkmcnt(0)
  v_mfma_f32_32x32x16_bf16 v[128:143], a[144:147], a[168:171], v[128:143]
  s_waitcnt vmcnt(12)
  ds_read_b64_tr_b16 a[128:129], v28 offset:16384
  ds_read_b64_tr_b16 a[130:131], v28 offset:17408
  s_add_u32 m0, s47, 0x2000
  v_mfma_f32_32x32x16_bf16 v[144:159], a[144:147], a[172:175], v[144:159]
  ds_read_b128 a[160:163], v0
  ds_read_b128 a[164:167], v0 offset:1024
  buffer_load_dwordx4 v40, s[16:19], s48 offen lds
  v_mfma_f32_32x32x16_bf16 v[160:175], a[148:151], a[168:171], v[160:175]
  ds_read_b64_tr_b16 a[132:133], v29 offset:16384
  ds_read_b64_tr_b16 a[134:135], v29 offset:17408
  v_mfma_f32_32x32x16_bf16 v[176:191], a[148:151], a[172:175], v[176:191]
  buffer_load_dwordx4 v41, s[16:19], s48 offen offset:1024 lds
  v_mfma_f32_32x32x16_bf16 v[192:207], a[152:155], a[168:171], v[192:207]
  ds_read_b64_tr_b16 a[136:137], v30 offset:16384
  ds_read_b64_tr_b16 a[138:139], v30 offset:17408
  v_mfma_f32_32x32x16_bf16 v[208:223], a[152:155], a[172:175], v[208:223]
  s_add_u32 s58, s58, 0x800
  s_and_b32 s58, s58, 0xffff
  buffer_load_dwordx4 v42, s[16:19], s48 offen offset:2048 lds
  v_mfma_f32_32x32x16_bf16 v[224:239], a[156:159], a[168:171], v[224:239]
  ds_read_b64_tr_b16 a[140:141], v31 offset:16384
  ds_read_b64_tr_b16 a[142:143], v31 offset:17408
  s_xor_b32 s58, s58, 64
  v_mfma_f32_32x32x16_bf16 v[240:255], a[156:159], a[172:175], v[240:255]
  buffer_load_dwordx4 v43, s[16:19], s48 offen offset:3072 lds
  s_add_u32 s48, s48, 0x20000
  s_and_b32 s48, s48, 0x3fffff
  v_xor_b32 v0, s58, v63
  s_waitcnt lgkmcnt(0)
  v_mfma_f32_32x32x16_bf16 v[128:143], a[128:131], a[160:163], v[128:143]
  s_waitcnt vmcnt(12)
  ds_read_b64_tr_b16 a[144:145], v28 offset:20480
  ds_read_b64_tr_b16 a[146:147], v28 offset:21504
  s_add_u32 m0, s47, 0x3000
  v_mfma_f32_32x32x16_bf16 v[144:159], a[128:131], a[164:167], v[144:159]
  ds_read_b128 a[168:171], v0
  ds_read_b128 a[172:175], v0 offset:1024
  buffer_load_dwordx4 v40, s[16:19], s48 offen lds
  v_mfma_f32_32x32x16_bf16 v[160:175], a[132:135], a[160:163], v[160:175]
  ds_read_b64_tr_b16 a[148:149], v29 offset:20480
  ds_read_b64_tr_b16 a[150:151], v29 offset:21504
  v_mfma_f32_32x32x16_bf16 v[176:191], a[132:135], a[164:167], v[176:191]
  buffer_load_dwordx4 v41, s[16:19], s48 offen offset:1024 lds
  v_mfma_f32_32x32x16_bf16 v[192:207], a[136:139], a[160:163], v[192:207]
  ds_read_b64_tr_b16 a[152:153], v30 offset:20480
  ds_read_b64_tr_b16 a[154:155], v30 offset:21504
  v_mfma_f32_32x32x16_bf16 v[208:223], a[136:139], a[164:167], v[208:223]
  s_add_u32 s58, s58, 0x800
  s_and_b32 s58, s58, 0xffff
  buffer_load_dwordx4 v42, s[16:19], s48 offen offset:2048 lds
  v_mfma_f32_32x32x16_bf16 v[224:239], a[140:143], a[160:163], v[224:239]
  ds_read_b64_tr_b16 a[156:157], v31 offset:20480
  ds_read_b64_tr_b16 a[158:159], v31 offset:21504
  s_xor_b32 s58, s58, 64
  v_mfma_f32_32x32x16_bf16 v[240:255], a[140:143], a[164:167], v[240:255]
  buffer_load_dwordx4 v43, s[16:19], s48 offen offset:3072 lds
  s_add_u32 s48, s48, 0x20000
  s_and_b32 s48, s48, 0x3fffff
  v_xor_b32 v0, s58, v63
  s_waitcnt lgkmcnt(0)
  v_mfma_f32_32x32x16_bf16 v[128:143], a[144:147], a[168:171], v[128:143]
  s_waitcnt vmcnt(12)
  ds_read_b64_tr_b16 a[128:129], v28
  ds_read_b64_tr_b16 a[130:131], v28 offset:1024
  s_add_u32 m0, s47, 0x4000
  v_mfma_f32_32x32x16_bf16 v[144:159], a[144:147], a[172:175], v[144:159]
  ds_read_b128 a[160:163], v0
  ds_read_b128 a[164:167], v0 offset:1024
  buffer_load_dwordx4 v40, s[16:19], s48 offen lds
  v_mfma_f32_32x32x16_bf16 v[160:175], a[148:151], a[168:171], v[160:175]
  ds_read_b64_tr_b16 a[132:133], v29
  ds_read_b64_tr_b16 a[134:135], v29 offset:1024
  v_mfma_f32_32x32x16_bf16 v[176:191], a[148:151], a[172:175], v[176:191]
  buffer_load_dwordx4 v41, s[16:19], s48 offen offset:1024 lds
  v_mfma_f32_32x32x16_bf16 v[192:207], a[152:155], a[168:171], v[192:207]
  ds_read_b64_tr_b16 a[136:137], v30
  ds_read_b64_tr_b16 a[138:139], v30 offset:1024
  v_mfma_f32_32x32x16_bf16 v[208:223], a[152:155], a[172:175], v[208:223]
  s_add_u32 s58, s58, 0x800
  s_and_b32 s58, s58, 0xffff
  buffer_load_dwordx4 v42, s[16:19], s48 offen offset:2048 lds
  v_mfma_f32_32x32x16_bf16 v[224:239], a[156:159], a[168:171], v[224:239]
  ds_read_b64_tr_b16 a[140:141], v31
  ds_read_b64_tr_b16 a[142:143], v31 offset:1024
  s_xor_b32 s58, s58, 64
  v_mfma_f32_32x32x16_bf16 v[240:255], a[156:159], a[172:175], v[240:255]
  buffer_load_dwordx4 v43, s[16:19], s48 offen offset:3072 lds
  s_add_u32 s48, s48, 0x20000
  s_and_b32 s48, s48, 0x3fffff
  v_xor_b32 v0, s58, v63
  s_waitcnt lgkmcnt(0)
  v_mfma_f32_32x32x16_bf16 v[128:143], a[128:131], a[160:163], v[128:143]
  s_waitcnt vmcnt(12)
  ds_read_b64_tr_b16 a[144:145], v28 offset:4096
  ds_read_b64_tr_b16 a[146:147], v28 offset:5120
  s_add_u32 m0, s47, 0x5000
  v_mfma_f32_32x32x16_bf16 v[144:159], a[128:131], a[164:167], v[144:159]
  ds_read_b128 a[168:171], v0
  ds_read_b128 a[172:175], v0 offset:1024
  buffer_load_dwordx4 v40, s[16:19], s48 offen lds
  v_mfma_f32_32x32x16_bf16 v[160:175], a[132:135], a[160:163], v[160:175]
  ds_read_b64_tr_b16 a[148:149], v29 offset:4096
  ds_read_b64_tr_b16 a[150:151], v29 offset:5120
  v_mfma_f32_32x32x16_bf16 v[176:191], a[132:135], a[164:167], v[176:191]
  buffer_load_dwordx4 v41, s[16:19], s48 offen offset:1024 lds
  v_mfma_f32_32x32x16_bf16 v[192:207], a[136:139], a[160:163], v[192:207]
  ds_read_b64_tr_b16 a[152:153], v30 offset:4096
  ds_read_b64_tr_b16 a[154:155], v30 offset:5120
  v_mfma_f32_32x32x16_bf16 v[208:223], a[136:139], a[164:167], v[208:223]
  s_add_u32 s58, s58, 0x800
  s_and_b32 s58, s58, 0xffff
  buffer_load_dwordx4 v42, s[16:19], s48 offen offset:2048 lds
  v_mfma_f32_32x32x16_bf16 v[224:239], a[140:143], a[160:163], v[224:239]
  ds_read_b64_tr_b16 a[156:157], v31 offset:4096
  ds_read_b64_tr_b16 a[158:159], v31 offset:5120
  s_xor_b32 s58, s58, 64
  v_mfma_f32_32x32x16_bf16 v[240:255], a[140:143], a[164:167], v[240:255]
  buffer_load_dwordx4 v43, s[16:19], s48 offen offset:3072 lds
  s_add_u32 s48, s48, 0x20000
  s_and_b32 s48, s48, 0x3fffff
  v_xor_b32 v0, s58, v63
  s_waitcnt lgkmcnt(0)
  v_mfma_f32_32x32x16_bf16 v[128:143], a[144:147], a[168:171], v[128:143]
  s_waitcnt vmcnt(12)
  ds_read_b64_tr_b16 a[128:129], v28 offset:8192
  ds_read_b64_tr_b16 a[130:131], v28 offset:9216
  s_add_u32 m0, s47, 0
  v_mfma_f32_32x32x16_bf16 v[144:159], a[144:147], a[172:175], v[144:159]
  ds_read_b128 a[160:163], v0
  ds_read_b128 a[164:167], v0 offset:1024
  buffer_load_dwordx4 v40, s[16:19], s48 offen lds
  v_mfma_f32_32x32x16_bf16 v[160:175], a[148:151], a[168:171], v[160:175]
  ds_read_b64_tr_b16 a[132:133], v29 offset:8192
  ds_read_b64_tr_b16 a[134:135], v29 offset:9216
  v_mfma_f32_32x32x16_bf16 v[176:191], a[148:151], a[172:175], v[176:191]
  buffer_load_dwordx4 v41, s[16:19], s48 offen offset:1024 lds
  v_mfma_f32_32x32x16_bf16 v[192:207], a[152:155], a[168:171], v[192:207]
  ds_read_b64_tr_b16 a[136:137], v30 offset:8192
  ds_read_b64_tr_b16 a[138:139], v30 offset:9216
  v_mfma_f32_32x32x16_bf16 v[208:223], a[152:155], a[172:175], v[208:223]
  s_add_u32 s58, s58, 0x800
  s_and_b32 s58, s58, 0xffff
  buffer_load_dwordx4 v42, s[16:19], s48 offen offset:2048 lds
  v_mfma_f32_32x32x16_bf16 v[224:239], a[156:159], a[168:171], v[224:239]
  ds_read_b64_tr_b16 a[140:141], v31 offset:8192
  ds_read_b64_tr_b16 a[142:143], v31 offset:9216
  s_xor_b32 s58, s58, 64
  v_mfma_f32_32x32x16_bf16 v[240:255], a[156:159], a[172:175], v[240:255]
  buffer_load_dwordx4 v43, s[16:19], s48 offen offset:3072 lds
  s_add_u32 s48, s48, 0x20000
  s_and_b32 s48, s48, 0x3fffff
  v_xor_b32 v0, s58, v63
  s_waitcnt lgkmcnt(0)
  v_mfma_f32_32x32x16_bf16 v[128:143], a[128:131], a[160:163], v[128:143]
  s_waitcnt vmcnt(12)
  ds_read_b64_tr_b16 a[144:145], v28 offset:12288
  ds_read_b64_tr_b16 a[146:147], v28 offset:13312
  s_add_u32 m0, s47, 0x1000
  v_mfma_f32_32x32x16_bf16 v[144:159], a[128:131], a[164:167], v[144:159]
  ds_read_b128 a[168:171], v0
  ds_read_b128 a[172:175], v0 offset:1024
  buffer_load_dwordx4 v40, s[16:19], s48 offen lds
  v_mfma_f32_32x32x16_bf16 v[160:175], a[132:135], a[160:163], v[160:175]
  ds_read_b64_tr_b16 a[148:149], v29 offset:12288
  ds_read_b64_tr_b16 a[150:151], v29 offset:13312
  v_mfma_f32_32x32x16_bf16 v[176:191], a[132:135], a[164:167], v[176:191]
  buffer_load_dwordx4 v41, s[16:19], s48 offen offset:1024 lds
  v_mfma_f32_32x32x16_bf16 v[192:207], a[136:139], a[160:163], v[192:207]
  ds_read_b64_tr_b16 a[152:153], v30 offset:12288
  ds_read_b64_tr_b16 a[154:155], v30 offset:13312
  v_mfma_f32_32x32x16_bf16 v[208:223], a[136:139], a[164:167], v[208:223]
  s_add_u32 s58, s58, 0x800
  s_and_b32 s58, s58, 0xffff
  buffer_load_dwordx4 v42, s[16:19], s48 offen offset:2048 lds
  v_mfma_f32_32x32x16_bf16 v[224:239], a[140:143], a[160:163], v[224:239]
  ds_read_b64_tr_b16 a[156:157], v31 offset:12288
  ds_read_b64_tr_b16 a[158:159], v31 offset:13312
  s_xor_b32 s58, s58, 64
  v_mfma_f32_32x32x16_bf16 v[240:255], a[140:143], a[164:167], v[240:255]
  buffer_load_dwordx4 v43, s[16:19], s48 offen offset:3072 lds
  s_add_u32 s48, s48, 0x20000
  s_and_b32 s48, s48, 0x3fffff
  v_xor_b32 v0, s58, v63
  s_waitcnt lgkmcnt(0)
  v_mfma_f32_32x32x16_bf16 v[128:143], a[144:147], a[168:171], v[128:143]
  s_waitcnt vmcnt(12)
  ds_read_b64_tr_b16 a[128:129], v28 offset:16384
  ds_read_b64_tr_b16 a[130:131], v28 offset:17408
  s_add_u32 m0, s47, 0x2000
  v_mfma_f32_32x32x16_bf16 v[144:159], a[144:147], a[172:175], v[144:159]
  ds_read_b128 a[160:163], v0
  ds_read_b128 a[164:167], v0 offset:1024
  buffer_load_dwordx4 v40, s[16:19], s48 offen lds
  v_mfma_f32_32x32x16_bf16 v[160:175], a[148:151], a[168:171], v[160:175]
  ds_read_b64_tr_b16 a[132:133], v29 offset:16384
  ds_read_b64_tr_b16 a[134:135], v29 offset:17408
  v_mfma_f32_32x32x16_bf16 v[176:191], a[148:151], a[172:175], v[176:191]
  buffer_load_dwordx4 v41, s[16:19], s48 offen offset:1024 lds
  v_mfma_f32_32x32x16_bf16 v[192:207], a[152:155], a[168:171], v[192:207]
  ds_read_b64_tr_b16 a[136:137], v30 offset:16384
  ds_read_b64_tr_b16 a[138:139], v30 offset:17408
  v_mfma_f32_32x32x16_bf16 v[208:223], a[152:155], a[172:175], v[208:223]
  s_add_u32 s58, s58, 0x800
  s_and_b32 s58, s58, 0xffff
  buffer_load_dwordx4 v42, s[16:19], s48 offen offset:2048 lds
  v_mfma_f32_32x32x16_bf16 v[224:239], a[156:159], a[168:171], v[224:239]
  ds_read_b64_tr_b16 a[140:141], v31 offset:16384
  ds_read_b64_tr_b16 a[142:143], v31 offset:17408
  s_xor_b32 s58, s58, 64
  v_mfma_f32_32x32x16_bf16 v[240:255], a[156:159], a[172:175], v[240:255]
  buffer_load_dwordx4 v43, s[16:19], s48 offen offset:3072 lds
  s_add_u32 s48, s48, 0x20000
  s_and_b32 s48, s48, 0x3fffff
  v_xor_b32 v0, s58, v63
  s_waitcnt lgkmcnt(0)
  v_mfma_f32_32x32x16_bf16 v[128:143], a[128:131], a[160:163], v[128:143]
  s_waitcnt vmcnt(12)
  ds_read_b64_tr_b16 a[144:145], v28 offset:20480
  ds_read_b64_tr_b16 a[146:147], v28 offset:21504
  s_add_u32 m0, s47, 0x3000
  v_mfma_f32_32x32x16_bf16 v[144:159], a[128:131], a[164:167], v[144:159]
  ds_read_b128 a[168:171], v0
  ds_read_b128 a[172:175], v0 offset:1024
  buffer_load_dwordx4 v40, s[16:19], s48 offen lds
  v_mfma_f32_32x32x16_bf16 v[160:175], a[132:135], a[160:163], v[160:175]
  ds_read_b64_tr_b16 a[148:149], v29 offset:20480
  ds_read_b64_tr_b16 a[150:151], v29 offset:21504
  v_mfma_f32_32x32x16_bf16 v[176:191], a[132:135], a[164:167], v[176:191]
  buffer_load_dwordx4 v41, s[16:19], s48 offen offset:1024 lds
  v_mfma_f32_32x32x16_bf16 v[192:207], a[136:139], a[160:163], v[192:207]
  ds_read_b64_tr_b16 a[152:153], v30 offset:20480
  ds_read_b64_tr_b16 a[154:155], v30 offset:21504
  v_mfma_f32_32x32x16_bf16 v[208:223], a[136:139], a[164:167], v[208:223]
  s_add_u32 s58, s58, 0x800
  s_and_b32 s58, s58, 0xffff
  buffer_load_dwordx4 v42, s[16:19], s48 offen offset:2048 lds
  v_mfma_f32_32x32x16_bf16 v[224:239], a[140:143], a[160:163], v[224:239]
  ds_read_b64_tr_b16 a[156:157], v31 offset:20480
  ds_read_b64_tr_b16 a[158:159], v31 offset:21504
  s_xor_b32 s58, s58, 64
  v_mfma_f32_32x32x16_bf16 v[240:255], a[140:143], a[164:167], v[240:255]
  buffer_load_dwordx4 v43, s[16:19], s48 offen offset:3072 lds
  s_add_u32 s48, s48, 0x20000
  s_and_b32 s48, s48, 0x3fffff
  v_xor_b32 v0, s58, v63
  s_waitcnt lgkmcnt(0)
  v_mfma_f32_32x32x16_bf16 v[128:143], a[144:147], a[168:171], v[128:143]
  s_waitcnt vmcnt(12)
  ds_read_b64_tr_b16 a[128:129], v28
  ds_read_b64_tr_b16 a[130:131], v28 offset:1024
  s_add_u32 m0, s47, 0x4000
  v_mfma_f32_32x32x16_bf16 v[144:159], a[144:147], a[172:175], v[144:159]
  ds_read_b128 a[160:163], v0
  ds_read_b128 a[164:167], v0 offset:1024
  buffer_load_dwordx4 v40, s[16:19], s48 offen lds
  v_mfma_f32_32x32x16_bf16 v[160:175], a[148:151], a[168:171], v[160:175]
  ds_read_b64_tr_b16 a[132:133], v29
  ds_read_b64_tr_b16 a[134:135], v29 offset:1024
  v_mfma_f32_32x32x16_bf16 v[176:191], a[148:151], a[172:175], v[176:191]
  buffer_load_dwordx4 v41, s[16:19], s48 offen offset:1024 lds
  v_mfma_f32_32x32x16_bf16 v[192:207], a[152:155], a[168:171], v[192:207]
  ds_read_b64_tr_b16 a[136:137], v30
  ds_read_b64_tr_b16 a[138:139], v30 offset:1024
  v_mfma_f32_32x32x16_bf16 v[208:223], a[152:155], a[172:175], v[208:223]
  s_add_u32 s58, s58, 0x800
  s_and_b32 s58, s58, 0xffff
  buffer_load_dwordx4 v42, s[16:19], s48 offen offset:2048 lds
  v_mfma_f32_32x32x16_bf16 v[224:239], a[156:159], a[168:171], v[224:239]
  ds_read_b64_tr_b16 a[140:141], v31
  ds_read_b64_tr_b16 a[142:143], v31 offset:1024
  s_xor_b32 s58, s58, 64
  v_mfma_f32_32x32x16_bf16 v[240:255], a[156:159], a[172:175], v[240:255]
  buffer_load_dwordx4 v43, s[16:19], s48 offen offset:3072 lds
  s_add_u32 s48, s48, 0x20000
  s_and_b32 s48, s48, 0x3fffff
  v_xor_b32 v0, s58, v63
  s_waitcnt lgkmcnt(0)
  v_mfma_f32_32x32x16_bf16 v[128:143], a[128:131], a[160:163], v[128:143]
  s_waitcnt vmcnt(12)
  ds_read_b64_tr_b16 a[144:145], v28 offset:4096
  ds_read_b64_tr_b16 a[146:147], v28 offset:5120
  s_add_u32 m0, s47, 0x5000
  v_mfma_f32_32x32x16_bf16 v[144:159], a[128:131], a[164:167], v[144:159]
  ds_read_b128 a[168:171], v0
  ds_read_b128 a[172:175], v0 offset:1024
  buffer_load_dwordx4 v40, s[16:19], s48 offen lds
  v_mfma_f32_32x32x16_bf16 v[160:175], a[132:135], a[160:163], v[160:175]
  ds_read_b64_tr_b16 a[148:149], v29 offset:4096
  ds_read_b64_tr_b16 a[150:151], v29 offset:5120
  v_mfma_f32_32x32x16_bf16 v[176:191], a[132:135], a[164:167], v[176:191]
  buffer_load_dwordx4 v41, s[16:19], s48 offen offset:1024 lds
  v_mfma_f32_32x32x16_bf16 v[192:207], a[136:139], a[160:163], v[192:207]
  ds_read_b64_tr_b16 a[152:153], v30 offset:4096
  ds_read_b64_tr_b16 a[154:155], v30 offset:5120
  v_mfma_f32_32x32x16_bf16 v[208:223], a[136:139], a[164:167], v[208:223]
  s_add_u32 s58, s58, 0x800
  s_and_b32 s58, s58, 0xffff
  buffer_load_dwordx4 v42, s[16:19], s48 offen offset:2048 lds
  v_mfma_f32_32x32x16_bf16 v[224:239], a[140:143], a[160:163], v[224:239]
  ds_read_b64_tr_b16 a[156:157], v31 offset:4096
  ds_read_b64_tr_b16 a[158:159], v31 offset:5120
  s_xor_b32 s58, s58, 64
  v_mfma_f32_32x32x16_bf16 v[240:255], a[140:143], a[164:167], v[240:255]
  buffer_load_dwordx4 v43, s[16:19], s48 offen offset:3072 lds
  s_add_u32 s48, s48, 0x20000
  s_and_b32 s48, s48, 0x3fffff
  v_xor_b32 v0, s58, v63
  s_waitcnt lgkmcnt(0)
  v_mfma_f32_32x32x16_bf16 v[128:143], a[144:147], a[168:171], v[128:143]
  s_waitcnt vmcnt(12)
  ds_read_b64_tr_b16 a[128:129], v28 offset:8192
  ds_read_b64_tr_b16 a[130:131], v28 offset:9216
  s_add_u32 m0, s47, 0
  v_mfma_f32_32x32x16_bf16 v[144:159], a[144:147], a[172:175], v[144:159]
  ds_read_b128 a[160:163], v0
  ds_read_b128 a[164:167], v0 offset:1024
  buffer_load_dwordx4 v40, s[16:19], s48 offen lds
  v_mfma_f32_32x32x16_bf16 v[160:175], a[148:151], a[168:171], v[160:175]
  ds_read_b64_tr_b16 a[132:133], v29 offset:8192
  ds_read_b64_tr_b16 a[134:135], v29 offset:9216
  v_mfma_f32_32x32x16_bf16 v[176:191], a[148:151], a[172:175], v[176:191]
  buffer_load_dwordx4 v41, s[16:19], s48 offen offset:1024 lds
  v_mfma_f32_32x32x16_bf16 v[192:207], a[152:155], a[168:171], v[192:207]
  ds_read_b64_tr_b16 a[136:137], v30 offset:8192
  ds_read_b64_tr_b16 a[138:139], v30 offset:9216
  v_mfma_f32_32x32x16_bf16 v[208:223], a[152:155], a[172:175], v[208:223]
  s_add_u32 s58, s58, 0x800
  s_and_b32 s58, s58, 0xffff
  buffer_load_dwordx4 v42, s[16:19], s48 offen offset:2048 lds
  v_mfma_f32_32x32x16_bf16 v[224:239], a[156:159], a[168:171], v[224:239]
  ds_read_b64_tr_b16 a[140:141], v31 offset:8192
  ds_read_b64_tr_b16 a[142:143], v31 offset:9216
  s_xor_b32 s58, s58, 64
  v_mfma_f32_32x32x16_bf16 v[240:255], a[156:159], a[172:175], v[240:255]
  buffer_load_dwordx4 v43, s[16:19], s48 offen offset:3072 lds
  s_add_u32 s48, s48, 0x20000
  s_and_b32 s48, s48, 0x3fffff
  v_xor_b32 v0, s58, v63
  s_waitcnt lgkmcnt(0)
  v_mfma_f32_32x32x16_bf16 v[128:143], a[128:131], a[160:163], v[128:143]
  s_waitcnt vmcnt(12)
  ds_read_b64_tr_b16 a[144:145], v28 offset:12288
  ds_read_b64_tr_b16 a[146:147], v28 offset:13312
  s_add_u32 m0, s47, 0x1000
  v_mfma_f32_32x32x16_bf16 v[144:159], a[128:131], a[164:167], v[144:159]
  ds_read_b128 a[168:171], v0
  ds_read_b128 a[172:175], v0 offset:1024
  buffer_load_dwordx4 v40, s[16:19], s48 offen lds
  v_mfma_f32_32x32x16_bf16 v[160:175], a[132:135], a[160:163], v[160:175]
  ds_read_b64_tr_b16 a[148:149], v29 offset:12288
  ds_read_b64_tr_b16 a[150:151], v29 offset:13312
  v_mfma_f32_32x32x16_bf16 v[176:191], a[132:135], a[164:167], v[176:191]
  buffer_load_dwordx4 v41, s[16:19], s48 offen offset:1024 lds
  v_mfma_f32_32x32x16_bf16 v[192:207], a[136:139], a[160:163], v[192:207]
  ds_read_b64_tr_b16 a[152:153], v30 offset:12288
  ds_read_b64_tr_b16 a[154:155], v30 offset:13312
  v_mfma_f32_32x32x16_bf16 v[208:223], a[136:139], a[164:167], v[208:223]
  s_add_u32 s58, s58, 0x800
  s_and_b32 s58, s58, 0xffff
  buffer_load_dwordx4 v42, s[16:19], s48 offen offset:2048 lds
  v_mfma_f32_32x32x16_bf16 v[224:239], a[140:143], a[160:163], v[224:239]
  ds_read_b64_tr_b16 a[156:157], v31 offset:12288
  ds_read_b64_tr_b16 a[158:159], v31 offset:13312
  s_xor_b32 s58, s58, 64
  v_mfma_f32_32x32x16_bf16 v[240:255], a[140:143], a[164:167], v[240:255]
  buffer_load_dwordx4 v43, s[16:19], s48 offen offset:3072 lds
  s_add_u32 s48, s48, 0x20000
  s_and_b32 s48, s48, 0x3fffff
  v_xor_b32 v0, s58, v63
  s_waitcnt lgkmcnt(0)
  v_mfma_f32_32x32x16_bf16 v[128:143], a[144:147], a[168:171], v[128:143]
  s_waitcnt vmcnt(12)
  ds_read_b64_tr_b16 a[128:129], v28 offset:16384
  ds_read_b64_tr_b16 a[130:131], v28 offset:17408
  s_add_u32 m0, s47, 0x2000
  v_mfma_f32_32x32x16_bf16 v[144:159], a[144:147], a[172:175], v[144:159]
  ds_read_b128 a[160:163], v0
  ds_read_b128 a[164:167], v0 offset:1024
  buffer_load_dwordx4 v40, s[16:19], s48 offen lds
  v_mfma_f32_32x32x16_bf16 v[160:175], a[148:151], a[168:171], v[160:175]
  ds_read_b64_tr_b16 a[132:133], v29 offset:16384
  ds_read_b64_tr_b16 a[134:135], v29 offset:17408
  v_mfma_f32_32x32x16_bf16 v[176:191], a[148:151], a[172:175], v[176:191]
  buffer_load_dwordx4 v41, s[16:19], s48 offen offset:1024 lds
  v_mfma_f32_32x32x16_bf16 v[192:207], a[152:155], a[168:171], v[192:207]
  ds_read_b64_tr_b16 a[136:137], v30 offset:16384
  ds_read_b64_tr_b16 a[138:139], v30 offset:17408
  v_mfma_f32_32x32x16_bf16 v[208:223], a[152:155], a[172:175], v[208:223]
  s_add_u32 s58, s58, 0x800
  s_and_b32 s58, s58, 0xffff
  buffer_load_dwordx4 v42, s[16:19], s48 offen offset:2048 lds
  v_mfma_f32_32x32x16_bf16 v[224:239], a[156:159], a[168:171], v[224:239]
  ds_read_b64_tr_b16 a[140:141], v31 offset:16384
  ds_read_b64_tr_b16 a[142:143], v31 offset:17408
  s_xor_b32 s58, s58, 64
  v_mfma_f32_32x32x16_bf16 v[240:255], a[156:159], a[172:175], v[240:255]
  buffer_load_dwordx4 v43, s[16:19], s48 offen offset:3072 lds
  s_add_u32 s48, s48, 0x20000
  s_and_b32 s48, s48, 0x3fffff
  v_xor_b32 v0, s58, v63
  s_waitcnt lgkmcnt(0)
  v_mfma_f32_32x32x16_bf16 v[128:143], a[128:131], a[160:163], v[128:143]
  s_waitcnt vmcnt(12)
  ds_read_b64_tr_b16 a[144:145], v28 offset:20480
  ds_read_b64_tr_b16 a[146:147], v28 offset:21504
  s_add_u32 m0, s47, 0x3000
  v_mfma_f32_32x32x16_bf16 v[144:159], a[128:131], a[164:167], v[144:159]
  ds_read_b128 a[168:171], v0
  ds_read_b128 a[172:175], v0 offset:1024
  buffer_load_dwordx4 v40, s[16:19], s48 offen lds
  v_mfma_f32_32x32x16_bf16 v[160:175], a[132:135], a[160:163], v[160:175]
  ds_read_b64_tr_b16 a[148:149], v29 offset:20480
  ds_read_b64_tr_b16 a[150:151], v29 offset:21504
  v_mfma_f32_32x32x16_bf16 v[176:191], a[132:135], a[164:167], v[176:191]
  buffer_load_dwordx4 v41, s[16:19], s48 offen offset:1024 lds
  v_mfma_f32_32x32x16_bf16 v[192:207], a[136:139], a[160:163], v[192:207]
  ds_read_b64_tr_b16 a[152:153], v30 offset:20480
  ds_read_b64_tr_b16 a[154:155], v30 offset:21504
  v_mfma_f32_32x32x16_bf16 v[208:223], a[136:139], a[164:167], v[208:223]
  s_add_u32 s58, s58, 0x800
  s_and_b32 s58, s58, 0xffff
  buffer_load_dwordx4 v42, s[16:19], s48 offen offset:2048 lds
  v_mfma_f32_32x32x16_bf16 v[224:239], a[140:143], a[160:163], v[224:239]
  ds_read_b64_tr_b16 a[156:157], v31 offset:20480
  ds_read_b64_tr_b16 a[158:159], v31 offset:21504
  s_xor_b32 s58, s58, 64
  v_mfma_f32_32x32x16_bf16 v[240:255], a[140:143], a[164:167], v[240:255]
  buffer_load_dwordx4 v43, s[16:19], s48 offen offset:3072 lds
  s_add_u32 s48, s48, 0x20000
  s_and_b32 s48, s48, 0x3fffff
  v_xor_b32 v0, s58, v63
  s_waitcnt lgkmcnt(0)
  v_mfma_f32_32x32x16_bf16 v[128:143], a[144:147], a[168:171], v[128:143]
  s_waitcnt vmcnt(12)
  ds_read_b64_tr_b16 a[128:129], v28
  ds_read_b64_tr_b16 a[130:131], v28 offset:1024
  s_add_u32 m0, s47, 0x4000
  v_mfma_f32_32x32x16_bf16 v[144:159], a[144:147], a[172:175], v[144:159]
  ds_read_b128 a[160:163], v0
  ds_read_b128 a[164:167], v0 offset:1024
  buffer_load_dwordx4 v40, s[16:19], s48 offen lds
  v_mfma_f32_32x32x16_bf16 v[160:175], a[148:151], a[168:171], v[160:175]
  ds_read_b64_tr_b16 a[132:133], v29
  ds_read_b64_tr_b16 a[134:135], v29 offset:1024
  v_mfma_f32_32x32x16_bf16 v[176:191], a[148:151], a[172:175], v[176:191]
  buffer_load_dwordx4 v41, s[16:19], s48 offen offset:1024 lds
  v_mfma_f32_32x32x16_bf16 v[192:207], a[152:155], a[168:171], v[192:207]
  ds_read_b64_tr_b16 a[136:137], v30
  ds_read_b64_tr_b16 a[138:139], v30 offset:1024
  v_mfma_f32_32x32x16_bf16 v[208:223], a[152:155], a[172:175], v[208:223]
  s_add_u32 s58, s58, 0x800
  s_and_b32 s58, s58, 0xffff
  buffer_load_dwordx4 v42, s[16:19], s48 offen offset:2048 lds
  v_mfma_f32_32x32x16_bf16 v[224:239], a[156:159], a[168:171], v[224:239]
  ds_read_b64_tr_b16 a[140:141], v31
  ds_read_b64_tr_b16 a[142:143], v31 offset:1024
  s_xor_b32 s58, s58, 64
  v_mfma_f32_32x32x16_bf16 v[240:255], a[156:159], a[172:175], v[240:255]
  buffer_load_dwordx4 v43, s[16:19], s48 offen offset:3072 lds
  s_add_u32 s48, s48, 0x20000
  s_and_b32 s48, s48, 0x3fffff
  v_xor_b32 v0, s58, v63
  s_waitcnt lgkmcnt(0)
  v_mfma_f32_32x32x16_bf16 v[128:143], a[128:131], a[160:163], v[128:143]
  s_waitcnt vmcnt(12)
  ds_read_b64_tr_b16 a[144:145], v28 offset:4096
  ds_read_b64_tr_b16 a[146:147], v28 offset:5120
  s_add_u32 m0, s47, 0x5000
  v_mfma_f32_32x32x16_bf16 v[144:159], a[128:131], a[164:167], v[144:159]
  ds_read_b128 a[168:171], v0
  ds_read_b128 a[172:175], v0 offset:1024
  buffer_load_dwordx4 v40, s[16:19], s48 offen lds
  v_mfma_f32_32x32x16_bf16 v[160:175], a[132:135], a[160:163], v[160:175]
  ds_read_b64_tr_b16 a[148:149], v29 offset:4096
  ds_read_b64_tr_b16 a[150:151], v29 offset:5120
  v_mfma_f32_32x32x16_bf16 v[176:191], a[132:135], a[164:167], v[176:191]
  buffer_load_dwordx4 v41, s[16:19], s48 offen offset:1024 lds
  v_mfma_f32_32x32x16_bf16 v[192:207], a[136:139], a[160:163], v[192:207]
  ds_read_b64_tr_b16 a[152:153], v30 offset:4096
  ds_read_b64_tr_b16 a[154:155], v30 offset:5120
  v_mfma_f32_32x32x16_bf16 v[208:223], a[136:139], a[164:167], v[208:223]
  s_add_u32 s58, s58, 0x800
  s_and_b32 s58, s58, 0xffff
  buffer_load_dwordx4 v42, s[16:19], s48 offen offset:2048 lds
  v_mfma_f32_32x32x16_bf16 v[224:239], a[140:143], a[160:163], v[224:239]
  ds_read_b64_tr_b16 a[156:157], v31 offset:4096
  ds_read_b64_tr_b16 a[158:159], v31 offset:5120
  s_xor_b32 s58, s58, 64
  v_mfma_f32_32x32x16_bf16 v[240:255], a[140:143], a[164:167], v[240:255]
  buffer_load_dwordx4 v43, s[16:19], s48 offen offset:3072 lds
  s_add_u32 s48, s48, 0x20000
  s_and_b32 s48, s48, 0x3fffff
  v_xor_b32 v0, s58, v63
  s_waitcnt lgkmcnt(0)
  v_mfma_f32_32x32x16_bf16 v[128:143], a[144:147], a[168:171], v[128:143]
  s_waitcnt vmcnt(12)
  ds_read_b64_tr_b16 a[128:129], v28 offset:8192
  ds_read_b64_tr_b16 a[130:131], v28 offset:9216
  s_add_u32 m0, s47, 0
  v_mfma_f32_32x32x16_bf16 v[144:159], a[144:147], a[172:175], v[144:159]
  ds_read_b128 a[160:163], v0
  ds_read_b128 a[164:167], v0 offset:1024
  buffer_load_dwordx4 v40, s[16:19], s48 offen lds
  v_mfma_f32_32x32x16_bf16 v[160:175], a[148:151], a[168:171], v[160:175]
  ds_read_b64_tr_b16 a[132:133], v29 offset:8192
  ds_read_b64_tr_b16 a[134:135], v29 offset:9216
  v_mfma_f32_32x32x16_bf16 v[176:191], a[148:151], a[172:175], v[176:191]
  buffer_load_dwordx4 v41, s[16:19], s48 offen offset:1024 lds
  v_mfma_f32_32x32x16_bf16 v[192:207], a[152:155], a[168:171], v[192:207]
  ds_read_b64_tr_b16 a[136:137], v30 offset:8192
  ds_read_b64_tr_b16 a[138:139], v30 offset:9216
  v_mfma_f32_32x32x16_bf16 v[208:223], a[152:155], a[172:175], v[208:223]
  s_add_u32 s58, s58, 0x800
  s_and_b32 s58, s58, 0xffff
  buffer_load_dwordx4 v42, s[16:19], s48 offen offset:2048 lds
  v_mfma_f32_32x32x16_bf16 v[224:239], a[156:159], a[168:171], v[224:239]
  ds_read_b64_tr_b16 a[140:141], v31 offset:8192
  ds_read_b64_tr_b16 a[142:143], v31 offset:9216
  s_xor_b32 s58, s58, 64
  v_mfma_f32_32x32x16_bf16 v[240:255], a[156:159], a[172:175], v[240:255]
  buffer_load_dwordx4 v43, s[16:19], s48 offen offset:3072 lds
  s_add_u32 s48, s48, 0x20000
  s_and_b32 s48, s48, 0x3fffff
  v_xor_b32 v0, s58, v63
  s_waitcnt lgkmcnt(0)
  v_mfma_f32_32x32x16_bf16 v[128:143], a[128:131], a[160:163], v[128:143]
  s_waitcnt vmcnt(12)
  ds_read_b64_tr_b16 a[144:145], v28 offset:12288
  ds_read_b64_tr_b16 a[146:147], v28 offset:13312
  s_add_u32 m0, s47, 0x1000
  v_mfma_f32_32x32x16_bf16 v[144:159], a[128:131], a[164:167], v[144:159]
  ds_read_b128 a[168:171], v0
  ds_read_b128 a[172:175], v0 offset:1024
  buffer_load_dwordx4 v40, s[16:19], s48 offen lds
  v_mfma_f32_32x32x16_bf16 v[160:175], a[132:135], a[160:163], v[160:175]
  ds_read_b64_tr_b16 a[148:149], v29 offset:12288
  ds_read_b64_tr_b16 a[150:151], v29 offset:13312
  v_mfma_f32_32x32x16_bf16 v[176:191], a[132:135], a[164:167], v[176:191]
  buffer_load_dwordx4 v41, s[16:19], s48 offen offset:1024 lds
  v_mfma_f32_32x32x16_bf16 v[192:207], a[136:139], a[160:163], v[192:207]
  ds_read_b64_tr_b16 a[152:153], v30 offset:12288
  ds_read_b64_tr_b16 a[154:155], v30 offset:13312
  v_mfma_f32_32x32x16_bf16 v[208:223], a[136:139], a[164:167], v[208:223]
  s_add_u32 s58, s58, 0x800
  s_and_b32 s58, s58, 0xffff
  buffer_load_dwordx4 v42, s[16:19], s48 offen offset:2048 lds
  v_mfma_f32_32x32x16_bf16 v[224:239], a[140:143], a[160:163], v[224:239]
  ds_read_b64_tr_b16 a[156:157], v31 offset:12288
  ds_read_b64_tr_b16 a[158:159], v31 offset:13312
  s_xor_b32 s58, s58, 64
  v_mfma_f32_32x32x16_bf16 v[240:255], a[140:143], a[164:167], v[240:255]
  buffer_load_dwordx4 v43, s[16:19], s48 offen offset:3072 lds
  s_add_u32 s48, s48, 0x20000
  s_and_b32 s48, s48, 0x3fffff
  v_xor_b32 v0, s58, v63
  s_waitcnt lgkmcnt(0)
  v_mfma_f32_32x32x16_bf16 v[128:143], a[144:147], a[168:171], v[128:143]
  s_waitcnt vmcnt(12)
  ds_read_b64_tr_b16 a[128:129], v28 offset:16384
  ds_read_b64_tr_b16 a[130:131], v28 offset:17408
  s_add_u32 m0, s47, 0x2000
  v_mfma_f32_32x32x16_bf16 v[144:159], a[144:147], a[172:175], v[144:159]
  ds_read_b128 a[160:163], v0
  ds_read_b128 a[164:167], v0 offset:1024
  buffer_load_dwordx4 v40, s[16:19], s48 offen lds
  v_mfma_f32_32x32x16_bf16 v[160:175], a[148:151], a[168:171], v[160:175]
  ds_read_b64_tr_b16 a[132:133], v29 offset:16384
  ds_read_b64_tr_b16 a[134:135], v29 offset:17408
  v_mfma_f32_32x32x16_bf16 v[176:191], a[148:151], a[172:175], v[176:191]
  buffer_load_dwordx4 v41, s[16:19], s48 offen offset:1024 lds
  v_mfma_f32_32x32x16_bf16 v[192:207], a[152:155], a[168:171], v[192:207]
  ds_read_b64_tr_b16 a[136:137], v30 offset:16384
  ds_read_b64_tr_b16 a[138:139], v30 offset:17408
  v_mfma_f32_32x32x16_bf16 v[208:223], a[152:155], a[172:175], v[208:223]
  s_add_u32 s58, s58, 0x800
  s_and_b32 s58, s58, 0xffff
  buffer_load_dwordx4 v42, s[16:19], s48 offen offset:2048 lds
  v_mfma_f32_32x32x16_bf16 v[224:239], a[156:159], a[168:171], v[224:239]
  ds_read_b64_tr_b16 a[140:141], v31 offset:16384
  ds_read_b64_tr_b16 a[142:143], v31 offset:17408
  s_xor_b32 s58, s58, 64
  v_mfma_f32_32x32x16_bf16 v[240:255], a[156:159], a[172:175], v[240:255]
  buffer_load_dwordx4 v43, s[16:19], s48 offen offset:3072 lds
  s_add_u32 s48, s48, 0x20000
  s_and_b32 s48, s48, 0x3fffff
  v_xor_b32 v0, s58, v63
  s_waitcnt lgkmcnt(0)
  v_mfma_f32_32x32x16_bf16 v[128:143], a[128:131], a[160:163], v[128:143]
  s_waitcnt vmcnt(12)
  ds_read_b64_tr_b16 a[144:145], v28 offset:20480
  ds_read_b64_tr_b16 a[146:147], v28 offset:21504
  s_add_u32 m0, s47, 0x3000
  v_mfma_f32_32x32x16_bf16 v[144:159], a[128:131], a[164:167], v[144:159]
  ds_read_b128 a[168:171], v0
  ds_read_b128 a[172:175], v0 offset:1024
  buffer_load_dwordx4 v40, s[16:19], s48 offen lds
  v_mfma_f32_32x32x16_bf16 v[160:175], a[132:135], a[160:163], v[160:175]
  ds_read_b64_tr_b16 a[148:149], v29 offset:20480
  ds_read_b64_tr_b16 a[150:151], v29 offset:21504
  v_mfma_f32_32x32x16_bf16 v[176:191], a[132:135], a[164:167], v[176:191]
  buffer_load_dwordx4 v41, s[16:19], s48 offen offset:1024 lds
  v_mfma_f32_32x32x16_bf16 v[192:207], a[136:139], a[160:163], v[192:207]
  ds_read_b64_tr_b16 a[152:153], v30 offset:20480
  ds_read_b64_tr_b16 a[154:155], v30 offset:21504
  v_mfma_f32_32x32x16_bf16 v[208:223], a[136:139], a[164:167], v[208:223]
  s_add_u32 s58, s58, 0x800
  s_and_b32 s58, s58, 0xffff
  buffer_load_dwordx4 v42, s[16:19], s48 offen offset:2048 lds
  v_mfma_f32_32x32x16_bf16 v[224:239], a[140:143], a[160:163], v[224:239]
  ds_read_b64_tr_b16 a[156:157], v31 offset:20480
  ds_read_b64_tr_b16 a[158:159], v31 offset:21504
  s_xor_b32 s58, s58, 64
  v_mfma_f32_32x32x16_bf16 v[240:255], a[140:143], a[164:167], v[240:255]
  buffer_load_dwordx4 v43, s[16:19], s48 offen offset:3072 lds
  v_xor_b32 v0, s58, v63
  s_waitcnt lgkmcnt(0)
  v_mfma_f32_32x32x16_bf16 v[128:143], a[144:147], a[168:171], v[128:143]
  s_waitcnt vmcnt(12)
  ds_read_b64_tr_b16 a[128:129], v28
  ds_read_b64_tr_b16 a[130:131], v28 offset:1024
  s_mul_i32 s48, s62, 0x4000
  s_add_u32 m0, s47, 0x4000
  v_mfma_f32_32x32x16_bf16 v[144:159], a[144:147], a[172:175], v[144:159]
  ds_read_b128 a[160:163], v0
  ds_read_b128 a[164:167], v0 offset:1024
  buffer_load_dwordx4 v20, s[32:35], s48 offen lds
  v_mfma_f32_32x32x16_bf16 v[160:175], a[148:151], a[168:171], v[160:175]
  ds_read_b64_tr_b16 a[132:133], v29
  ds_read_b64_tr_b16 a[134:135], v29 offset:1024
  v_mfma_f32_32x32x16_bf16 v[176:191], a[148:151], a[172:175], v[176:191]
  buffer_load_dwordx4 v21, s[32:35], s48 offen offset:1024 lds
  v_mfma_f32_32x32x16_bf16 v[192:207], a[152:155], a[168:171], v[192:207]
  ds_read_b64_tr_b16 a[136:137], v30
  ds_read_b64_tr_b16 a[138:139], v30 offset:1024
  v_mfma_f32_32x32x16_bf16 v[208:223], a[152:155], a[172:175], v[208:223]
  s_add_u32 s58, s58, 0x800
  s_and_b32 s58, s58, 0xffff
  buffer_load_dwordx4 v22, s[32:35], s48 offen offset:2048 lds
  v_mfma_f32_32x32x16_bf16 v[224:239], a[156:159], a[168:171], v[224:239]
  ds_read_b64_tr_b16 a[140:141], v31
  ds_read_b64_tr_b16 a[142:143], v31 offset:1024
  s_xor_b32 s58, s58, 64
  v_mfma_f32_32x32x16_bf16 v[240:255], a[156:159], a[172:175], v[240:255]
  buffer_load_dwordx4 v23, s[32:35], s48 offen offset:3072 lds
  s_add_u32 s48, s48, 0x4000
  s_cmp_eq_u32 s48, 0x38000
  s_cselect_b32 s48, 0, s48
  v_xor_b32 v0, s58, v63
  s_waitcnt lgkmcnt(0)
  v_mfma_f32_32x32x16_bf16 v[128:143], a[128:131], a[160:163], v[128:143]
  s_waitcnt vmcnt(12)
  ds_read_b64_tr_b16 a[144:145], v28 offset:4096
  ds_read_b64_tr_b16 a[146:147], v28 offset:5120
  s_add_u32 m0, s47, 0x5000
  v_mfma_f32_32x32x16_bf16 v[144:159], a[128:131], a[164:167], v[144:159]
  ds_read_b128 a[168:171], v0
  ds_read_b128 a[172:175], v0 offset:1024
  buffer_load_dwordx4 v20, s[32:35], s48 offen lds
  v_mfma_f32_32x32x16_bf16 v[160:175], a[132:135], a[160:163], v[160:175]
  ds_read_b64_tr_b16 a[148:149], v29 offset:4096
  ds_read_b64_tr_b16 a[150:151], v29 offset:5120
  v_mfma_f32_32x32x16_bf16 v[176:191], a[132:135], a[164:167], v[176:191]
  buffer_load_dwordx4 v21, s[32:35], s48 offen offset:1024 lds
  v_mfma_f32_32x32x16_bf16 v[192:207], a[136:139], a[160:163], v[192:207]
  ds_read_b64_tr_b16 a[152:153], v30 offset:4096
  ds_read_b64_tr_b16 a[154:155], v30 offset:5120
  v_mfma_f32_32x32x16_bf16 v[208:223], a[136:139], a[164:167], v[208:223]
  s_add_u32 s58, s58, 0x800
  s_and_b32 s58, s58, 0xffff
  buffer_load_dwordx4 v22, s[32:35], s48 offen offset:2048 lds
  v_mfma_f32_32x32x16_bf16 v[224:239], a[140:143], a[160:163], v[224:239]
  ds_read_b64_tr_b16 a[156:157], v31 offset:4096
  ds_read_b64_tr_b16 a[158:159], v31 offset:5120
  s_xor_b32 s58, s58, 64
  v_mfma_f32_32x32x16_bf16 v[240:255], a[140:143], a[164:167], v[240:255]
  buffer_load_dwordx4 v23, s[32:35], s48 offen offset:3072 lds
  s_add_u32 s48, s48, 0x4000
  s_cmp_eq_u32 s48, 0x38000
  s_cselect_b32 s48, 0, s48
  v_xor_b32 v0, s58, v63
  s_waitcnt lgkmcnt(0)
  v_mfma_f32_32x32x16_bf16 v[128:143], a[144:147], a[168:171], v[128:143]
  s_waitcnt vmcnt(12)
  ds_read_b64_tr_b16 a[128:129], v28 offset:8192
  ds_read_b64_tr_b16 a[130:131], v28 offset:9216
  s_add_u32 m0, s47, 0
  v_mfma_f32_32x32x16_bf16 v[144:159], a[144:147], a[172:175], v[144:159]
  ds_read_b128 a[160:163], v0
  ds_read_b128 a[164:167], v0 offset:1024
  buffer_load_dwordx4 v20, s[32:35], s48 offen lds
  v_mfma_f32_32x32x16_bf16 v[160:175], a[148:151], a[168:171], v[160:175]
  ds_read_b64_tr_b16 a[132:133], v29 offset:8192
  ds_read_b64_tr_b16 a[134:135], v29 offset:9216
  v_mfma_f32_32x32x16_bf16 v[176:191], a[148:151], a[172:175], v[176:191]
  buffer_load_dwordx4 v21, s[32:35], s48 offen offset:1024 lds
  v_mfma_f32_32x32x16_bf16 v[192:207], a[152:155], a[168:171], v[192:207]
  ds_read_b64_tr_b16 a[136:137], v30 offset:8192
  ds_read_b64_tr_b16 a[138:139], v30 offset:9216
  v_mfma_f32_32x32x16_bf16 v[208:223], a[152:155], a[172:175], v[208:223]
  s_add_u32 s58, s58, 0x800
  s_and_b32 s58, s58, 0xffff
  buffer_load_dwordx4 v22, s[32:35], s48 offen offset:2048 lds
  v_mfma_f32_32x32x16_bf16 v[224:239], a[156:159], a[168:171], v[224:239]
  ds_read_b64_tr_b16 a[140:141], v31 offset:8192
  ds_read_b64_tr_b16 a[142:143], v31 offset:9216
  s_xor_b32 s58, s58, 64
  v_mfma_f32_32x32x16_bf16 v[240:255], a[156:159], a[172:175], v[240:255]
  buffer_load_dwordx4 v23, s[32:35], s48 offen offset:3072 lds
  s_add_u32 s48, s48, 0x4000
  s_cmp_eq_u32 s48, 0x38000
  s_cselect_b32 s48, 0, s48
  v_xor_b32 v0, s58, v63
  s_waitcnt lgkmcnt(0)
  v_mfma_f32_32x32x16_bf16 v[128:143], a[128:131], a[160:163], v[128:143]
  s_waitcnt vmcnt(12)
  ds_read_b64_tr_b16 a[144:145], v28 offset:12288
  ds_read_b64_tr_b16 a[146:147], v28 offset:13312
  s_add_u32 m0, s47, 0x1000
  v_mfma_f32_32x32x16_bf16 v[144:159], a[128:131], a[164:167], v[144:159]
  ds_read_b128 a[168:171], v0
  ds_read_b128 a[172:175], v0 offset:1024
  buffer_load_dwordx4 v20, s[32:35], s48 offen lds
  v_mfma_f32_32x32x16_bf16 v[160:175], a[132:135], a[160:163], v[160:175]
  ds_read_b64_tr_b16 a[148:149], v29 offset:12288
  ds_read_b64_tr_b16 a[150:151], v29 offset:13312
  v_mfma_f32_32x32x16_bf16 v[176:191], a[132:135], a[164:167], v[176:191]
  buffer_load_dwordx4 v21, s[32:35], s48 offen offset:1024 lds
  v_mfma_f32_32x32x16_bf16 v[192:207], a[136:139], a[160:163], v[192:207]
  ds_read_b64_tr_b16 a[152:153], v30 offset:12288
  ds_read_b64_tr_b16 a[154:155], v30 offset:13312
  v_mfma_f32_32x32x16_bf16 v[208:223], a[136:139], a[164:167], v[208:223]
  buffer_load_dwordx4 v22, s[32:35], s48 offen offset:2048 lds
  v_mfma_f32_32x32x16_bf16 v[224:239], a[140:143], a[160:163], v[224:239]
  ds_read_b64_tr_b16 a[156:157], v31 offset:12288
  ds_read_b64_tr_b16 a[158:159], v31 offset:13312
  v_mfma_f32_32x32x16_bf16 v[240:255], a[140:143], a[164:167], v[240:255]
  buffer_load_dwordx4 v23, s[32:35], s48 offen offset:3072 lds
  s_add_u32 s48, s48, 0x4000
  s_cmp_eq_u32 s48, 0x38000
  s_cselect_b32 s48, 0, s48
  s_waitcnt lgkmcnt(0)
  v_mfma_f32_32x32x16_bf16 v[128:143], a[144:147], a[168:171], v[128:143]
  s_barrier
  s_add_u32 m0, s47, 0x2000
  v_mfma_f32_32x32x16_bf16 v[144:159], a[144:147], a[172:175], v[144:159]
  buffer_load_dwordx4 v20, s[32:35], s48 offen lds
  ds_write_b128 v44, v[64:67]
  ds_write_b128 v44, v[68:71] offset:1024
  v_mfma_f32_32x32x16_bf16 v[160:175], a[148:151], a[168:171], v[160:175]
  ds_write_b128 v44, v[72:75] offset:2048
  v_mfma_f32_32x32x16_bf16 v[176:191], a[148:151], a[172:175], v[176:191]
  buffer_load_dwordx4 v21, s[32:35], s48 offen offset:1024 lds
  ds_write_b128 v44, v[76:79] offset:3072
  v_mfma_f32_32x32x16_bf16 v[192:207], a[152:155], a[168:171], v[192:207]
  ds_write_b128 v45, v[80:83]
  v_mfma_f32_32x32x16_bf16 v[208:223], a[152:155], a[172:175], v[208:223]
  buffer_load_dwordx4 v22, s[32:35], s48 offen offset:2048 lds
  ds_write_b128 v45, v[84:87] offset:1024
  v_mfma_f32_32x32x16_bf16 v[224:239], a[156:159], a[168:171], v[224:239]
  ds_write_b128 v45, v[88:91] offset:2048
  v_mfma_f32_32x32x16_bf16 v[240:255], a[156:159], a[172:175], v[240:255]
  buffer_load_dwordx4 v23, s[32:35], s48 offen offset:3072 lds
  s_add_u32 s48, s48, 0x4000
  s_cmp_eq_u32 s48, 0x38000
  s_cselect_b32 s48, 0, s48
  ds_write_b128 v45, v[92:95] offset:3072
  s_lshl_b32 s55, s46, 11
  s_lshr_b32 s56, s100, 1
  s_lshl_b32 s56, s56, 13
  s_add_u32 s56, s56, s55
  s_mov_b32 s57, s56
  s_waitcnt lgkmcnt(0)
  s_barrier
  v_cvt_pk_bf16_f32 v64, v128, v129
  v_cvt_pk_bf16_f32 v65, v130, v131
  v_cvt_pk_bf16_f32 v66, v132, v133
  v_cvt_pk_bf16_f32 v67, v134, v135
  v_cvt_pk_bf16_f32 v96, v144, v145
  v_cvt_pk_bf16_f32 v97, v146, v147
  v_cvt_pk_bf16_f32 v98, v148, v149
  v_cvt_pk_bf16_f32 v99, v150, v151
  v_cvt_pk_bf16_f32 v68, v136, v137
  v_cvt_pk_bf16_f32 v69, v138, v139
  v_cvt_pk_bf16_f32 v70, v140, v141
  v_cvt_pk_bf16_f32 v71, v142, v143
  v_cvt_pk_bf16_f32 v100, v152, v153
  v_cvt_pk_bf16_f32 v101, v154, v155
  v_cvt_pk_bf16_f32 v102, v156, v157
  v_cvt_pk_bf16_f32 v103, v158, v159
  v_cvt_pk_bf16_f32 v72, v160, v161
  v_cvt_pk_bf16_f32 v73, v162, v163
  v_cvt_pk_bf16_f32 v74, v164, v165
  v_cvt_pk_bf16_f32 v75, v166, v167
  v_cvt_pk_bf16_f32 v104, v176, v177
  v_cvt_pk_bf16_f32 v105, v178, v179
  v_cvt_pk_bf16_f32 v106, v180, v181
  v_cvt_pk_bf16_f32 v107, v182, v183
  v_cvt_pk_bf16_f32 v76, v168, v169
  v_cvt_pk_bf16_f32 v77, v170, v171
  v_cvt_pk_bf16_f32 v78, v172, v173
  v_cvt_pk_bf16_f32 v79, v174, v175
  v_cvt_pk_bf16_f32 v108, v184, v185
  v_cvt_pk_bf16_f32 v109, v186, v187
  v_cvt_pk_bf16_f32 v110, v188, v189
  v_cvt_pk_bf16_f32 v111, v190, v191
  v_cvt_pk_bf16_f32 v80, v192, v193
  v_cvt_pk_bf16_f32 v81, v194, v195
  v_cvt_pk_bf16_f32 v82, v196, v197
  v_cvt_pk_bf16_f32 v83, v198, v199
  v_cvt_pk_bf16_f32 v112, v208, v209
  v_cvt_pk_bf16_f32 v113, v210, v211
  v_cvt_pk_bf16_f32 v114, v212, v213
  v_cvt_pk_bf16_f32 v115, v214, v215
  v_cvt_pk_bf16_f32 v84, v200, v201
  v_cvt_pk_bf16_f32 v85, v202, v203
  v_cvt_pk_bf16_f32 v86, v204, v205
  v_cvt_pk_bf16_f32 v87, v206, v207
  v_cvt_pk_bf16_f32 v116, v216, v217
  v_cvt_pk_bf16_f32 v117, v218, v219
  v_cvt_pk_bf16_f32 v118, v220, v221
  v_cvt_pk_bf16_f32 v119, v222, v223
  v_cvt_pk_bf16_f32 v88, v224, v225
  v_cvt_pk_bf16_f32 v89, v226, v227
  v_cvt_pk_bf16_f32 v90, v228, v229
  v_cvt_pk_bf16_f32 v91, v230, v231
  v_cvt_pk_bf16_f32 v120, v240, v241
  v_cvt_pk_bf16_f32 v121, v242, v243
  v_cvt_pk_bf16_f32 v122, v244, v245
  v_cvt_pk_bf16_f32 v123, v246, v247
  v_cvt_pk_bf16_f32 v92, v232, v233
  v_cvt_pk_bf16_f32 v93, v234, v235
  v_cvt_pk_bf16_f32 v94, v236, v237
  v_cvt_pk_bf16_f32 v95, v238, v239
  v_cvt_pk_bf16_f32 v124, v248, v249
  v_cvt_pk_bf16_f32 v125, v250, v251
  v_cvt_pk_bf16_f32 v126, v252, v253
  v_cvt_pk_bf16_f32 v127, v254, v255
  s_lshl_b32 s58, s62, 11
  v_add_u32 v0, s58, v3
  s_waitcnt vmcnt(16)
  ds_read_b64_tr_b16 a[128:129], v4 offset:16384
  ds_read_b64_tr_b16 a[130:131], v4 offset:18432
  ds_read_b128 a[160:163], v0
  ds_read_b128 a[164:167], v0 offset:1024
  ds_read_b64_tr_b16 a[132:133], v5 offset:16384
  ds_read_b64_tr_b16 a[134:135], v5 offset:18432
  ds_read_b64_tr_b16 a[136:137], v6 offset:16384
  ds_read_b64_tr_b16 a[138:139], v6 offset:18432
  ds_read_b64_tr_b16 a[140:141], v7 offset:16384
  ds_read_b64_tr_b16 a[142:143], v7 offset:18432
  s_add_u32 s58, s58, 0x800
  s_cmp_eq_u32 s58, 0x7000
  s_cselect_b32 s58, 0, s58
  v_add_u32 v0, s58, v3
  s_waitcnt lgkmcnt(0)
  v_mfma_f32_32x32x16_bf16 v[128:143], a[128:131], a[160:163], 0
  s_waitcnt vmcnt(12)
  ds_read_b64_tr_b16 a[144:145], v4 offset:20480
  ds_read_b64_tr_b16 a[146:147], v4 offset:22528
  s_add_u32 m0, s47, 0x3000
  s_nop 0
  buffer_load_dwordx4 v20, s[32:35], s48 offen lds
  v_mfma_f32_32x32x16_bf16 v[144:159], a[128:131], a[164:167], 0
  ds_read_b128 a[168:171], v0
  ds_read_b128 a[172:175], v0 offset:1024
  buffer_load_dwordx4 v21, s[32:35], s48 offen offset:1024 lds
  v_mfma_f32_32x32x16_bf16 v[160:175], a[132:135], a[160:163], 0
  ds_read_b64_tr_b16 a[148:149], v5 offset:20480
  ds_read_b64_tr_b16 a[150:151], v5 offset:22528
  buffer_load_dwordx4 v22, s[32:35], s48 offen offset:2048 lds
  v_mfma_f32_32x32x16_bf16 v[176:191], a[132:135], a[164:167], 0
  buffer_load_dwordx4 v23, s[32:35], s48 offen offset:3072 lds
  s_add_u32 s48, s48, 0x4000
  s_cmp_eq_u32 s48, 0x38000
  s_cselect_b32 s48, 0, s48
  s_add_u32 m0, s55, 0x8000
  v_mfma_f32_32x32x16_bf16 v[192:207], a[136:139], a[160:163], 0
  ds_read_b64_tr_b16 a[152:153], v6 offset:20480
  ds_read_b64_tr_b16 a[154:155], v6 offset:22528
  buffer_load_dwordx4 v24, s[8:11], s56 offen lds
  v_mfma_f32_32x32x16_bf16 v[208:223], a[136:139], a[164:167], 0
  s_add_u32 s58, s58, 0x800
  s_cmp_eq_u32 s58, 0x7000
  s_cselect_b32 s58, 0, s58
  buffer_load_dwordx4 v25, s[8:11], s56 offen offset:1024 lds
  v_mfma_f32_32x32x16_bf16 v[224:239], a[140:143], a[160:163], 0
  ds_read_b64_tr_b16 a[156:157], v7 offset:20480
  ds_read_b64_tr_b16 a[158:159], v7 offset:22528
  v_mfma_f32_32x32x16_bf16 v[240:255], a[140:143], a[164:167], 0
  s_add_u32 s56, s56, 0x2000
  s_and_b32 s56, s56, 0x1ffff
  v_add_u32 v0, s58, v3
  s_waitcnt lgkmcnt(0)
  v_mfma_f32_32x32x16_bf16 v[128:143], a[144:147], a[168:171], v[128:143]
  s_waitcnt vmcnt(14)
  ds_read_b64_tr_b16 a[128:129], v4
  ds_read_b64_tr_b16 a[130:131], v4 offset:2048
  s_add_u32 m0, s47, 0x4000
  s_nop 0
  buffer_load_dwordx4 v20, s[32:35], s48 offen lds
  v_mfma_f32_32x32x16_bf16 v[144:159], a[144:147], a[172:175], v[144:159]
  ds_read_b128 a[160:163], v0
  ds_read_b128 a[164:167], v0 offset:1024
  buffer_load_dwordx4 v21, s[32:35], s48 offen offset:1024 lds
  v_mfma_f32_32x32x16_bf16 v[160:175], a[148:151], a[168:171], v[160:175]
  ds_read_b64_tr_b16 a[132:133], v5
  ds_read_b64_tr_b16 a[134:135], v5 offset:2048
  buffer_load_dwordx4 v22, s[32:35], s48 offen offset:2048 lds
  v_mfma_f32_32x32x16_bf16 v[176:191], a[148:151], a[172:175], v[176:191]
  buffer_load_dwordx4 v23, s[32:35], s48 offen offset:3072 lds
  s_add_u32 s48, s48, 0x4000
  s_cmp_eq_u32 s48, 0x38000
  s_cselect_b32 s48, 0, s48
  s_add_u32 m0, s55, 0xa000
  v_mfma_f32_32x32x16_bf16 v[192:207], a[152:155], a[168:171], v[192:207]
  ds_read_b64_tr_b16 a[136:137], v6
  ds_read_b64_tr_b16 a[138:139], v6 offset:2048
  buffer_load_dwordx4 v26, s[12:15], s57 offen lds
  v_mfma_f32_32x32x16_bf16 v[208:223], a[152:155], a[172:175], v[208:223]
  s_add_u32 s58, s58, 0x800
  s_cmp_eq_u32 s58, 0x7000
  s_cselect_b32 s58, 0, s58
  buffer_load_dwordx4 v26, s[12:15], s57 offen offset:1024 lds
  v_mfma_f32_32x32x16_bf16 v[224:239], a[156:159], a[168:171], v[224:239]
  ds_read_b64_tr_b16 a[140:141], v7
  ds_read_b64_tr_b16 a[142:143], v7 offset:2048
  v_mfma_f32_32x32x16_bf16 v[240:255], a[156:159], a[172:175], v[240:255]
  s_add_u32 s57, s57, 0x2000
  s_and_b32 s57, s57, 0x1ffff
  v_add_u32 v0, s58, v3
  s_waitcnt lgkmcnt(0)
  v_mfma_f32_32x32x16_bf16 v[128:143], a[128:131], a[160:163], v[128:143]
  s_waitcnt vmcnt(16)
  ds_read_b64_tr_b16 a[144:145], v4 offset:4096
  ds_read_b64_tr_b16 a[146:147], v4 offset:6144
  s_add_u32 m0, s47, 0x5000
  s_nop 0
  buffer_load_dwordx4 v20, s[32:35], s48 offen lds
  v_mfma_f32_32x32x16_bf16 v[144:159], a[128:131], a[164:167], v[144:159]
  ds_read_b128 a[168:171], v0
  ds_read_b128 a[172:175], v0 offset:1024
  buffer_load_dwordx4 v21, s[32:35], s48 offen offset:1024 lds
  v_mfma_f32_32x32x16_bf16 v[160:175], a[132:135], a[160:163], v[160:175]
  ds_read_b64_tr_b16 a[148:149], v5 offset:4096
  ds_read_b64_tr_b16 a[150:151], v5 offset:6144
  buffer_load_dwordx4 v22, s[32:35], s48 offen offset:2048 lds
  v_mfma_f32_32x32x16_bf16 v[176:191], a[132:135], a[164:167], v[176:191]
  buffer_load_dwordx4 v23, s[32:35], s48 offen offset:3072 lds
  s_add_u32 s48, s48, 0x4000
  s_cmp_eq_u32 s48, 0x38000
  s_cselect_b32 s48, 0, s48
  s_add_u32 m0, s55, 0xc000
  v_mfma_f32_32x32x16_bf16 v[192:207], a[136:139], a[160:163], v[192:207]
  ds_read_b64_tr_b16 a[152:153], v6 offset:4096
  ds_read_b64_tr_b16 a[154:155], v6 offset:6144
  buffer_load_dwordx4 v24, s[8:11], s56 offen lds
  v_mfma_f32_32x32x16_bf16 v[208:223], a[136:139], a[164:167], v[208:223]
  s_add_u32 s58, s58, 0x800
  s_cmp_eq_u32 s58, 0x7000
  s_cselect_b32 s58, 0, s58
  buffer_load_dwordx4 v25, s[8:11], s56 offen offset:1024 lds
  v_mfma_f32_32x32x16_bf16 v[224:239], a[140:143], a[160:163], v[224:239]
  ds_read_b64_tr_b16 a[156:157], v7 offset:4096
  ds_read_b64_tr_b16 a[158:159], v7 offset:6144
  v_mfma_f32_32x32x16_bf16 v[240:255], a[140:143], a[164:167], v[240:255]
  s_add_u32 s56, s56, 0x2000
  s_and_b32 s56, s56, 0x1ffff
  v_add_u32 v0, s58, v3
  s_waitcnt lgkmcnt(0)
  v_mfma_f32_32x32x16_bf16 v[128:143], a[144:147], a[168:171], v[128:143]
  s_waitcnt vmcnt(18)
  ds_read_b64_tr_b16 a[128:129], v4 offset:8192
  ds_read_b64_tr_b16 a[130:131], v4 offset:10240
  s_add_u32 m0, s47, 0
  s_nop 0
  buffer_load_dwordx4 v20, s[32:35], s48 offen lds
  v_mfma_f32_32x32x16_bf16 v[144:159], a[144:147], a[172:175], v[144:159]
  ds_read_b128 a[160:163], v0
  ds_read_b128 a[164:167], v0 offset:1024
  buffer_load_dwordx4 v21, s[32:35], s48 offen offset:1024 lds
  v_mfma_f32_32x32x16_bf16 v[160:175], a[148:151], a[168:171], v[160:175]
  ds_read_b64_tr_b16 a[132:133], v5 offset:8192
  ds_read_b64_tr_b16 a[134:135], v5 offset:10240
  buffer_load_dwordx4 v22, s[32:35], s48 offen offset:2048 lds
  v_mfma_f32_32x32x16_bf16 v[176:191], a[148:151], a[172:175], v[176:191]
  buffer_load_dwordx4 v23, s[32:35], s48 offen offset:3072 lds
  s_add_u32 s48, s48, 0x4000
  s_cmp_eq_u32 s48, 0x38000
  s_cselect_b32 s48, 0, s48
  s_add_u32 m0, s55, 0xe000
  v_mfma_f32_32x32x16_bf16 v[192:207], a[152:155], a[168:171], v[192:207]
  ds_read_b64_tr_b16 a[136:137], v6 offset:8192
  ds_read_b64_tr_b16 a[138:139], v6 offset:10240
  buffer_load_dwordx4 v26, s[12:15], s57 offen lds
  v_mfma_f32_32x32x16_bf16 v[208:223], a[152:155], a[172:175], v[208:223]
  s_add_u32 s58, s58, 0x800
  s_cmp_eq_u32 s58, 0x7000
  s_cselect_b32 s58, 0, s58
  buffer_load_dwordx4 v26, s[12:15], s57 offen offset:1024 lds
  v_mfma_f32_32x32x16_bf16 v[224:239], a[156:159], a[168:171], v[224:239]
  ds_read_b64_tr_b16 a[140:141], v7 offset:8192
  ds_read_b64_tr_b16 a[142:143], v7 offset:10240
  v_mfma_f32_32x32x16_bf16 v[240:255], a[156:159], a[172:175], v[240:255]
  s_add_u32 s57, s57, 0x2000
  s_and_b32 s57, s57, 0x1ffff
  v_add_u32 v0, s58, v3
  s_waitcnt lgkmcnt(0)
  v_mfma_f32_32x32x16_bf16 v[128:143], a[128:131], a[160:163], v[128:143]
  s_waitcnt vmcnt(20)
  ds_read_b64_tr_b16 a[144:145], v4 offset:12288
  ds_read_b64_tr_b16 a[146:147], v4 offset:14336
  s_add_u32 m0, s47, 0x1000
  v_mfma_f32_32x32x16_bf16 v[144:159], a[128:131], a[164:167], v[144:159]
  ds_read_b128 a[168:171], v0
  ds_read_b128 a[172:175], v0 offset:1024
  buffer_load_dwordx4 v20, s[32:35], s48 offen lds
  v_mfma_f32_32x32x16_bf16 v[160:175], a[132:135], a[160:163], v[160:175]
  ds_read_b64_tr_b16 a[148:149], v5 offset:12288
  ds_read_b64_tr_b16 a[150:151], v5 offset:14336
  v_mfma_f32_32x32x16_bf16 v[176:191], a[132:135], a[164:167], v[176:191]
  buffer_load_dwordx4 v21, s[32:35], s48 offen offset:1024 lds
  v_mfma_f32_32x32x16_bf16 v[192:207], a[136:139], a[160:163], v[192:207]
  ds_read_b64_tr_b16 a[152:153], v6 offset:12288
  ds_read_b64_tr_b16 a[154:155], v6 offset:14336
  v_mfma_f32_32x32x16_bf16 v[208:223], a[136:139], a[164:167], v[208:223]
  s_add_u32 s58, s58, 0x800
  s_cmp_eq_u32 s58, 0x7000
  s_cselect_b32 s58, 0, s58
  buffer_load_dwordx4 v22, s[32:35], s48 offen offset:2048 lds
  v_mfma_f32_32x32x16_bf16 v[224:239], a[140:143], a[160:163], v[224:239]
  ds_read_b64_tr_b16 a[156:157], v7 offset:12288
  ds_read_b64_tr_b16 a[158:159], v7 offset:14336
  v_mfma_f32_32x32x16_bf16 v[240:255], a[140:143], a[164:167], v[240:255]
  buffer_load_dwordx4 v23, s[32:35], s48 offen offset:3072 lds
  s_add_u32 s48, s48, 0x4000
  s_cmp_eq_u32 s48, 0x38000
  s_cselect_b32 s48, 0, s48
  v_add_u32 v0, s58, v3
  s_waitcnt lgkmcnt(0)
  v_mfma_f32_32x32x16_bf16 v[128:143], a[144:147], a[168:171], v[128:143]
  s_waitcnt vmcnt(18)
  ds_read_b64_tr_b16 a[128:129], v4 offset:16384
  ds_read_b64_tr_b16 a[130:131], v4 offset:18432
  s_add_u32 m0, s47, 0x2000
  v_mfma_f32_32x32x16_bf16 v[144:159], a[144:147], a[172:175], v[144:159]
  ds_read_b128 a[160:163], v0
  ds_read_b128 a[164:167], v0 offset:1024
  buffer_load_dwordx4 v20, s[32:35], s48 offen lds
  v_mfma_f32_32x32x16_bf16 v[160:175], a[148:151], a[168:171], v[160:175]
  ds_read_b64_tr_b16 a[132:133], v5 offset:16384
  ds_read_b64_tr_b16 a[134:135], v5 offset:18432
  v_mfma_f32_32x32x16_bf16 v[176:191], a[148:151], a[172:175], v[176:191]
  buffer_load_dwordx4 v21, s[32:35], s48 offen offset:1024 lds
  v_mfma_f32_32x32x16_bf16 v[192:207], a[152:155], a[168:171], v[192:207]
  ds_read_b64_tr_b16 a[136:137], v6 offset:16384
  ds_read_b64_tr_b16 a[138:139], v6 offset:18432
  v_mfma_f32_32x32x16_bf16 v[208:223], a[152:155], a[172:175], v[208:223]
  s_add_u32 s58, s58, 0x800
  s_cmp_eq_u32 s58, 0x7000
  s_cselect_b32 s58, 0, s58
  buffer_load_dwordx4 v22, s[32:35], s48 offen offset:2048 lds
  v_mfma_f32_32x32x16_bf16 v[224:239], a[156:159], a[168:171], v[224:239]
  ds_read_b64_tr_b16 a[140:141], v7 offset:16384
  ds_read_b64_tr_b16 a[142:143], v7 offset:18432
  v_mfma_f32_32x32x16_bf16 v[240:255], a[156:159], a[172:175], v[240:255]
  buffer_load_dwordx4 v23, s[32:35], s48 offen offset:3072 lds
  s_add_u32 s48, s48, 0x4000
  s_cmp_eq_u32 s48, 0x38000
  s_cselect_b32 s48, 0, s48
  v_add_u32 v0, s58, v3
  s_waitcnt lgkmcnt(0)
  v_mfma_f32_32x32x16_bf16 v[128:143], a[128:131], a[160:163], v[128:143]
  s_waitcnt vmcnt(16)
  ds_read_b64_tr_b16 a[144:145], v4 offset:20480
  ds_read_b64_tr_b16 a[146:147], v4 offset:22528
  s_add_u32 m0, s47, 0x3000
  v_mfma_f32_32x32x16_bf16 v[144:159], a[128:131], a[164:167], v[144:159]
  ds_read_b128 a[168:171], v0
  ds_read_b128 a[172:175], v0 offset:1024
  buffer_load_dwordx4 v20, s[32:35], s48 offen lds
  v_mfma_f32_32x32x16_bf16 v[160:175], a[132:135], a[160:163], v[160:175]
  ds_read_b64_tr_b16 a[148:149], v5 offset:20480
  ds_read_b64_tr_b16 a[150:151], v5 offset:22528
  v_mfma_f32_32x32x16_bf16 v[176:191], a[132:135], a[164:167], v[176:191]
  buffer_load_dwordx4 v21, s[32:35], s48 offen offset:1024 lds
  v_mfma_f32_32x32x16_bf16 v[192:207], a[136:139], a[160:163], v[192:207]
  ds_read_b64_tr_b16 a[152:153], v6 offset:20480
  ds_read_b64_tr_b16 a[154:155], v6 offset:22528
  v_mfma_f32_32x32x16_bf16 v[208:223], a[136:139], a[164:167], v[208:223]
  s_add_u32 s58, s58, 0x800
  s_cmp_eq_u32 s58, 0x7000
  s_cselect_b32 s58, 0, s58
  buffer_load_dwordx4 v22, s[32:35], s48 offen offset:2048 lds
  v_mfma_f32_32x32x16_bf16 v[224:239], a[140:143], a[160:163], v[224:239]
  ds_read_b64_tr_b16 a[156:157], v7 offset:20480
  ds_read_b64_tr_b16 a[158:159], v7 offset:22528
  v_mfma_f32_32x32x16_bf16 v[240:255], a[140:143], a[164:167], v[240:255]
  buffer_load_dwordx4 v23, s[32:35], s48 offen offset:3072 lds
  s_add_u32 s48, s48, 0x4000
  s_cmp_eq_u32 s48, 0x38000
  s_cselect_b32 s48, 0, s48
  v_add_u32 v0, s58, v3
  s_waitcnt lgkmcnt(0)
  v_mfma_f32_32x32x16_bf16 v[128:143], a[144:147], a[168:171], v[128:143]
  s_waitcnt vmcnt(14)
  ds_read_b64_tr_b16 a[128:129], v4
  ds_read_b64_tr_b16 a[130:131], v4 offset:2048
  s_add_u32 m0, s47, 0x4000
  v_mfma_f32_32x32x16_bf16 v[144:159], a[144:147], a[172:175], v[144:159]
  ds_read_b128 a[160:163], v0
  ds_read_b128 a[164:167], v0 offset:1024
  buffer_load_dwordx4 v20, s[32:35], s48 offen lds
  v_mfma_f32_32x32x16_bf16 v[160:175], a[148:151], a[168:171], v[160:175]
  ds_read_b64_tr_b16 a[132:133], v5
  ds_read_b64_tr_b16 a[134:135], v5 offset:2048
  v_mfma_f32_32x32x16_bf16 v[176:191], a[148:151], a[172:175], v[176:191]
  buffer_load_dwordx4 v21, s[32:35], s48 offen offset:1024 lds
  v_mfma_f32_32x32x16_bf16 v[192:207], a[152:155], a[168:171], v[192:207]
  ds_read_b64_tr_b16 a[136:137], v6
  ds_read_b64_tr_b16 a[138:139], v6 offset:2048
  v_mfma_f32_32x32x16_bf16 v[208:223], a[152:155], a[172:175], v[208:223]
  s_add_u32 s58, s58, 0x800
  s_cmp_eq_u32 s58, 0x7000
  s_cselect_b32 s58, 0, s58
  buffer_load_dwordx4 v22, s[32:35], s48 offen offset:2048 lds
  v_mfma_f32_32x32x16_bf16 v[224:239], a[156:159], a[168:171], v[224:239]
  ds_read_b64_tr_b16 a[140:141], v7
  ds_read_b64_tr_b16 a[142:143], v7 offset:2048
  v_mfma_f32_32x32x16_bf16 v[240:255], a[156:159], a[172:175], v[240:255]
  buffer_load_dwordx4 v23, s[32:35], s48 offen offset:3072 lds
  s_add_u32 s48, s48, 0x4000
  s_cmp_eq_u32 s48, 0x38000
  s_cselect_b32 s48, 0, s48
  v_add_u32 v0, s58, v3
  s_waitcnt lgkmcnt(0)
  v_mfma_f32_32x32x16_bf16 v[128:143], a[128:131], a[160:163], v[128:143]
  s_waitcnt vmcnt(12)
  ds_read_b64_tr_b16 a[144:145], v4 offset:4096
  ds_read_b64_tr_b16 a[146:147], v4 offset:6144
  s_add_u32 m0, s47, 0x5000
  v_mfma_f32_32x32x16_bf16 v[144:159], a[128:131], a[164:167], v[144:159]
  ds_read_b128 a[168:171], v0
  ds_read_b128 a[172:175], v0 offset:1024
  buffer_load_dwordx4 v20, s[32:35], s48 offen lds
  v_mfma_f32_32x32x16_bf16 v[160:175], a[132:135], a[160:163], v[160:175]
  ds_read_b64_tr_b16 a[148:149], v5 offset:4096
  ds_read_b64_tr_b16 a[150:151], v5 offset:6144
  v_mfma_f32_32x32x16_bf16 v[176:191], a[132:135], a[164:167], v[176:191]
  buffer_load_dwordx4 v21, s[32:35], s48 offen offset:1024 lds
  v_mfma_f32_32x32x16_bf16 v[192:207], a[136:139], a[160:163], v[192:207]
  ds_read_b64_tr_b16 a[152:153], v6 offset:4096
  ds_read_b64_tr_b16 a[154:155], v6 offset:6144
  v_mfma_f32_32x32x16_bf16 v[208:223], a[136:139], a[164:167], v[208:223]
  s_add_u32 s58, s58, 0x800
  s_cmp_eq_u32 s58, 0x7000
  s_cselect_b32 s58, 0, s58
  buffer_load_dwordx4 v22, s[32:35], s48 offen offset:2048 lds
  v_mfma_f32_32x32x16_bf16 v[224:239], a[140:143], a[160:163], v[224:239]
  ds_read_b64_tr_b16 a[156:157], v7 offset:4096
  ds_read_b64_tr_b16 a[158:159], v7 offset:6144
  v_mfma_f32_32x32x16_bf16 v[240:255], a[140:143], a[164:167], v[240:255]
  buffer_load_dwordx4 v23, s[32:35], s48 offen offset:3072 lds
  v_add_u32 v0, s58, v3
  s_waitcnt lgkmcnt(0)
  v_mfma_f32_32x32x16_bf16 v[128:143], a[144:147], a[168:171], v[128:143]
  s_waitcnt vmcnt(12)
  ds_read_b64_tr_b16 a[128:129], v4 offset:8192
  ds_read_b64_tr_b16 a[130:131], v4 offset:10240
  v_mfma_f32_32x32x16_bf16 v[144:159], a[144:147], a[172:175], v[144:159]
  ds_read_b128 a[160:163], v0
  ds_read_b128 a[164:167], v0 offset:1024
  v_mfma_f32_32x32x16_bf16 v[160:175], a[148:151], a[168:171], v[160:175]
  ds_read_b64_tr_b16 a[132:133], v5 offset:8192
  ds_read_b64_tr_b16 a[134:135], v5 offset:10240
  v_mfma_f32_32x32x16_bf16 v[176:191], a[148:151], a[172:175], v[176:191]
  v_mfma_f32_32x32x16_bf16 v[192:207], a[152:155], a[168:171], v[192:207]
  ds_read_b64_tr_b16 a[136:137], v6 offset:8192
  ds_read_b64_tr_b16 a[138:139], v6 offset:10240
  v_mfma_f32_32x32x16_bf16 v[208:223], a[152:155], a[172:175], v[208:223]
  s_add_u32 s58, s58, 0x800
  s_cmp_eq_u32 s58, 0x7000
  s_cselect_b32 s58, 0, s58
  v_mfma_f32_32x32x16_bf16 v[224:239], a[156:159], a[168:171], v[224:239]
  ds_read_b64_tr_b16 a[140:141], v7 offset:8192
  ds_read_b64_tr_b16 a[142:143], v7 offset:10240
  v_mfma_f32_32x32x16_bf16 v[240:255], a[156:159], a[172:175], v[240:255]
  v_add_u32 v0, s58, v3
  s_waitcnt lgkmcnt(0)
  v_mfma_f32_32x32x16_bf16 v[128:143], a[128:131], a[160:163], v[128:143]
  s_barrier
  s_waitcnt vmcnt(8)
  ds_read_b64_tr_b16 a[144:145], v4 offset:12288
  ds_read_b64_tr_b16 a[146:147], v4 offset:14336
  v_mfma_f32_32x32x16_bf16 v[144:159], a[128:131], a[164:167], v[144:159]
  ds_read_b128 a[168:171], v0
  ds_read_b128 a[172:175], v0 offset:1024
  v_mfma_f32_32x32x16_bf16 v[160:175], a[132:135], a[160:163], v[160:175]
  ds_read_b64_tr_b16 a[148:149], v5 offset:12288
  ds_read_b64_tr_b16 a[150:151], v5 offset:14336
  v_mfma_f32_32x32x16_bf16 v[176:191], a[132:135], a[164:167], v[176:191]
  v_mfma_f32_32x32x16_bf16 v[192:207], a[136:139], a[160:163], v[192:207]
  ds_read_b64_tr_b16 a[152:153], v6 offset:12288
  ds_read_b64_tr_b16 a[154:155], v6 offset:14336
  v_mfma_f32_32x32x16_bf16 v[208:223], a[136:139], a[164:167], v[208:223]
  s_add_u32 s58, s58, 0x800
  s_cmp_eq_u32 s58, 0x7000
  s_cselect_b32 s58, 0, s58
  v_mfma_f32_32x32x16_bf16 v[224:239], a[140:143], a[160:163], v[224:239]
  ds_read_b64_tr_b16 a[156:157], v7 offset:12288
  ds_read_b64_tr_b16 a[158:159], v7 offset:14336
  v_mfma_f32_32x32x16_bf16 v[240:255], a[140:143], a[164:167], v[240:255]
  v_add_u32 v0, s58, v3
  s_waitcnt lgkmcnt(0)
  v_mfma_f32_32x32x16_bf16 v[128:143], a[144:147], a[168:171], v[128:143]
  s_waitcnt vmcnt(4)
  ds_read_b64_tr_b16 a[128:129], v4 offset:16384
  ds_read_b64_tr_b16 a[130:131], v4 offset:18432
  v_mfma_f32_32x32x16_bf16 v[144:159], a[144:147], a[172:175], v[144:159]
  ds_read_b128 a[160:163], v0
  ds_read_b128 a[164:167], v0 offset:1024
  v_mfma_f32_32x32x16_bf16 v[160:175], a[148:151], a[168:171], v[160:175]
  ds_read_b64_tr_b16 a[132:133], v5 offset:16384
  ds_read_b64_tr_b16 a[134:135], v5 offset:18432
  v_mfma_f32_32x32x16_bf16 v[176:191], a[148:151], a[172:175], v[176:191]
  v_mfma_f32_32x32x16_bf16 v[192:207], a[152:155], a[168:171], v[192:207]
  ds_read_b64_tr_b16 a[136:137], v6 offset:16384
  ds_read_b64_tr_b16 a[138:139], v6 offset:18432
  v_mfma_f32_32x32x16_bf16 v[208:223], a[152:155], a[172:175], v[208:223]
  s_add_u32 s58, s58, 0x800
  s_cmp_eq_u32 s58, 0x7000
  s_cselect_b32 s58, 0, s58
  v_mfma_f32_32x32x16_bf16 v[224:239], a[156:159], a[168:171], v[224:239]
  ds_read_b64_tr_b16 a[140:141], v7 offset:16384
  ds_read_b64_tr_b16 a[142:143], v7 offset:18432
  v_mfma_f32_32x32x16_bf16 v[240:255], a[156:159], a[172:175], v[240:255]
  v_add_u32 v0, s58, v3
  s_waitcnt lgkmcnt(0)
  v_mfma_f32_32x32x16_bf16 v[128:143], a[128:131], a[160:163], v[128:143]
  s_waitcnt vmcnt(0)
  ds_read_b64_tr_b16 a[144:145], v4 offset:20480
  ds_read_b64_tr_b16 a[146:147], v4 offset:22528
  v_mfma_f32_32x32x16_bf16 v[144:159], a[128:131], a[164:167], v[144:159]
  ds_read_b128 a[168:171], v0
  ds_read_b128 a[172:175], v0 offset:1024
  v_mfma_f32_32x32x16_bf16 v[160:175], a[132:135], a[160:163], v[160:175]
  ds_read_b64_tr_b16 a[148:149], v5 offset:20480
  ds_read_b64_tr_b16 a[150:151], v5 offset:22528
  v_mfma_f32_32x32x16_bf16 v[176:191], a[132:135], a[164:167], v[176:191]
  v_mfma_f32_32x32x16_bf16 v[192:207], a[136:139], a[160:163], v[192:207]
  ds_read_b64_tr_b16 a[152:153], v6 offset:20480
  ds_read_b64_tr_b16 a[154:155], v6 offset:22528
  v_mfma_f32_32x32x16_bf16 v[208:223], a[136:139], a[164:167], v[208:223]
  ds_read_b128 a[192:195], v12 offset:32768
  ds_read_b128 a[196:199], v13 offset:32768
  ds_read_b128 a[200:203], v14 offset:32768
  v_mfma_f32_32x32x16_bf16 v[224:239], a[140:143], a[160:163], v[224:239]
  ds_read_b64_tr_b16 a[156:157], v7 offset:20480
  ds_read_b64_tr_b16 a[158:159], v7 offset:22528
  ds_read_b128 a[204:207], v15 offset:32768
  ds_read_b128 a[208:211], v16 offset:32768
  ds_read_b128 a[212:215], v17 offset:32768
  v_mfma_f32_32x32x16_bf16 v[240:255], a[140:143], a[164:167], v[240:255]
  ds_read_b128 a[216:219], v18 offset:32768
  ds_read_b128 a[220:223], v19 offset:32768
  s_waitcnt lgkmcnt(5)
  v_mfma_f32_32x32x16_bf16 v[128:143], a[144:147], a[168:171], v[128:143]
  s_barrier
  ds_read_b128 a[0:3], v12 offset:49152
  ds_read_b128 a[4:7], v13 offset:49152
  ds_read_b128 a[8:11], v14 offset:49152
  v_mfma_f32_32x32x16_bf16 v[144:159], a[144:147], a[172:175], v[144:159]
  ds_read_b128 a[12:15], v15 offset:49152
  ds_read_b128 a[16:19], v16 offset:49152
  ds_read_b128 a[20:23], v17 offset:49152
  v_mfma_f32_32x32x16_bf16 v[160:175], a[148:151], a[168:171], v[160:175]
  ds_read_b128 a[24:27], v18 offset:49152
  ds_read_b128 a[28:31], v19 offset:49152
  ds_read_b64_tr_b16 a[224:225], v8 offset:40960
  v_mfma_f32_32x32x16_bf16 v[176:191], a[148:151], a[172:175], v[176:191]
  ds_read_b64_tr_b16 a[226:227], v8 offset:43008
  ds_read_b64_tr_b16 a[228:229], v9 offset:40960
  ds_read_b64_tr_b16 a[230:231], v9 offset:43008
  v_mfma_f32_32x32x16_bf16 v[192:207], a[152:155], a[168:171], v[192:207]
  ds_read_b64_tr_b16 a[232:233], v10 offset:40960
  ds_read_b64_tr_b16 a[234:235], v10 offset:43008
  ds_read_b64_tr_b16 a[236:237], v11 offset:40960
  v_cvt_pk_bf16_f32 v32, v128, v129
  v_cvt_pk_bf16_f32 v33, v130, v131
  v_cvt_pk_bf16_f32 v34, v132, v133
  v_cvt_pk_bf16_f32 v35, v134, v135
  v_accvgpr_write_b32 a128, v32
  v_accvgpr_write_b32 a129, v33
  v_accvgpr_write_b32 a130, v34
  v_accvgpr_write_b32 a131, v35
  v_mfma_f32_32x32x16_bf16 v[208:223], a[152:155], a[172:175], v[208:223]
  ds_read_b64_tr_b16 a[238:239], v11 offset:43008
  ds_read_b64_tr_b16 a[240:241], v8 offset:45056
  ds_read_b64_tr_b16 a[242:243], v8 offset:47104
  v_cvt_pk_bf16_f32 v36, v136, v137
  v_cvt_pk_bf16_f32 v37, v138, v139
  v_cvt_pk_bf16_f32 v38, v140, v141
  v_cvt_pk_bf16_f32 v39, v142, v143
  v_accvgpr_write_b32 a132, v36
  v_accvgpr_write_b32 a133, v37
  v_accvgpr_write_b32 a134, v38
  v_accvgpr_write_b32 a135, v39
  v_mfma_f32_32x32x16_bf16 v[224:239], a[156:159], a[168:171], v[224:239]
  ds_read_b64_tr_b16 a[244:245], v9 offset:45056
  ds_read_b64_tr_b16 a[246:247], v9 offset:47104
  ds_read_b64_tr_b16 a[248:249], v10 offset:45056
  v_cvt_pk_bf16_f32 v32, v144, v145
  v_cvt_pk_bf16_f32 v33, v146, v147
  v_cvt_pk_bf16_f32 v34, v148, v149
  v_cvt_pk_bf16_f32 v35, v150, v151
  v_accvgpr_write_b32 a136, v32
  v_accvgpr_write_b32 a137, v33
  v_accvgpr_write_b32 a138, v34
  v_accvgpr_write_b32 a139, v35
  v_mfma_f32_32x32x16_bf16 v[240:255], a[156:159], a[172:175], v[240:255]
  ds_read_b64_tr_b16 a[250:251], v10 offset:47104
  ds_read_b64_tr_b16 a[252:253], v11 offset:45056
  ds_read_b64_tr_b16 a[254:255], v11 offset:47104
  v_cvt_pk_bf16_f32 v36, v152, v153
  v_cvt_pk_bf16_f32 v37, v154, v155
  v_cvt_pk_bf16_f32 v38, v156, v157
  v_cvt_pk_bf16_f32 v39, v158, v159
  v_accvgpr_write_b32 a140, v36
  v_accvgpr_write_b32 a141, v37
  v_accvgpr_write_b32 a142, v38
  v_accvgpr_write_b32 a143, v39
  v_and_b32 v58, 7, v1
  v_lshlrev_b32 v58, 2, v58
  s_lshl_b32 s78, s44, 16
  s_lshl_b32 s49, s46, 14
  v_add_u32 v59, s49, v2
  v_lshrrev_b32 v46, 3, v1
  v_and_b32 v47, 7, v1
  v_and_b32 v48, 2, v46
  v_lshlrev_b32 v48, 1, v48
  v_xor_b32 v47, v47, v48
  v_lshlrev_b32 v47, 4, v47
  v_lshl_add_u32 v47, v46, 10, v47
  s_lshl_b32 s49, s46, 8
  v_add_u32 v20, s49, v47
  v_add_u32 v21, 0x1c00, v20
  v_add_u32 v22, 0x3800, v20
  v_add_u32 v23, 0x5400, v20
  v_bfe_u32 v46, v1, 2, 2
  v_lshrrev_b32 v47, 5, v1
  v_lshl_add_u32 v47, v47, 2, v46
  v_lshlrev_b32 v47, 7, v47
  v_bfe_u32 v48, v1, 4, 1
  v_lshl_add_u32 v47, v48, 5, v47
  v_and_b32 v48, 3, v1
  v_lshl_add_u32 v47, v48, 3, v47
  v_lshrrev_b32 v46, 1, v46
  v_xor_b32 v48, 0, v46
  v_lshl_add_u32 v48, v48, 6, v47
  v_add_u32 v4, s47, v48
  v_xor_b32 v48, 1, v46
  v_lshl_add_u32 v48, v48, 6, v47
  v_add_u32 v5, s47, v48
  s_lshr_b32 s49, s44, 1
  s_and_b32 s49, s49, 1
  v_xor_b32 v48, s49, v46
  v_lshl_add_u32 v48, v48, 6, v47
  v_add_u32 v6, s47, v48
  v_xor_b32 v7, 64, v6
  s_and_b32 s49, s44, 1
  s_lshl_b32 s49, s49, 10
  v_add_u32 v3, s49, v2
  s_lshr_b32 s49, s44, 2
  s_xor_b32 s49, s49, 1
  s_lshl_b32 s79, s49, 7
  v_add_u32 v20, s79, v20
  v_add_u32 v21, s79, v21
  v_add_u32 v22, s79, v22
  v_add_u32 v23, s79, v23
  s_lshl_b32 s62, s46, 17
  s_add_u32 s54, s62, 0x20000
  s_and_b32 s54, s54, 0x7ffff
  s_lshr_b32 s49, s100, 1
  s_and_b32 s49, s49, 15
  s_sub_u32 s51, s49, 12
  s_cmp_ge_u32 s49, 12
  s_cselect_b32 s49, s51, s49
  s_lshl_b32 s51, s46, 2
  s_add_u32 s49, s49, s51
  s_add_u32 s49, s49, 4
  s_and_b32 s49, s49, 15
  s_lshl_b32 s59, s49, 15
  v_mfma_f32_32x32x16_bf16 v[128:143], a[192:195], v[64:67], 0
  v_cvt_pk_bf16_f32 v32, v160, v161
  v_cvt_pk_bf16_f32 v33, v162, v163
  v_cvt_pk_bf16_f32 v34, v164, v165
  v_cvt_pk_bf16_f32 v35, v166, v167
  v_accvgpr_write_b32 a144, v32
  v_accvgpr_write_b32 a145, v33
  v_mfma_f32_32x32x16_bf16 v[144:159], a[192:195], v[96:99], 0
  s_add_u32 m0, s55, 0
  s_nop 0
  buffer_load_dwordx4 v24, s[8:11], s56 offen lds
  v_accvgpr_write_b32 a146, v34
  v_accvgpr_write_b32 a147, v35
  v_cvt_pk_bf16_f32 v36, v168, v169
  v_mfma_f32_32x32x16_bf16 v[128:143], a[196:199], v[68:71], v[128:143]
  buffer_load_dwordx4 v25, s[8:11], s56 offen offset:1024 lds
  v_cvt_pk_bf16_f32 v37, v170, v171
  v_cvt_pk_bf16_f32 v38, v172, v173
  v_cvt_pk_bf16_f32 v39, v174, v175
  v_accvgpr_write_b32 a148, v36
  v_mfma_f32_32x32x16_bf16 v[144:159], a[196:199], v[100:103], v[144:159]
  s_add_u32 s56, s56, 0x2000
  v_accvgpr_write_b32 a149, v37
  v_accvgpr_write_b32 a150, v38
  v_accvgpr_write_b32 a151, v39
  v_cvt_pk_bf16_f32 v32, v176, v177
  v_cvt_pk_bf16_f32 v33, v178, v179
  v_mfma_f32_32x32x16_bf16 v[128:143], a[200:203], v[72:75], v[128:143]
  s_and_b32 s56, s56, 0x1ffff
  v_cvt_pk_bf16_f32 v34, v180, v181
  v_cvt_pk_bf16_f32 v35, v182, v183
  v_accvgpr_write_b32 a152, v32
  v_accvgpr_write_b32 a153, v33
  v_accvgpr_write_b32 a154, v34
  v_mfma_f32_32x32x16_bf16 v[144:159], a[200:203], v[104:107], v[144:159]
  s_add_u32 m0, s55, 0x2000
  v_accvgpr_write_b32 a155, v35
  v_cvt_pk_bf16_f32 v36, v184, v185
  v_cvt_pk_bf16_f32 v37, v186, v187
  v_cvt_pk_bf16_f32 v38, v188, v189
  v_cvt_pk_bf16_f32 v39, v190, v191
  s_waitcnt lgkmcnt(15)
  v_mfma_f32_32x32x16_bf16 v[128:143], a[204:207], v[76:79], v[128:143]
  buffer_load_dwordx4 v26, s[12:15], s57 offen lds
  v_accvgpr_write_b32 a156, v36
  v_accvgpr_write_b32 a157, v37
  v_accvgpr_write_b32 a158, v38
  v_accvgpr_write_b32 a159, v39
  v_mfma_f32_32x32x16_bf16 v[144:159], a[204:207], v[108:111], v[144:159]
  buffer_load_dwordx4 v26, s[12:15], s57 offen offset:1024 lds
  v_cvt_pk_bf16_f32 v32, v192, v193
  v_cvt_pk_bf16_f32 v33, v194, v195
  v_cvt_pk_bf16_f32 v34, v196, v197
  v_cvt_pk_bf16_f32 v35, v198, v199
  v_mfma_f32_32x32x16_bf16 v[128:143], a[208:211], v[80:83], v[128:143]
  s_add_u32 s57, s57, 0x2000
  v_accvgpr_write_b32 a160, v32
  v_accvgpr_write_b32 a161, v33
  v_accvgpr_write_b32 a162, v34
  v_accvgpr_write_b32 a163, v35
  v_cvt_pk_bf16_f32 v36, v200, v201
  v_mfma_f32_32x32x16_bf16 v[144:159], a[208:211], v[112:115], v[144:159]
  s_and_b32 s57, s57, 0x1ffff
  v_cvt_pk_bf16_f32 v37, v202, v203
  v_cvt_pk_bf16_f32 v38, v204, v205
  v_cvt_pk_bf16_f32 v39, v206, v207
  v_accvgpr_write_b32 a164, v36
  v_accvgpr_write_b32 a165, v37
  v_mfma_f32_32x32x16_bf16 v[128:143], a[212:215], v[84:87], v[128:143]
  s_add_u32 m0, s55, 0x4000
  v_accvgpr_write_b32 a166, v38
  v_accvgpr_write_b32 a167, v39
  v_cvt_pk_bf16_f32 v32, v208, v209
  v_cvt_pk_bf16_f32 v33, v210, v211
  v_cvt_pk_bf16_f32 v34, v212, v213
  v_mfma_f32_32x32x16_bf16 v[144:159], a[212:215], v[116:119], v[144:159]
  buffer_load_dwordx4 v24, s[8:11], s56 offen lds
  v_cvt_pk_bf16_f32 v35, v214, v215
  v_accvgpr_write_b32 a168, v32
  v_accvgpr_write_b32 a169, v33
  v_accvgpr_write_b32 a170, v34
  v_mfma_f32_32x32x16_bf16 v[128:143], a[216:219], v[88:91], v[128:143]
  buffer_load_dwordx4 v25, s[8:11], s56 offen offset:1024 lds
  v_accvgpr_write_b32 a171, v35
  v_cvt_pk_bf16_f32 v36, v216, v217
  v_cvt_pk_bf16_f32 v37, v218, v219
  v_cvt_pk_bf16_f32 v38, v220, v221
  v_mfma_f32_32x32x16_bf16 v[144:159], a[216:219], v[120:123], v[144:159]
  s_add_u32 s56, s56, 0x2000
  v_cvt_pk_bf16_f32 v39, v222, v223
  v_accvgpr_write_b32 a172, v36
  v_accvgpr_write_b32 a173, v37
  v_accvgpr_write_b32 a174, v38
  v_accvgpr_write_b32 a175, v39
  v_mfma_f32_32x32x16_bf16 v[128:143], a[220:223], v[92:95], v[128:143]
  s_and_b32 s56, s56, 0x1ffff
  v_cvt_pk_bf16_f32 v32, v224, v225
  v_cvt_pk_bf16_f32 v33, v226, v227
  v_cvt_pk_bf16_f32 v34, v228, v229
  v_cvt_pk_bf16_f32 v35, v230, v231
  v_accvgpr_write_b32 a176, v32
  v_mfma_f32_32x32x16_bf16 v[144:159], a[220:223], v[124:127], v[144:159]
  v_accvgpr_write_b32 a177, v33
  v_accvgpr_write_b32 a178, v34
  v_accvgpr_write_b32 a179, v35
  v_cvt_pk_bf16_f32 v36, v232, v233
  v_cvt_pk_bf16_f32 v37, v234, v235
  v_cvt_pk_bf16_f32 v38, v236, v237
  v_cvt_pk_bf16_f32 v39, v238, v239
  v_accvgpr_write_b32 a180, v36
  v_accvgpr_write_b32 a181, v37
  v_accvgpr_write_b32 a182, v38
  v_accvgpr_write_b32 a183, v39
  v_cvt_pk_bf16_f32 v32, v240, v241
  v_cvt_pk_bf16_f32 v33, v242, v243
  v_cvt_pk_bf16_f32 v34, v244, v245
  v_cvt_pk_bf16_f32 v35, v246, v247
  v_accvgpr_write_b32 a184, v32
  v_accvgpr_write_b32 a185, v33
  v_accvgpr_write_b32 a186, v34
  v_accvgpr_write_b32 a187, v35
  v_cvt_pk_bf16_f32 v36, v248, v249
  v_cvt_pk_bf16_f32 v37, v250, v251
  v_cvt_pk_bf16_f32 v38, v252, v253
  v_cvt_pk_bf16_f32 v39, v254, v255
  v_accvgpr_write_b32 a188, v36
  v_accvgpr_write_b32 a189, v37
  v_accvgpr_write_b32 a190, v38
  v_accvgpr_write_b32 a191, v39
  v_mfma_f32_32x32x16_bf16 v[160:175], a[0:3], v[64:67], 0
  v_mfma_f32_32x32x16_bf16 v[176:191], a[0:3], v[96:99], 0
  v_mfma_f32_32x32x16_bf16 v[160:175], a[4:7], v[68:71], v[160:175]
  v_max3_f32 v44, v128, v129, v130
  v_max3_f32 v44, v44, v131, v132
  v_max3_f32 v44, v44, v133, v134
  v_max3_f32 v44, v44, v135, v136
  v_max3_f32 v44, v44, v137, v138
  v_max3_f32 v44, v44, v139, v140
  v_max3_f32 v44, v44, v141, v142
  v_max_f32 v44, v44, v143
  v_max3_f32 v45, v144, v145, v146
  v_max3_f32 v45, v45, v147, v148
  v_max3_f32 v45, v45, v149, v150
  v_max3_f32 v45, v45, v151, v152
  v_max3_f32 v45, v45, v153, v154
  v_max3_f32 v45, v45, v155, v156
  v_max3_f32 v45, v45, v157, v158
  v_max_f32 v45, v45, v159
  s_nop 1
  v_permlane32_swap_b32 v44, v45
  v_max_f32 v44, v44, v45
  v_mov_b32 v45, v44
  s_nop 1
  v_permlane32_swap_b32 v44, v45
  v_mfma_f32_32x32x16_bf16 v[176:191], a[4:7], v[100:103], v[176:191]
  v_sub_f32 v128, v128, v44
  v_sub_f32 v129, v129, v44
  v_exp_f32 v32, v128
  v_exp_f32 v33, v129
  v_mfma_f32_32x32x16_bf16 v[160:175], a[8:11], v[72:75], v[160:175]
  v_sub_f32 v130, v130, v44
  v_sub_f32 v131, v131, v44
  v_exp_f32 v34, v130
  v_exp_f32 v35, v131
  v_mfma_f32_32x32x16_bf16 v[176:191], a[8:11], v[104:107], v[176:191]
  v_add_f32 v30, v32, v33
  v_cvt_pk_bf16_f32 v224, v32, v33
  v_sub_f32 v132, v132, v44
  v_sub_f32 v133, v133, v44
  v_exp_f32 v36, v132
  v_mfma_f32_32x32x16_bf16 v[160:175], a[12:15], v[76:79], v[160:175]
  v_exp_f32 v37, v133
  v_add_f32 v30, v30, v34
  v_add_f32 v30, v30, v35
  v_cvt_pk_bf16_f32 v225, v34, v35
  v_sub_f32 v134, v134, v44
  v_mfma_f32_32x32x16_bf16 v[176:191], a[12:15], v[108:111], v[176:191]
  v_sub_f32 v135, v135, v44
  v_exp_f32 v38, v134
  v_exp_f32 v39, v135
  v_add_f32 v30, v30, v36
  v_mfma_f32_32x32x16_bf16 v[160:175], a[16:19], v[80:83], v[160:175]
  v_add_f32 v30, v30, v37
  v_cvt_pk_bf16_f32 v226, v36, v37
  v_sub_f32 v144, v144, v45
  v_sub_f32 v145, v145, v45
  v_exp_f32 v40, v144
  v_mfma_f32_32x32x16_bf16 v[176:191], a[16:19], v[112:115], v[176:191]
  v_exp_f32 v41, v145
  v_add_f32 v30, v30, v38
  v_add_f32 v30, v30, v39
  v_cvt_pk_bf16_f32 v227, v38, v39
  v_sub_f32 v146, v146, v45
  v_mfma_f32_32x32x16_bf16 v[160:175], a[20:23], v[84:87], v[160:175]
  v_sub_f32 v147, v147, v45
  v_exp_f32 v42, v146
  v_exp_f32 v43, v147
  v_add_f32 v31, v40, v41
  v_mfma_f32_32x32x16_bf16 v[176:191], a[20:23], v[116:119], v[176:191]
  v_cvt_pk_bf16_f32 v232, v40, v41
  v_sub_f32 v148, v148, v45
  v_sub_f32 v149, v149, v45
  v_exp_f32 v32, v148
  v_mfma_f32_32x32x16_bf16 v[160:175], a[24:27], v[88:91], v[160:175]
  v_exp_f32 v33, v149
  v_add_f32 v31, v31, v42
  v_add_f32 v31, v31, v43
  v_cvt_pk_bf16_f32 v233, v42, v43
  v_sub_f32 v150, v150, v45
  v_mfma_f32_32x32x16_bf16 v[176:191], a[24:27], v[120:123], v[176:191]
  v_sub_f32 v151, v151, v45
  v_exp_f32 v34, v150
  v_exp_f32 v35, v151
  v_add_f32 v31, v31, v32
  v_mfma_f32_32x32x16_bf16 v[160:175], a[28:31], v[92:95], v[160:175]
  v_add_f32 v31, v31, v33
  v_cvt_pk_bf16_f32 v234, v32, v33
  v_add_f32 v31, v31, v34
  v_add_f32 v31, v31, v35
  v_cvt_pk_bf16_f32 v235, v34, v35
  v_sub_f32 v136, v136, v44
  v_mfma_f32_32x32x16_bf16 v[176:191], a[28:31], v[124:127], v[176:191]
  v_sub_f32 v137, v137, v44
  v_exp_f32 v36, v136
  v_exp_f32 v37, v137
  v_sub_f32 v138, v138, v44
  s_waitcnt lgkmcnt(14)
  v_mfma_f32_32x32x16_bf16 a[0:15], a[224:227], v[224:227], 0
  s_waitcnt vmcnt(4)
  s_barrier
  v_sub_f32 v139, v139, v44
  v_exp_f32 v38, v138
  v_mfma_f32_32x32x16_bf16 a[16:31], a[224:227], v[232:235], 0
  ds_read_b128 a[192:195], v12
  v_exp_f32 v39, v139
  v_add_f32 v30, v30, v36
  v_add_f32 v30, v30, v37
  v_cvt_pk_bf16_f32 v228, v36, v37
  s_waitcnt lgkmcnt(13)
  v_mfma_f32_32x32x16_bf16 a[32:47], a[228:231], v[224:227], 0
  ds_read_b128 a[196:199], v13
  v_sub_f32 v140, v140, v44
  v_sub_f32 v141, v141, v44
  v_exp_f32 v40, v140
  v_mfma_f32_32x32x16_bf16 a[48:63], a[228:231], v[232:235], 0
  ds_read_b128 a[200:203], v14
  v_exp_f32 v41, v141
  v_add_f32 v30, v30, v38
  v_add_f32 v30, v30, v39
  v_cvt_pk_bf16_f32 v229, v38, v39
  s_waitcnt lgkmcnt(13)
  v_mfma_f32_32x32x16_bf16 a[64:79], a[232:235], v[224:227], 0
  ds_read_b128 a[204:207], v15
  v_sub_f32 v142, v142, v44
  v_sub_f32 v143, v143, v44
  v_exp_f32 v42, v142
  v_mfma_f32_32x32x16_bf16 a[80:95], a[232:235], v[232:235], 0
  ds_read_b128 a[208:211], v16
  v_exp_f32 v43, v143
  v_add_f32 v30, v30, v40
  v_add_f32 v30, v30, v41
  v_cvt_pk_bf16_f32 v230, v40, v41
  s_waitcnt lgkmcnt(13)
  v_mfma_f32_32x32x16_bf16 a[96:111], a[236:239], v[224:227], 0
  ds_read_b128 a[212:215], v17
  v_sub_f32 v152, v152, v45
  v_sub_f32 v153, v153, v45
  v_exp_f32 v32, v152
  v_mfma_f32_32x32x16_bf16 a[112:127], a[236:239], v[232:235], 0
  ds_read_b128 a[216:219], v18
  v_exp_f32 v33, v153
  v_add_f32 v30, v30, v42
  v_add_f32 v30, v30, v43
  v_cvt_pk_bf16_f32 v231, v42, v43
  v_sub_f32 v154, v154, v45
  v_sub_f32 v155, v155, v45
  v_exp_f32 v34, v154
  v_exp_f32 v35, v155
  v_add_f32 v31, v31, v32
  v_add_f32 v31, v31, v33
  v_cvt_pk_bf16_f32 v236, v32, v33
  v_sub_f32 v156, v156, v45
  v_sub_f32 v157, v157, v45
  v_exp_f32 v36, v156
  v_exp_f32 v37, v157
  v_add_f32 v31, v31, v34
  v_add_f32 v31, v31, v35
  v_cvt_pk_bf16_f32 v237, v34, v35
  v_sub_f32 v158, v158, v45
  v_sub_f32 v159, v159, v45
  v_exp_f32 v38, v158
  v_exp_f32 v39, v159
  v_add_f32 v31, v31, v36
  v_add_f32 v31, v31, v37
  v_cvt_pk_bf16_f32 v238, v36, v37
  v_add_f32 v31, v31, v38
  v_add_f32 v31, v31, v39
  v_cvt_pk_bf16_f32 v239, v38, v39
  s_waitcnt lgkmcnt(13)
  v_mfma_f32_32x32x16_bf16 a[0:15], a[240:243], v[228:231], a[0:15]
  ds_read_b128 a[220:223], v19
  v_mov_b32 v28, v30
  v_mov_b32 v29, v31
  v_sub_f32 v192, 0, v44
  v_sub_f32 v193, 0, v44
  v_sub_f32 v194, 0, v44
  v_mfma_f32_32x32x16_bf16 a[16:31], a[240:243], v[236:239], a[16:31]
  s_add_u32 m0, s55, 0x8000
  s_nop 0
  buffer_load_dwordx4 v24, s[8:11], s56 offen lds
  v_sub_f32 v195, 0, v44
  v_sub_f32 v196, 0, v44
  v_sub_f32 v197, 0, v44
  s_waitcnt lgkmcnt(12)
  v_mfma_f32_32x32x16_bf16 a[32:47], a[244:247], v[228:231], a[32:47]
  v_sub_f32 v198, 0, v44
  v_sub_f32 v199, 0, v44
  v_sub_f32 v200, 0, v44
  v_sub_f32 v201, 0, v44
  v_sub_f32 v202, 0, v44
  v_sub_f32 v203, 0, v44
  v_mfma_f32_32x32x16_bf16 a[48:63], a[244:247], v[236:239], a[48:63]
  v_sub_f32 v204, 0, v44
  v_sub_f32 v205, 0, v44
  v_sub_f32 v206, 0, v44
  v_sub_f32 v207, 0, v44
  v_sub_f32 v208, 0, v45
  v_sub_f32 v209, 0, v45
  s_waitcnt lgkmcnt(10)
  v_mfma_f32_32x32x16_bf16 a[64:79], a[248:251], v[228:231], a[64:79]
  buffer_load_dwordx4 v25, s[8:11], s56 offen offset:1024 lds
  v_sub_f32 v210, 0, v45
  v_sub_f32 v211, 0, v45
  v_sub_f32 v212, 0, v45
  v_sub_f32 v213, 0, v45
  v_mfma_f32_32x32x16_bf16 a[80:95], a[248:251], v[236:239], a[80:95]
  v_sub_f32 v214, 0, v45
  v_sub_f32 v215, 0, v45
  v_sub_f32 v216, 0, v45
  v_sub_f32 v217, 0, v45
  v_sub_f32 v218, 0, v45
  v_sub_f32 v219, 0, v45
  s_waitcnt lgkmcnt(8)
  v_mfma_f32_32x32x16_bf16 a[96:111], a[252:255], v[228:231], a[96:111]
  v_sub_f32 v220, 0, v45
  v_sub_f32 v221, 0, v45
  v_sub_f32 v222, 0, v45
  v_sub_f32 v223, 0, v45
  v_sub_f32 v160, v160, v44
  v_sub_f32 v161, v161, v44
  v_mfma_f32_32x32x16_bf16 a[112:127], a[252:255], v[236:239], a[112:127]
  s_waitcnt lgkmcnt(0)
  s_add_u32 s56, s56, 0x2000
  s_and_b32 s56, s56, 0x1ffff
  s_add_u32 m0, s55, 0x6000
  s_nop 0
  buffer_load_dwordx4 v26, s[12:15], s57 offen lds
  v_mfma_f32_32x32x16_bf16 v[128:143], a[192:195], v[64:67], v[192:207]
  ds_read_b64_tr_b16 a[224:225], v8 offset:57344
  ds_read_b64_tr_b16 a[226:227], v8 offset:59392
  v_exp_f32 v32, v160
  v_exp_f32 v33, v161
  v_mfma_f32_32x32x16_bf16 v[144:159], a[192:195], v[96:99], v[208:223]
  ds_read_b64_tr_b16 a[228:229], v9 offset:57344
  v_sub_f32 v162, v162, v44
  v_sub_f32 v163, v163, v44
  v_exp_f32 v34, v162
  v_mfma_f32_32x32x16_bf16 v[128:143], a[196:199], v[68:71], v[128:143]
  ds_read_b64_tr_b16 a[230:231], v9 offset:59392
  buffer_load_dwordx4 v26, s[12:15], s57 offen offset:1024 lds
  v_exp_f32 v35, v163
  v_add_f32 v30, v32, v33
  v_mfma_f32_32x32x16_bf16 v[144:159], a[196:199], v[100:103], v[144:159]
  ds_read_b64_tr_b16 a[232:233], v10 offset:57344
  ds_read_b64_tr_b16 a[234:235], v10 offset:59392
  v_cvt_pk_bf16_f32 v240, v32, v33
  v_sub_f32 v164, v164, v44
  v_sub_f32 v165, v165, v44
  v_mfma_f32_32x32x16_bf16 v[128:143], a[200:203], v[72:75], v[128:143]
  ds_read_b64_tr_b16 a[236:237], v11 offset:57344
  v_exp_f32 v36, v164
  v_exp_f32 v37, v165
  v_add_f32 v30, v30, v34
  v_mfma_f32_32x32x16_bf16 v[144:159], a[200:203], v[104:107], v[144:159]
  ds_read_b64_tr_b16 a[238:239], v11 offset:59392
  s_add_u32 s57, s57, 0x2000
  s_and_b32 s57, s57, 0x1ffff
  s_mov_b32 s53, 0
  buffer_store_dwordx4 a[128:131], v27, s[36:39], s53 offen sc1
  v_mfma_f32_32x32x16_bf16 v[128:143], a[204:207], v[76:79], v[128:143]
  ds_read_b64_tr_b16 a[240:241], v8 offset:61440
  ds_read_b64_tr_b16 a[242:243], v8 offset:63488
  v_add_f32 v30, v30, v35
  v_cvt_pk_bf16_f32 v241, v34, v35
  v_sub_f32 v166, v166, v44
  v_sub_f32 v167, v167, v44
  v_mfma_f32_32x32x16_bf16 v[144:159], a[204:207], v[108:111], v[144:159]
  ds_read_b64_tr_b16 a[244:245], v9 offset:61440
  v_exp_f32 v38, v166
  v_exp_f32 v39, v167
  v_add_f32 v30, v30, v36
  v_mfma_f32_32x32x16_bf16 v[128:143], a[208:211], v[80:83], v[128:143]
  ds_read_b64_tr_b16 a[246:247], v9 offset:63488
  buffer_store_dwordx4 a[132:135], v27, s[36:39], s53 offen offset:1024 sc1
  v_add_f32 v30, v30, v37
  v_cvt_pk_bf16_f32 v242, v36, v37
  v_sub_f32 v176, v176, v45
  v_mfma_f32_32x32x16_bf16 v[144:159], a[208:211], v[112:115], v[144:159]
  ds_read_b64_tr_b16 a[248:249], v10 offset:61440
  ds_read_b64_tr_b16 a[250:251], v10 offset:63488
  v_sub_f32 v177, v177, v45
  v_exp_f32 v40, v176
  v_mfma_f32_32x32x16_bf16 v[128:143], a[212:215], v[84:87], v[128:143]
  ds_read_b64_tr_b16 a[252:253], v11 offset:61440
  v_exp_f32 v41, v177
  v_add_f32 v30, v30, v38
  v_add_f32 v30, v30, v39
  v_cvt_pk_bf16_f32 v243, v38, v39
  v_mfma_f32_32x32x16_bf16 v[144:159], a[212:215], v[116:119], v[144:159]
  ds_read_b64_tr_b16 a[254:255], v11 offset:63488
  v_sub_f32 v178, v178, v45
  v_sub_f32 v179, v179, v45
  v_exp_f32 v42, v178
  v_mfma_f32_32x32x16_bf16 v[128:143], a[216:219], v[88:91], v[128:143]
  v_exp_f32 v43, v179
  v_add_f32 v31, v40, v41
  v_cvt_pk_bf16_f32 v248, v40, v41
  v_sub_f32 v180, v180, v45
  v_sub_f32 v181, v181, v45
  v_mfma_f32_32x32x16_bf16 v[144:159], a[216:219], v[120:123], v[144:159]
  v_exp_f32 v32, v180
  v_exp_f32 v33, v181
  v_add_f32 v31, v31, v42
  v_add_f32 v31, v31, v43
  v_mfma_f32_32x32x16_bf16 v[128:143], a[220:223], v[92:95], v[128:143]
  v_cvt_pk_bf16_f32 v249, v42, v43
  v_sub_f32 v182, v182, v45
  v_sub_f32 v183, v183, v45
  v_exp_f32 v34, v182
  v_exp_f32 v35, v183
  v_add_f32 v31, v31, v32
  v_add_f32 v31, v31, v33
  v_cvt_pk_bf16_f32 v250, v32, v33
  v_sub_f32 v168, v168, v44
  v_sub_f32 v169, v169, v44
  v_exp_f32 v36, v168
  v_exp_f32 v37, v169
  v_add_f32 v31, v31, v34
  v_add_f32 v31, v31, v35
  v_cvt_pk_bf16_f32 v251, v34, v35
  v_sub_f32 v170, v170, v44
  v_sub_f32 v171, v171, v44
  v_exp_f32 v38, v170
  v_exp_f32 v39, v171
  v_add_f32 v30, v30, v36
  v_add_f32 v30, v30, v37
  v_cvt_pk_bf16_f32 v244, v36, v37
  v_sub_f32 v172, v172, v44
  v_sub_f32 v173, v173, v44
  v_exp_f32 v40, v172
  v_exp_f32 v41, v173
  v_add_f32 v30, v30, v38
  v_add_f32 v30, v30, v39
  v_cvt_pk_bf16_f32 v245, v38, v39
  v_sub_f32 v174, v174, v44
  v_sub_f32 v175, v175, v44
  v_exp_f32 v42, v174
  v_exp_f32 v43, v175
  v_add_f32 v30, v30, v40
  v_add_f32 v30, v30, v41
  v_cvt_pk_bf16_f32 v246, v40, v41
  v_sub_f32 v184, v184, v45
  v_sub_f32 v185, v185, v45
  v_exp_f32 v32, v184
  v_exp_f32 v33, v185
  v_add_f32 v30, v30, v42
  v_add_f32 v30, v30, v43
  v_cvt_pk_bf16_f32 v247, v42, v43
  v_sub_f32 v186, v186, v45
  v_sub_f32 v187, v187, v45
  v_exp_f32 v34, v186
  v_exp_f32 v35, v187
  v_add_f32 v31, v31, v32
  v_add_f32 v31, v31, v33
  v_cvt_pk_bf16_f32 v252, v32, v33
  v_sub_f32 v188, v188, v45
  v_sub_f32 v189, v189, v45
  v_exp_f32 v36, v188
  v_exp_f32 v37, v189
  v_add_f32 v31, v31, v34
  v_add_f32 v31, v31, v35
  v_cvt_pk_bf16_f32 v253, v34, v35
  v_sub_f32 v190, v190, v45
  v_sub_f32 v191, v191, v45
  v_exp_f32 v38, v190
  v_exp_f32 v39, v191
  v_add_f32 v31, v31, v36
  v_add_f32 v31, v31, v37
  v_cvt_pk_bf16_f32 v254, v36, v37
  v_add_f32 v31, v31, v38
  v_add_f32 v31, v31, v39
  v_cvt_pk_bf16_f32 v255, v38, v39
  v_mfma_f32_32x32x16_bf16 v[144:159], a[220:223], v[124:127], v[144:159]
  v_max_f32 v32, v30, v31
  v_cmp_nge_f32 vcc, s50, v32
  s_waitcnt lgkmcnt(0)
  s_nop 0
  s_cbranch_vccz L_ok_1
  s_call_b64 s[60:61], L_slow_1
L_ok_1:
  v_mfma_f32_32x32x16_bf16 a[0:15], a[224:227], v[240:243], a[0:15]
  s_waitcnt vmcnt(6)
  s_barrier
  v_add_f32 v28, v28, v30
  v_add_f32 v29, v29, v31
  v_mfma_f32_32x32x16_bf16 a[16:31], a[224:227], v[248:251], a[16:31]
  ds_read_b128 a[192:195], v12 offset:16384
  v_exp_f32 v32, v128
  v_exp_f32 v33, v129
  v_mfma_f32_32x32x16_bf16 a[32:47], a[228:231], v[240:243], a[32:47]
  ds_read_b128 a[196:199], v13 offset:16384
  v_exp_f32 v34, v130
  v_exp_f32 v35, v131
  v_mfma_f32_32x32x16_bf16 a[48:63], a[228:231], v[248:251], a[48:63]
  ds_read_b128 a[200:203], v14 offset:16384
  v_add_f32 v30, v32, v33
  v_cvt_pk_bf16_f32 v224, v32, v33
  v_exp_f32 v36, v132
  v_mfma_f32_32x32x16_bf16 a[64:79], a[232:235], v[240:243], a[64:79]
  ds_read_b128 a[204:207], v15 offset:16384
  v_exp_f32 v37, v133
  v_add_f32 v30, v30, v34
  v_add_f32 v30, v30, v35
  v_mfma_f32_32x32x16_bf16 a[80:95], a[232:235], v[248:251], a[80:95]
  ds_read_b128 a[208:211], v16 offset:16384
  v_cvt_pk_bf16_f32 v225, v34, v35
  v_exp_f32 v38, v134
  v_mfma_f32_32x32x16_bf16 a[96:111], a[236:239], v[240:243], a[96:111]
  ds_read_b128 a[212:215], v17 offset:16384
  v_exp_f32 v39, v135
  v_add_f32 v30, v30, v36
  v_add_f32 v30, v30, v37
  v_cvt_pk_bf16_f32 v226, v36, v37
  v_mfma_f32_32x32x16_bf16 a[112:127], a[236:239], v[248:251], a[112:127]
  ds_read_b128 a[216:219], v18 offset:16384
  v_exp_f32 v40, v144
  v_exp_f32 v41, v145
  v_mfma_f32_32x32x16_bf16 a[0:15], a[240:243], v[244:247], a[0:15]
  ds_read_b128 a[220:223], v19 offset:16384
  v_add_f32 v30, v30, v38
  v_add_f32 v30, v30, v39
  v_cvt_pk_bf16_f32 v227, v38, v39
  v_mfma_f32_32x32x16_bf16 a[16:31], a[240:243], v[252:255], a[16:31]
  s_add_u32 m0, s55, 0xc000
  s_nop 0
  buffer_load_dwordx4 v24, s[8:11], s56 offen lds
  v_exp_f32 v42, v146
  v_mfma_f32_32x32x16_bf16 a[32:47], a[244:247], v[244:247], a[32:47]
  v_exp_f32 v43, v147
  v_add_f32 v31, v40, v41
  v_cvt_pk_bf16_f32 v232, v40, v41
  v_exp_f32 v32, v148
  v_mfma_f32_32x32x16_bf16 a[48:63], a[244:247], v[252:255], a[48:63]
  v_exp_f32 v33, v149
  v_add_f32 v31, v31, v42
  v_add_f32 v31, v31, v43
  v_cvt_pk_bf16_f32 v233, v42, v43
  v_mfma_f32_32x32x16_bf16 a[64:79], a[248:251], v[244:247], a[64:79]
  buffer_load_dwordx4 v25, s[8:11], s56 offen offset:1024 lds
  v_exp_f32 v34, v150
  v_exp_f32 v35, v151
  v_mfma_f32_32x32x16_bf16 a[80:95], a[248:251], v[252:255], a[80:95]
  v_add_f32 v31, v31, v32
  v_add_f32 v31, v31, v33
  v_cvt_pk_bf16_f32 v234, v32, v33
  v_exp_f32 v36, v136
  v_mfma_f32_32x32x16_bf16 a[96:111], a[252:255], v[244:247], a[96:111]
  v_exp_f32 v37, v137
  v_add_f32 v31, v31, v34
  v_add_f32 v31, v31, v35
  v_mfma_f32_32x32x16_bf16 a[112:127], a[252:255], v[252:255], a[112:127]
  s_waitcnt lgkmcnt(0)
  s_add_u32 s56, s56, 0x2000
  s_and_b32 s56, s56, 0x1ffff
  s_add_u32 m0, s55, 0xa000
  s_nop 0
  buffer_load_dwordx4 v26, s[12:15], s57 offen lds
  v_mfma_f32_32x32x16_bf16 v[160:175], a[192:195], v[64:67], v[192:207]
  ds_read_b64_tr_b16 a[224:225], v8 offset:8192
  ds_read_b64_tr_b16 a[226:227], v8 offset:10240
  v_cvt_pk_bf16_f32 v235, v34, v35
  v_exp_f32 v38, v138
  v_mfma_f32_32x32x16_bf16 v[176:191], a[192:195], v[96:99], v[208:223]
  ds_read_b64_tr_b16 a[228:229], v9 offset:8192
  v_exp_f32 v39, v139
  v_add_f32 v30, v30, v36
  v_add_f32 v30, v30, v37
  v_cvt_pk_bf16_f32 v228, v36, v37
  v_mfma_f32_32x32x16_bf16 v[160:175], a[196:199], v[68:71], v[160:175]
  ds_read_b64_tr_b16 a[230:231], v9 offset:10240
  buffer_load_dwordx4 v26, s[12:15], s57 offen offset:1024 lds
  v_exp_f32 v40, v140
  v_mfma_f32_32x32x16_bf16 v[176:191], a[196:199], v[100:103], v[176:191]
  ds_read_b64_tr_b16 a[232:233], v10 offset:8192
  ds_read_b64_tr_b16 a[234:235], v10 offset:10240
  v_exp_f32 v41, v141
  v_add_f32 v30, v30, v38
  v_mfma_f32_32x32x16_bf16 v[160:175], a[200:203], v[72:75], v[160:175]
  ds_read_b64_tr_b16 a[236:237], v11 offset:8192
  v_add_f32 v30, v30, v39
  v_cvt_pk_bf16_f32 v229, v38, v39
  v_exp_f32 v42, v142
  v_mfma_f32_32x32x16_bf16 v[176:191], a[200:203], v[104:107], v[176:191]
  ds_read_b64_tr_b16 a[238:239], v11 offset:10240
  s_add_u32 s57, s57, 0x2000
  s_and_b32 s57, s57, 0x1ffff
  s_mov_b32 s53, 0x10000
  buffer_store_dwordx4 a[136:139], v27, s[36:39], s53 offen sc1
  v_mfma_f32_32x32x16_bf16 v[160:175], a[204:207], v[76:79], v[160:175]
  ds_read_b64_tr_b16 a[240:241], v8 offset:12288
  ds_read_b64_tr_b16 a[242:243], v8 offset:14336
  v_exp_f32 v43, v143
  v_add_f32 v30, v30, v40
  v_add_f32 v30, v30, v41
  v_mfma_f32_32x32x16_bf16 v[176:191], a[204:207], v[108:111], v[176:191]
  ds_read_b64_tr_b16 a[244:245], v9 offset:12288
  v_cvt_pk_bf16_f32 v230, v40, v41
  v_exp_f32 v32, v152
  v_mfma_f32_32x32x16_bf16 v[160:175], a[208:211], v[80:83], v[160:175]
  ds_read_b64_tr_b16 a[246:247], v9 offset:14336
  buffer_store_dwordx4 a[140:143], v27, s[36:39], s53 offen offset:1024 sc1
  v_exp_f32 v33, v153
  v_add_f32 v30, v30, v42
  v_mfma_f32_32x32x16_bf16 v[176:191], a[208:211], v[112:115], v[176:191]
  ds_read_b64_tr_b16 a[248:249], v10 offset:12288
  ds_read_b64_tr_b16 a[250:251], v10 offset:14336
  v_add_f32 v30, v30, v43
  v_cvt_pk_bf16_f32 v231, v42, v43
  v_mfma_f32_32x32x16_bf16 v[160:175], a[212:215], v[84:87], v[160:175]
  ds_read_b64_tr_b16 a[252:253], v11 offset:12288
  v_exp_f32 v34, v154
  v_exp_f32 v35, v155
  v_add_f32 v31, v31, v32
  v_mfma_f32_32x32x16_bf16 v[176:191], a[212:215], v[116:119], v[176:191]
  ds_read_b64_tr_b16 a[254:255], v11 offset:14336
  v_add_f32 v31, v31, v33
  v_cvt_pk_bf16_f32 v236, v32, v33
  v_exp_f32 v36, v156
  v_mfma_f32_32x32x16_bf16 v[160:175], a[216:219], v[88:91], v[160:175]
  v_exp_f32 v37, v157
  v_add_f32 v31, v31, v34
  v_add_f32 v31, v31, v35
  v_cvt_pk_bf16_f32 v237, v34, v35
  v_mfma_f32_32x32x16_bf16 v[176:191], a[216:219], v[120:123], v[176:191]
  v_exp_f32 v38, v158
  v_exp_f32 v39, v159
  v_add_f32 v31, v31, v36
  v_mfma_f32_32x32x16_bf16 v[160:175], a[220:223], v[92:95], v[160:175]
  v_add_f32 v31, v31, v37
  v_cvt_pk_bf16_f32 v238, v36, v37
  v_add_f32 v31, v31, v38
  v_add_f32 v31, v31, v39
  v_cvt_pk_bf16_f32 v239, v38, v39
  v_mfma_f32_32x32x16_bf16 v[176:191], a[220:223], v[124:127], v[176:191]
  v_max_f32 v32, v30, v31
  v_cmp_nge_f32 vcc, s50, v32
  s_waitcnt lgkmcnt(0)
  s_nop 0
  s_cbranch_vccz L_ok_2
  s_call_b64 s[60:61], L_slow_0
L_ok_2:
  v_mfma_f32_32x32x16_bf16 a[0:15], a[224:227], v[224:227], a[0:15]
  s_waitcnt vmcnt(8)
  s_barrier
  v_add_f32 v28, v28, v30
  v_add_f32 v29, v29, v31
  v_mfma_f32_32x32x16_bf16 a[16:31], a[224:227], v[232:235], a[16:31]
  ds_read_b128 a[192:195], v12 offset:32768
  v_exp_f32 v32, v160
  v_exp_f32 v33, v161
  v_mfma_f32_32x32x16_bf16 a[32:47], a[228:231], v[224:227], a[32:47]
  ds_read_b128 a[196:199], v13 offset:32768
  v_exp_f32 v34, v162
  v_exp_f32 v35, v163
  v_mfma_f32_32x32x16_bf16 a[48:63], a[228:231], v[232:235], a[48:63]
  ds_read_b128 a[200:203], v14 offset:32768
  v_add_f32 v30, v32, v33
  v_cvt_pk_bf16_f32 v240, v32, v33
  v_exp_f32 v36, v164
  v_mfma_f32_32x32x16_bf16 a[64:79], a[232:235], v[224:227], a[64:79]
  ds_read_b128 a[204:207], v15 offset:32768
  v_exp_f32 v37, v165
  v_add_f32 v30, v30, v34
  v_add_f32 v30, v30, v35
  v_mfma_f32_32x32x16_bf16 a[80:95], a[232:235], v[232:235], a[80:95]
  ds_read_b128 a[208:211], v16 offset:32768
  v_cvt_pk_bf16_f32 v241, v34, v35
  v_exp_f32 v38, v166
  v_mfma_f32_32x32x16_bf16 a[96:111], a[236:239], v[224:227], a[96:111]
  ds_read_b128 a[212:215], v17 offset:32768
  v_exp_f32 v39, v167
  v_add_f32 v30, v30, v36
  v_add_f32 v30, v30, v37
  v_cvt_pk_bf16_f32 v242, v36, v37
  v_mfma_f32_32x32x16_bf16 a[112:127], a[236:239], v[232:235], a[112:127]
  ds_read_b128 a[216:219], v18 offset:32768
  v_exp_f32 v40, v176
  v_exp_f32 v41, v177
  v_mfma_f32_32x32x16_bf16 a[0:15], a[240:243], v[228:231], a[0:15]
  ds_read_b128 a[220:223], v19 offset:32768
  v_add_f32 v30, v30, v38
  v_add_f32 v30, v30, v39
  v_cvt_pk_bf16_f32 v243, v38, v39
  v_mfma_f32_32x32x16_bf16 a[16:31], a[240:243], v[236:239], a[16:31]
  s_add_u32 m0, s55, 0
  s_nop 0
  buffer_load_dwordx4 v24, s[8:11], s56 offen lds
  v_exp_f32 v42, v178
  v_mfma_f32_32x32x16_bf16 a[32:47], a[244:247], v[228:231], a[32:47]
  v_exp_f32 v43, v179
  v_add_f32 v31, v40, v41
  v_cvt_pk_bf16_f32 v248, v40, v41
  v_exp_f32 v32, v180
  v_mfma_f32_32x32x16_bf16 a[48:63], a[244:247], v[236:239], a[48:63]
  v_exp_f32 v33, v181
  v_add_f32 v31, v31, v42
  v_add_f32 v31, v31, v43
  v_cvt_pk_bf16_f32 v249, v42, v43
  v_mfma_f32_32x32x16_bf16 a[64:79], a[248:251], v[228:231], a[64:79]
  buffer_load_dwordx4 v25, s[8:11], s56 offen offset:1024 lds
  v_exp_f32 v34, v182
  v_exp_f32 v35, v183
  v_mfma_f32_32x32x16_bf16 a[80:95], a[248:251], v[236:239], a[80:95]
  v_add_f32 v31, v31, v32
  v_add_f32 v31, v31, v33
  v_cvt_pk_bf16_f32 v250, v32, v33
  v_exp_f32 v36, v168
  v_mfma_f32_32x32x16_bf16 a[96:111], a[252:255], v[228:231], a[96:111]
  v_exp_f32 v37, v169
  v_add_f32 v31, v31, v34
  v_add_f32 v31, v31, v35
  v_mfma_f32_32x32x16_bf16 a[112:127], a[252:255], v[236:239], a[112:127]
  s_waitcnt lgkmcnt(0)
  s_add_u32 s56, s56, 0x2000
  s_and_b32 s56, s56, 0x1ffff
  s_add_u32 m0, s55, 0xe000
  s_nop 0
  buffer_load_dwordx4 v26, s[12:15], s57 offen lds
  v_mfma_f32_32x32x16_bf16 v[128:143], a[192:195], v[64:67], v[192:207]
  ds_read_b64_tr_b16 a[224:225], v8 offset:24576
  ds_read_b64_tr_b16 a[226:227], v8 offset:26624
  v_cvt_pk_bf16_f32 v251, v34, v35
  v_exp_f32 v38, v170
  v_mfma_f32_32x32x16_bf16 v[144:159], a[192:195], v[96:99], v[208:223]
  ds_read_b64_tr_b16 a[228:229], v9 offset:24576
  v_exp_f32 v39, v171
  v_add_f32 v30, v30, v36
  v_add_f32 v30, v30, v37
  v_cvt_pk_bf16_f32 v244, v36, v37
  v_mfma_f32_32x32x16_bf16 v[128:143], a[196:199], v[68:71], v[128:143]
  ds_read_b64_tr_b16 a[230:231], v9 offset:26624
  buffer_load_dwordx4 v26, s[12:15], s57 offen offset:1024 lds
  v_exp_f32 v40, v172
  v_mfma_f32_32x32x16_bf16 v[144:159], a[196:199], v[100:103], v[144:159]
  ds_read_b64_tr_b16 a[232:233], v10 offset:24576
  ds_read_b64_tr_b16 a[234:235], v10 offset:26624
  v_exp_f32 v41, v173
  v_add_f32 v30, v30, v38
  v_mfma_f32_32x32x16_bf16 v[128:143], a[200:203], v[72:75], v[128:143]
  ds_read_b64_tr_b16 a[236:237], v11 offset:24576
  v_add_f32 v30, v30, v39
  v_cvt_pk_bf16_f32 v245, v38, v39
  v_exp_f32 v42, v174
  v_mfma_f32_32x32x16_bf16 v[144:159], a[200:203], v[104:107], v[144:159]
  ds_read_b64_tr_b16 a[238:239], v11 offset:26624
  s_add_u32 s57, s57, 0x2000
  s_and_b32 s57, s57, 0x1ffff
  s_mov_b32 s53, 0x20000
  buffer_store_dwordx4 a[144:147], v27, s[36:39], s53 offen sc1
  v_mfma_f32_32x32x16_bf16 v[128:143], a[204:207], v[76:79], v[128:143]
  ds_read_b64_tr_b16 a[240:241], v8 offset:28672
  ds_read_b64_tr_b16 a[242:243], v8 offset:30720
  v_exp_f32 v43, v175
  v_add_f32 v30, v30, v40
  v_add_f32 v30, v30, v41
  v_mfma_f32_32x32x16_bf16 v[144:159], a[204:207], v[108:111], v[144:159]
  ds_read_b64_tr_b16 a[244:245], v9 offset:28672
  v_cvt_pk_bf16_f32 v246, v40, v41
  v_exp_f32 v32, v184
  v_mfma_f32_32x32x16_bf16 v[128:143], a[208:211], v[80:83], v[128:143]
  ds_read_b64_tr_b16 a[246:247], v9 offset:30720
  buffer_store_dwordx4 a[148:151], v27, s[36:39], s53 offen offset:1024 sc1
  v_exp_f32 v33, v185
  v_add_f32 v30, v30, v42
  v_mfma_f32_32x32x16_bf16 v[144:159], a[208:211], v[112:115], v[144:159]
  ds_read_b64_tr_b16 a[248:249], v10 offset:28672
  ds_read_b64_tr_b16 a[250:251], v10 offset:30720
  v_add_f32 v30, v30, v43
  v_cvt_pk_bf16_f32 v247, v42, v43
  v_mfma_f32_32x32x16_bf16 v[128:143], a[212:215], v[84:87], v[128:143]
  ds_read_b64_tr_b16 a[252:253], v11 offset:28672
  v_exp_f32 v34, v186
  v_exp_f32 v35, v187
  v_add_f32 v31, v31, v32
  v_mfma_f32_32x32x16_bf16 v[144:159], a[212:215], v[116:119], v[144:159]
  ds_read_b64_tr_b16 a[254:255], v11 offset:30720
  v_add_f32 v31, v31, v33
  v_cvt_pk_bf16_f32 v252, v32, v33
  v_exp_f32 v36, v188
  v_mfma_f32_32x32x16_bf16 v[128:143], a[216:219], v[88:91], v[128:143]
  v_exp_f32 v37, v189
  v_add_f32 v31, v31, v34
  v_add_f32 v31, v31, v35
  v_cvt_pk_bf16_f32 v253, v34, v35
  v_mfma_f32_32x32x16_bf16 v[144:159], a[216:219], v[120:123], v[144:159]
  v_exp_f32 v38, v190
  v_exp_f32 v39, v191
  v_add_f32 v31, v31, v36
  v_mfma_f32_32x32x16_bf16 v[128:143], a[220:223], v[92:95], v[128:143]
  v_add_f32 v31, v31, v37
  v_cvt_pk_bf16_f32 v254, v36, v37
  v_add_f32 v31, v31, v38
  v_add_f32 v31, v31, v39
  v_cvt_pk_bf16_f32 v255, v38, v39
  v_mfma_f32_32x32x16_bf16 v[144:159], a[220:223], v[124:127], v[144:159]
  v_max_f32 v32, v30, v31
  v_cmp_nge_f32 vcc, s50, v32
  s_waitcnt lgkmcnt(0)
  s_nop 0
  s_cbranch_vccz L_ok_3
  s_call_b64 s[60:61], L_slow_1
L_ok_3:
  v_mfma_f32_32x32x16_bf16 a[0:15], a[224:227], v[240:243], a[0:15]
  s_waitcnt vmcnt(8)
  s_barrier
  v_add_f32 v28, v28, v30
  v_add_f32 v29, v29, v31
  v_mfma_f32_32x32x16_bf16 a[16:31], a[224:227], v[248:251], a[16:31]
  ds_read_b128 a[192:195], v12 offset:49152
  v_exp_f32 v32, v128
  v_exp_f32 v33, v129
  v_mfma_f32_32x32x16_bf16 a[32:47], a[228:231], v[240:243], a[32:47]
  ds_read_b128 a[196:199], v13 offset:49152
  v_exp_f32 v34, v130
  v_exp_f32 v35, v131
  v_mfma_f32_32x32x16_bf16 a[48:63], a[228:231], v[248:251], a[48:63]
  ds_read_b128 a[200:203], v14 offset:49152
  v_add_f32 v30, v32, v33
  v_cvt_pk_bf16_f32 v224, v32, v33
  v_exp_f32 v36, v132
  v_mfma_f32_32x32x16_bf16 a[64:79], a[232:235], v[240:243], a[64:79]
  ds_read_b128 a[204:207], v15 offset:49152
  v_exp_f32 v37, v133
  v_add_f32 v30, v30, v34
  v_add_f32 v30, v30, v35
  v_mfma_f32_32x32x16_bf16 a[80:95], a[232:235], v[248:251], a[80:95]
  ds_read_b128 a[208:211], v16 offset:49152
  v_cvt_pk_bf16_f32 v225, v34, v35
  v_exp_f32 v38, v134
  v_mfma_f32_32x32x16_bf16 a[96:111], a[236:239], v[240:243], a[96:111]
  ds_read_b128 a[212:215], v17 offset:49152
  v_exp_f32 v39, v135
  v_add_f32 v30, v30, v36
  v_add_f32 v30, v30, v37
  v_cvt_pk_bf16_f32 v226, v36, v37
  v_mfma_f32_32x32x16_bf16 a[112:127], a[236:239], v[248:251], a[112:127]
  ds_read_b128 a[216:219], v18 offset:49152
  v_exp_f32 v40, v144
  v_exp_f32 v41, v145
  v_mfma_f32_32x32x16_bf16 a[0:15], a[240:243], v[244:247], a[0:15]
  ds_read_b128 a[220:223], v19 offset:49152
  v_add_f32 v30, v30, v38
  v_add_f32 v30, v30, v39
  v_cvt_pk_bf16_f32 v227, v38, v39
  v_mfma_f32_32x32x16_bf16 a[16:31], a[240:243], v[252:255], a[16:31]
  s_add_u32 m0, s55, 0x4000
  s_nop 0
  buffer_load_dwordx4 v24, s[8:11], s56 offen lds
  v_exp_f32 v42, v146
  v_mfma_f32_32x32x16_bf16 a[32:47], a[244:247], v[244:247], a[32:47]
  v_exp_f32 v43, v147
  v_add_f32 v31, v40, v41
  v_cvt_pk_bf16_f32 v232, v40, v41
  v_exp_f32 v32, v148
  v_mfma_f32_32x32x16_bf16 a[48:63], a[244:247], v[252:255], a[48:63]
  v_exp_f32 v33, v149
  v_add_f32 v31, v31, v42
  v_add_f32 v31, v31, v43
  v_cvt_pk_bf16_f32 v233, v42, v43
  v_mfma_f32_32x32x16_bf16 a[64:79], a[248:251], v[244:247], a[64:79]
  buffer_load_dwordx4 v25, s[8:11], s56 offen offset:1024 lds
  v_exp_f32 v34, v150
  v_exp_f32 v35, v151
  v_mfma_f32_32x32x16_bf16 a[80:95], a[248:251], v[252:255], a[80:95]
  v_add_f32 v31, v31, v32
  v_add_f32 v31, v31, v33
  v_cvt_pk_bf16_f32 v234, v32, v33
  v_exp_f32 v36, v136
  v_mfma_f32_32x32x16_bf16 a[96:111], a[252:255], v[244:247], a[96:111]
  v_exp_f32 v37, v137
  v_add_f32 v31, v31, v34
  v_add_f32 v31, v31, v35
  v_mfma_f32_32x32x16_bf16 a[112:127], a[252:255], v[252:255], a[112:127]
  s_waitcnt lgkmcnt(0)
  s_add_u32 s56, s56, 0x2000
  s_and_b32 s56, s56, 0x1ffff
  s_add_u32 m0, s55, 0x2000
  s_nop 0
  buffer_load_dwordx4 v26, s[12:15], s57 offen lds
  v_mfma_f32_32x32x16_bf16 v[160:175], a[192:195], v[64:67], v[192:207]
  ds_read_b64_tr_b16 a[224:225], v8 offset:40960
  ds_read_b64_tr_b16 a[226:227], v8 offset:43008
  v_cvt_pk_bf16_f32 v235, v34, v35
  v_exp_f32 v38, v138
  v_mfma_f32_32x32x16_bf16 v[176:191], a[192:195], v[96:99], v[208:223]
  ds_read_b64_tr_b16 a[228:229], v9 offset:40960
  v_exp_f32 v39, v139
  v_add_f32 v30, v30, v36
  v_add_f32 v30, v30, v37
  v_cvt_pk_bf16_f32 v228, v36, v37
  v_mfma_f32_32x32x16_bf16 v[160:175], a[196:199], v[68:71], v[160:175]
  ds_read_b64_tr_b16 a[230:231], v9 offset:43008
  buffer_load_dwordx4 v26, s[12:15], s57 offen offset:1024 lds
  v_exp_f32 v40, v140
  v_mfma_f32_32x32x16_bf16 v[176:191], a[196:199], v[100:103], v[176:191]
  ds_read_b64_tr_b16 a[232:233], v10 offset:40960
  ds_read_b64_tr_b16 a[234:235], v10 offset:43008
  v_exp_f32 v41, v141
  v_add_f32 v30, v30, v38
  v_mfma_f32_32x32x16_bf16 v[160:175], a[200:203], v[72:75], v[160:175]
  ds_read_b64_tr_b16 a[236:237], v11 offset:40960
  v_add_f32 v30, v30, v39
  v_cvt_pk_bf16_f32 v229, v38, v39
  v_exp_f32 v42, v142
  v_mfma_f32_32x32x16_bf16 v[176:191], a[200:203], v[104:107], v[176:191]
  ds_read_b64_tr_b16 a[238:239], v11 offset:43008
  s_add_u32 s57, s57, 0x2000
  s_and_b32 s57, s57, 0x1ffff
  s_mov_b32 s53, 0x30000
  buffer_store_dwordx4 a[152:155], v27, s[36:39], s53 offen sc1
  v_mfma_f32_32x32x16_bf16 v[160:175], a[204:207], v[76:79], v[160:175]
  ds_read_b64_tr_b16 a[240:241], v8 offset:45056
  ds_read_b64_tr_b16 a[242:243], v8 offset:47104
  v_exp_f32 v43, v143
  v_add_f32 v30, v30, v40
  v_add_f32 v30, v30, v41
  v_mfma_f32_32x32x16_bf16 v[176:191], a[204:207], v[108:111], v[176:191]
  ds_read_b64_tr_b16 a[244:245], v9 offset:45056
  v_cvt_pk_bf16_f32 v230, v40, v41
  v_exp_f32 v32, v152
  v_mfma_f32_32x32x16_bf16 v[160:175], a[208:211], v[80:83], v[160:175]
  ds_read_b64_tr_b16 a[246:247], v9 offset:47104
  buffer_store_dwordx4 a[156:159], v27, s[36:39], s53 offen offset:1024 sc1
  v_exp_f32 v33, v153
  v_add_f32 v30, v30, v42
  v_mfma_f32_32x32x16_bf16 v[176:191], a[208:211], v[112:115], v[176:191]
  ds_read_b64_tr_b16 a[248:249], v10 offset:45056
  ds_read_b64_tr_b16 a[250:251], v10 offset:47104
  v_add_f32 v30, v30, v43
  v_cvt_pk_bf16_f32 v231, v42, v43
  v_mfma_f32_32x32x16_bf16 v[160:175], a[212:215], v[84:87], v[160:175]
  ds_read_b64_tr_b16 a[252:253], v11 offset:45056
  v_exp_f32 v34, v154
  v_exp_f32 v35, v155
  v_add_f32 v31, v31, v32
  v_mfma_f32_32x32x16_bf16 v[176:191], a[212:215], v[116:119], v[176:191]
  ds_read_b64_tr_b16 a[254:255], v11 offset:47104
  v_add_f32 v31, v31, v33
  v_cvt_pk_bf16_f32 v236, v32, v33
  v_exp_f32 v36, v156
  v_mfma_f32_32x32x16_bf16 v[160:175], a[216:219], v[88:91], v[160:175]
  v_exp_f32 v37, v157
  v_add_f32 v31, v31, v34
  v_add_f32 v31, v31, v35
  v_cvt_pk_bf16_f32 v237, v34, v35
  v_mfma_f32_32x32x16_bf16 v[176:191], a[216:219], v[120:123], v[176:191]
  v_exp_f32 v38, v158
  v_exp_f32 v39, v159
  v_add_f32 v31, v31, v36
  v_mfma_f32_32x32x16_bf16 v[160:175], a[220:223], v[92:95], v[160:175]
  v_add_f32 v31, v31, v37
  v_cvt_pk_bf16_f32 v238, v36, v37
  v_add_f32 v31, v31, v38
  v_add_f32 v31, v31, v39
  v_cvt_pk_bf16_f32 v239, v38, v39
  v_mfma_f32_32x32x16_bf16 v[176:191], a[220:223], v[124:127], v[176:191]
  v_max_f32 v32, v30, v31
  v_cmp_nge_f32 vcc, s50, v32
  s_waitcnt lgkmcnt(0)
  s_nop 0
  s_cbranch_vccz L_ok_4
  s_call_b64 s[60:61], L_slow_0
L_ok_4:
  v_mfma_f32_32x32x16_bf16 a[0:15], a[224:227], v[224:227], a[0:15]
  s_waitcnt vmcnt(8)
  s_barrier
  v_add_f32 v28, v28, v30
  v_add_f32 v29, v29, v31
  v_mfma_f32_32x32x16_bf16 a[16:31], a[224:227], v[232:235], a[16:31]
  ds_read_b128 a[192:195], v12
  v_exp_f32 v32, v160
  v_exp_f32 v33, v161
  v_mfma_f32_32x32x16_bf16 a[32:47], a[228:231], v[224:227], a[32:47]
  ds_read_b128 a[196:199], v13
  v_exp_f32 v34, v162
  v_exp_f32 v35, v163
  v_mfma_f32_32x32x16_bf16 a[48:63], a[228:231], v[232:235], a[48:63]
  ds_read_b128 a[200:203], v14
  v_add_f32 v30, v32, v33
  v_cvt_pk_bf16_f32 v240, v32, v33
  v_exp_f32 v36, v164
  v_mfma_f32_32x32x16_bf16 a[64:79], a[232:235], v[224:227], a[64:79]
  ds_read_b128 a[204:207], v15
  v_exp_f32 v37, v165
  v_add_f32 v30, v30, v34
  v_add_f32 v30, v30, v35
  v_mfma_f32_32x32x16_bf16 a[80:95], a[232:235], v[232:235], a[80:95]
  ds_read_b128 a[208:211], v16
  v_cvt_pk_bf16_f32 v241, v34, v35
  v_exp_f32 v38, v166
  v_mfma_f32_32x32x16_bf16 a[96:111], a[236:239], v[224:227], a[96:111]
  ds_read_b128 a[212:215], v17
  v_exp_f32 v39, v167
  v_add_f32 v30, v30, v36
  v_add_f32 v30, v30, v37
  v_cvt_pk_bf16_f32 v242, v36, v37
  v_mfma_f32_32x32x16_bf16 a[112:127], a[236:239], v[232:235], a[112:127]
  ds_read_b128 a[216:219], v18
  v_exp_f32 v40, v176
  v_exp_f32 v41, v177
  v_mfma_f32_32x32x16_bf16 a[0:15], a[240:243], v[228:231], a[0:15]
  ds_read_b128 a[220:223], v19
  v_add_f32 v30, v30, v38
  v_add_f32 v30, v30, v39
  v_cvt_pk_bf16_f32 v243, v38, v39
  v_mfma_f32_32x32x16_bf16 a[16:31], a[240:243], v[236:239], a[16:31]
  s_add_u32 m0, s55, 0x8000
  s_nop 0
  buffer_load_dwordx4 v24, s[8:11], s56 offen lds
  v_exp_f32 v42, v178
  v_mfma_f32_32x32x16_bf16 a[32:47], a[244:247], v[228:231], a[32:47]
  v_exp_f32 v43, v179
  v_add_f32 v31, v40, v41
  v_cvt_pk_bf16_f32 v248, v40, v41
  v_exp_f32 v32, v180
  v_mfma_f32_32x32x16_bf16 a[48:63], a[244:247], v[236:239], a[48:63]
  v_exp_f32 v33, v181
  v_add_f32 v31, v31, v42
  v_add_f32 v31, v31, v43
  v_cvt_pk_bf16_f32 v249, v42, v43
  v_mfma_f32_32x32x16_bf16 a[64:79], a[248:251], v[228:231], a[64:79]
  buffer_load_dwordx4 v25, s[8:11], s56 offen offset:1024 lds
  v_exp_f32 v34, v182
  v_exp_f32 v35, v183
  v_mfma_f32_32x32x16_bf16 a[80:95], a[248:251], v[236:239], a[80:95]
  v_add_f32 v31, v31, v32
  v_add_f32 v31, v31, v33
  v_cvt_pk_bf16_f32 v250, v32, v33
  v_exp_f32 v36, v168
  v_mfma_f32_32x32x16_bf16 a[96:111], a[252:255], v[228:231], a[96:111]
  v_exp_f32 v37, v169
  v_add_f32 v31, v31, v34
  v_add_f32 v31, v31, v35
  v_mfma_f32_32x32x16_bf16 a[112:127], a[252:255], v[236:239], a[112:127]
  s_waitcnt lgkmcnt(0)
  s_add_u32 s56, s56, 0x2000
  s_and_b32 s56, s56, 0x1ffff
  s_add_u32 m0, s55, 0x6000
  s_nop 0
  buffer_load_dwordx4 v26, s[12:15], s57 offen lds
  v_mfma_f32_32x32x16_bf16 v[128:143], a[192:195], v[64:67], v[192:207]
  ds_read_b64_tr_b16 a[224:225], v8 offset:57344
  ds_read_b64_tr_b16 a[226:227], v8 offset:59392
  v_cvt_pk_bf16_f32 v251, v34, v35
  v_exp_f32 v38, v170
  v_mfma_f32_32x32x16_bf16 v[144:159], a[192:195], v[96:99], v[208:223]
  ds_read_b64_tr_b16 a[228:229], v9 offset:57344
  v_exp_f32 v39, v171
  v_add_f32 v30, v30, v36
  v_add_f32 v30, v30, v37
  v_cvt_pk_bf16_f32 v244, v36, v37
  v_mfma_f32_32x32x16_bf16 v[128:143], a[196:199], v[68:71], v[128:143]
  ds_read_b64_tr_b16 a[230:231], v9 offset:59392
  buffer_load_dwordx4 v26, s[12:15], s57 offen offset:1024 lds
  v_exp_f32 v40, v172
  v_mfma_f32_32x32x16_bf16 v[144:159], a[196:199], v[100:103], v[144:159]
  ds_read_b64_tr_b16 a[232:233], v10 offset:57344
  ds_read_b64_tr_b16 a[234:235], v10 offset:59392
  v_exp_f32 v41, v173
  v_add_f32 v30, v30, v38
  v_mfma_f32_32x32x16_bf16 v[128:143], a[200:203], v[72:75], v[128:143]
  ds_read_b64_tr_b16 a[236:237], v11 offset:57344
  v_add_f32 v30, v30, v39
  v_cvt_pk_bf16_f32 v245, v38, v39
  v_exp_f32 v42, v174
  v_mfma_f32_32x32x16_bf16 v[144:159], a[200:203], v[104:107], v[144:159]
  ds_read_b64_tr_b16 a[238:239], v11 offset:59392
  s_add_u32 s57, s57, 0x2000
  s_and_b32 s57, s57, 0x1ffff
  s_mov_b32 s53, 0x40000
  buffer_store_dwordx4 a[160:163], v27, s[36:39], s53 offen sc1
  v_mfma_f32_32x32x16_bf16 v[128:143], a[204:207], v[76:79], v[128:143]
  ds_read_b64_tr_b16 a[240:241], v8 offset:61440
  ds_read_b64_tr_b16 a[242:243], v8 offset:63488
  v_exp_f32 v43, v175
  v_add_f32 v30, v30, v40
  v_add_f32 v30, v30, v41
  v_mfma_f32_32x32x16_bf16 v[144:159], a[204:207], v[108:111], v[144:159]
  ds_read_b64_tr_b16 a[244:245], v9 offset:61440
  v_cvt_pk_bf16_f32 v246, v40, v41
  v_exp_f32 v32, v184
  v_mfma_f32_32x32x16_bf16 v[128:143], a[208:211], v[80:83], v[128:143]
  ds_read_b64_tr_b16 a[246:247], v9 offset:63488
  buffer_store_dwordx4 a[164:167], v27, s[36:39], s53 offen offset:1024 sc1
  v_exp_f32 v33, v185
  v_add_f32 v30, v30, v42
  v_mfma_f32_32x32x16_bf16 v[144:159], a[208:211], v[112:115], v[144:159]
  ds_read_b64_tr_b16 a[248:249], v10 offset:61440
  ds_read_b64_tr_b16 a[250:251], v10 offset:63488
  v_add_f32 v30, v30, v43
  v_cvt_pk_bf16_f32 v247, v42, v43
  v_mfma_f32_32x32x16_bf16 v[128:143], a[212:215], v[84:87], v[128:143]
  ds_read_b64_tr_b16 a[252:253], v11 offset:61440
  v_exp_f32 v34, v186
  v_exp_f32 v35, v187
  v_add_f32 v31, v31, v32
  v_mfma_f32_32x32x16_bf16 v[144:159], a[212:215], v[116:119], v[144:159]
  ds_read_b64_tr_b16 a[254:255], v11 offset:63488
  v_add_f32 v31, v31, v33
  v_cvt_pk_bf16_f32 v252, v32, v33
  v_exp_f32 v36, v188
  v_mfma_f32_32x32x16_bf16 v[128:143], a[216:219], v[88:91], v[128:143]
  v_exp_f32 v37, v189
  v_add_f32 v31, v31, v34
  v_add_f32 v31, v31, v35
  v_cvt_pk_bf16_f32 v253, v34, v35
  v_mfma_f32_32x32x16_bf16 v[144:159], a[216:219], v[120:123], v[144:159]
  v_exp_f32 v38, v190
  v_exp_f32 v39, v191
  v_add_f32 v31, v31, v36
  v_mfma_f32_32x32x16_bf16 v[128:143], a[220:223], v[92:95], v[128:143]
  v_add_f32 v31, v31, v37
  v_cvt_pk_bf16_f32 v254, v36, v37
  v_add_f32 v31, v31, v38
  v_add_f32 v31, v31, v39
  v_cvt_pk_bf16_f32 v255, v38, v39
  v_mfma_f32_32x32x16_bf16 v[144:159], a[220:223], v[124:127], v[144:159]
  v_max_f32 v32, v30, v31
  v_cmp_nge_f32 vcc, s50, v32
  s_waitcnt lgkmcnt(0)
  s_nop 0
  s_cbranch_vccz L_ok_5
  s_call_b64 s[60:61], L_slow_1
L_ok_5:
  v_mov_b32 v61, 0
  v_mfma_f32_32x32x16_bf16 a[0:15], a[224:227], v[240:243], a[0:15]
  s_waitcnt vmcnt(8)
  s_barrier
  v_add_f32 v28, v28, v30
  v_add_f32 v29, v29, v31
  v_mfma_f32_32x32x16_bf16 a[16:31], a[224:227], v[248:251], a[16:31]
  ds_read_b128 a[192:195], v12 offset:16384
  v_exp_f32 v32, v128
  v_exp_f32 v33, v129
  v_mfma_f32_32x32x16_bf16 a[32:47], a[228:231], v[240:243], a[32:47]
  ds_read_b128 a[196:199], v13 offset:16384
  v_exp_f32 v34, v130
  v_exp_f32 v35, v131
  v_mfma_f32_32x32x16_bf16 a[48:63], a[228:231], v[248:251], a[48:63]
  ds_read_b128 a[200:203], v14 offset:16384
  v_add_f32 v30, v32, v33
  v_cvt_pk_bf16_f32 v224, v32, v33
  v_exp_f32 v36, v132
  v_mfma_f32_32x32x16_bf16 a[64:79], a[232:235], v[240:243], a[64:79]
  ds_read_b128 a[204:207], v15 offset:16384
  v_exp_f32 v37, v133
  v_add_f32 v30, v30, v34
  v_add_f32 v30, v30, v35
  v_mfma_f32_32x32x16_bf16 a[80:95], a[232:235], v[248:251], a[80:95]
  ds_read_b128 a[208:211], v16 offset:16384
  v_cvt_pk_bf16_f32 v225, v34, v35
  v_exp_f32 v38, v134
  v_exp_f32 v39, v135
  v_mfma_f32_32x32x16_bf16 a[96:111], a[236:239], v[240:243], a[96:111]
  ds_read_b128 a[212:215], v17 offset:16384
  v_add_f32 v30, v30, v36
  v_add_f32 v30, v30, v37
  v_cvt_pk_bf16_f32 v226, v36, v37
  v_mfma_f32_32x32x16_bf16 a[112:127], a[236:239], v[248:251], a[112:127]
  ds_read_b128 a[216:219], v18 offset:16384
  v_exp_f32 v40, v144
  v_exp_f32 v41, v145
  v_add_f32 v30, v30, v38
  v_mfma_f32_32x32x16_bf16 a[0:15], a[240:243], v[244:247], a[0:15]
  ds_read_b128 a[220:223], v19 offset:16384
  v_add_f32 v30, v30, v39
  v_cvt_pk_bf16_f32 v227, v38, v39
  v_exp_f32 v42, v146
  v_mfma_f32_32x32x16_bf16 a[16:31], a[240:243], v[252:255], a[16:31]
  s_add_u32 m0, s55, 0xc000
  s_nop 0
  buffer_load_dwordx4 v24, s[8:11], s56 offen lds
  v_exp_f32 v43, v147
  v_mfma_f32_32x32x16_bf16 a[32:47], a[244:247], v[244:247], a[32:47]
  v_add_f32 v31, v40, v41
  v_cvt_pk_bf16_f32 v232, v40, v41
  v_exp_f32 v32, v148
  v_mfma_f32_32x32x16_bf16 a[48:63], a[244:247], v[252:255], a[48:63]
  v_exp_f32 v33, v149
  v_add_f32 v31, v31, v42
  v_add_f32 v31, v31, v43
  v_cvt_pk_bf16_f32 v233, v42, v43
  v_mfma_f32_32x32x16_bf16 a[64:79], a[248:251], v[244:247], a[64:79]
  buffer_load_dwordx4 v25, s[8:11], s56 offen offset:1024 lds
  v_exp_f32 v34, v150
  v_exp_f32 v35, v151
  v_mfma_f32_32x32x16_bf16 a[80:95], a[248:251], v[252:255], a[80:95]
  v_add_f32 v31, v31, v32
  v_add_f32 v31, v31, v33
  v_cvt_pk_bf16_f32 v234, v32, v33
  v_exp_f32 v36, v136
  v_mfma_f32_32x32x16_bf16 a[96:111], a[252:255], v[244:247], a[96:111]
  v_exp_f32 v37, v137
  v_add_f32 v31, v31, v34
  v_add_f32 v31, v31, v35
  v_cvt_pk_bf16_f32 v235, v34, v35
  v_mfma_f32_32x32x16_bf16 a[112:127], a[252:255], v[252:255], a[112:127]
  s_waitcnt lgkmcnt(0)
  s_add_u32 s56, s56, 0x2000
  s_and_b32 s56, s56, 0x1ffff
  s_add_u32 m0, s55, 0xa000
  s_nop 0
  buffer_load_dwordx4 v26, s[12:15], s57 offen lds
  v_mfma_f32_32x32x16_bf16 v[160:175], a[192:195], v[64:67], v[192:207]
  ds_read_b64_tr_b16 a[224:225], v8 offset:8192
  ds_read_b64_tr_b16 a[226:227], v8 offset:10240
  v_exp_f32 v38, v138
  v_exp_f32 v39, v139
  v_mfma_f32_32x32x16_bf16 v[176:191], a[192:195], v[96:99], v[208:223]
  ds_read_b64_tr_b16 a[228:229], v9 offset:8192
  v_add_f32 v30, v30, v36
  v_add_f32 v30, v30, v37
  v_cvt_pk_bf16_f32 v228, v36, v37
  v_mfma_f32_32x32x16_bf16 v[160:175], a[196:199], v[68:71], v[160:175]
  ds_read_b64_tr_b16 a[230:231], v9 offset:10240
  buffer_load_dwordx4 v26, s[12:15], s57 offen offset:1024 lds
  v_exp_f32 v40, v140
  v_mfma_f32_32x32x16_bf16 v[176:191], a[196:199], v[100:103], v[176:191]
  ds_read_b64_tr_b16 a[232:233], v10 offset:8192
  ds_read_b64_tr_b16 a[234:235], v10 offset:10240
  v_exp_f32 v41, v141
  v_add_f32 v30, v30, v38
  v_add_f32 v30, v30, v39
  v_mfma_f32_32x32x16_bf16 v[160:175], a[200:203], v[72:75], v[160:175]
  ds_read_b64_tr_b16 a[236:237], v11 offset:8192
  v_cvt_pk_bf16_f32 v229, v38, v39
  v_exp_f32 v42, v142
  v_exp_f32 v43, v143
  v_mfma_f32_32x32x16_bf16 v[176:191], a[200:203], v[104:107], v[176:191]
  ds_read_b64_tr_b16 a[238:239], v11 offset:10240
  s_add_u32 s57, s57, 0x2000
  s_and_b32 s57, s57, 0x1ffff
  s_mov_b32 s53, 0x50000
  buffer_store_dwordx4 a[168:171], v27, s[36:39], s53 offen sc1
  v_mfma_f32_32x32x16_bf16 v[160:175], a[204:207], v[76:79], v[160:175]
  ds_read_b64_tr_b16 a[240:241], v8 offset:12288
  ds_read_b64_tr_b16 a[242:243], v8 offset:14336
  v_add_f32 v30, v30, v40
  v_add_f32 v30, v30, v41
  v_cvt_pk_bf16_f32 v230, v40, v41
  v_mfma_f32_32x32x16_bf16 v[176:191], a[204:207], v[108:111], v[176:191]
  ds_read_b64_tr_b16 a[244:245], v9 offset:12288
  v_exp_f32 v32, v152
  v_exp_f32 v33, v153
  v_mfma_f32_32x32x16_bf16 v[160:175], a[208:211], v[80:83], v[160:175]
  ds_read_b64_tr_b16 a[246:247], v9 offset:14336
  buffer_store_dwordx4 a[172:175], v27, s[36:39], s53 offen offset:1024 sc1
  v_add_f32 v30, v30, v42
  v_add_f32 v30, v30, v43
  v_mfma_f32_32x32x16_bf16 v[176:191], a[208:211], v[112:115], v[176:191]
  ds_read_b64_tr_b16 a[248:249], v10 offset:12288
  ds_read_b64_tr_b16 a[250:251], v10 offset:14336
  v_cvt_pk_bf16_f32 v231, v42, v43
  v_exp_f32 v34, v154
  v_mfma_f32_32x32x16_bf16 v[160:175], a[212:215], v[84:87], v[160:175]
  ds_read_b64_tr_b16 a[252:253], v11 offset:12288
  v_exp_f32 v35, v155
  v_add_f32 v31, v31, v32
  v_add_f32 v31, v31, v33
  v_cvt_pk_bf16_f32 v236, v32, v33
  v_mfma_f32_32x32x16_bf16 v[176:191], a[212:215], v[116:119], v[176:191]
  ds_read_b64_tr_b16 a[254:255], v11 offset:14336
  buffer_load_dword v61, v61, s[68:71], 0 offen sc1
  v_exp_f32 v36, v156
  v_mfma_f32_32x32x16_bf16 v[160:175], a[216:219], v[88:91], v[160:175]
  v_exp_f32 v37, v157
  v_add_f32 v31, v31, v34
  v_add_f32 v31, v31, v35
  v_cvt_pk_bf16_f32 v237, v34, v35
  v_mfma_f32_32x32x16_bf16 v[176:191], a[216:219], v[120:123], v[176:191]
  v_exp_f32 v38, v158
  v_exp_f32 v39, v159
  v_add_f32 v31, v31, v36
  v_mfma_f32_32x32x16_bf16 v[160:175], a[220:223], v[92:95], v[160:175]
  v_add_f32 v31, v31, v37
  v_cvt_pk_bf16_f32 v238, v36, v37
  v_add_f32 v31, v31, v38
  v_add_f32 v31, v31, v39
  v_cvt_pk_bf16_f32 v239, v38, v39
  v_mfma_f32_32x32x16_bf16 v[176:191], a[220:223], v[124:127], v[176:191]
  v_max_f32 v32, v30, v31
  v_cmp_nge_f32 vcc, s50, v32
  s_waitcnt lgkmcnt(0)
  s_nop 0
  s_cbranch_vccz L_ok_6
  s_call_b64 s[60:61], L_slow_0
L_ok_6:
  v_mfma_f32_32x32x16_bf16 a[0:15], a[224:227], v[224:227], a[0:15]
  s_waitcnt vmcnt(9)
  s_barrier
  v_add_f32 v28, v28, v30
  v_add_f32 v29, v29, v31
  v_mfma_f32_32x32x16_bf16 a[16:31], a[224:227], v[232:235], a[16:31]
  ds_read_b128 a[192:195], v12 offset:32768
  v_exp_f32 v32, v160
  v_exp_f32 v33, v161
  v_mfma_f32_32x32x16_bf16 a[32:47], a[228:231], v[224:227], a[32:47]
  ds_read_b128 a[196:199], v13 offset:32768
  v_exp_f32 v34, v162
  v_exp_f32 v35, v163
  v_mfma_f32_32x32x16_bf16 a[48:63], a[228:231], v[232:235], a[48:63]
  ds_read_b128 a[200:203], v14 offset:32768
  v_add_f32 v30, v32, v33
  v_cvt_pk_bf16_f32 v240, v32, v33
  v_exp_f32 v36, v164
  v_mfma_f32_32x32x16_bf16 a[64:79], a[232:235], v[224:227], a[64:79]
  ds_read_b128 a[204:207], v15 offset:32768
  v_exp_f32 v37, v165
  v_add_f32 v30, v30, v34
  v_add_f32 v30, v30, v35
  v_mfma_f32_32x32x16_bf16 a[80:95], a[232:235], v[232:235], a[80:95]
  ds_read_b128 a[208:211], v16 offset:32768
  v_cvt_pk_bf16_f32 v241, v34, v35
  v_exp_f32 v38, v166
  v_mfma_f32_32x32x16_bf16 a[96:111], a[236:239], v[224:227], a[96:111]
  ds_read_b128 a[212:215], v17 offset:32768
  v_exp_f32 v39, v167
  v_add_f32 v30, v30, v36
  v_add_f32 v30, v30, v37
  v_cvt_pk_bf16_f32 v242, v36, v37
  v_mfma_f32_32x32x16_bf16 a[112:127], a[236:239], v[232:235], a[112:127]
  ds_read_b128 a[216:219], v18 offset:32768
  v_exp_f32 v40, v176
  v_exp_f32 v41, v177
  v_mfma_f32_32x32x16_bf16 a[0:15], a[240:243], v[228:231], a[0:15]
  ds_read_b128 a[220:223], v19 offset:32768
  v_add_f32 v30, v30, v38
  v_add_f32 v30, v30, v39
  v_cvt_pk_bf16_f32 v243, v38, v39
  v_mfma_f32_32x32x16_bf16 a[16:31], a[240:243], v[236:239], a[16:31]
  s_add_u32 m0, s55, 0
  s_nop 0
  buffer_load_dwordx4 v24, s[8:11], s56 offen lds
  v_exp_f32 v42, v178
  v_mfma_f32_32x32x16_bf16 a[32:47], a[244:247], v[228:231], a[32:47]
  v_exp_f32 v43, v179
  v_add_f32 v31, v40, v41
  v_cvt_pk_bf16_f32 v248, v40, v41
  v_exp_f32 v32, v180
  v_mfma_f32_32x32x16_bf16 a[48:63], a[244:247], v[236:239], a[48:63]
  v_exp_f32 v33, v181
  v_add_f32 v31, v31, v42
  v_add_f32 v31, v31, v43
  v_cvt_pk_bf16_f32 v249, v42, v43
  v_mfma_f32_32x32x16_bf16 a[64:79], a[248:251], v[228:231], a[64:79]
  buffer_load_dwordx4 v25, s[8:11], s56 offen offset:1024 lds
  v_exp_f32 v34, v182
  v_exp_f32 v35, v183
  v_mfma_f32_32x32x16_bf16 a[80:95], a[248:251], v[236:239], a[80:95]
  v_add_f32 v31, v31, v32
  v_add_f32 v31, v31, v33
  v_cvt_pk_bf16_f32 v250, v32, v33
  v_exp_f32 v36, v168
  v_mfma_f32_32x32x16_bf16 a[96:111], a[252:255], v[228:231], a[96:111]
  v_exp_f32 v37, v169
  v_add_f32 v31, v31, v34
  v_add_f32 v31, v31, v35
  v_mfma_f32_32x32x16_bf16 a[112:127], a[252:255], v[236:239], a[112:127]
  s_waitcnt lgkmcnt(0)
  s_add_u32 s56, s56, 0x2000
  s_and_b32 s56, s56, 0x1ffff
  s_add_u32 m0, s55, 0xe000
  s_nop 0
  buffer_load_dwordx4 v26, s[12:15], s57 offen lds
  v_mfma_f32_32x32x16_bf16 v[128:143], a[192:195], v[64:67], v[192:207]
  ds_read_b64_tr_b16 a[224:225], v8 offset:24576
  ds_read_b64_tr_b16 a[226:227], v8 offset:26624
  v_cvt_pk_bf16_f32 v251, v34, v35
  v_exp_f32 v38, v170
  v_mfma_f32_32x32x16_bf16 v[144:159], a[192:195], v[96:99], v[208:223]
  ds_read_b64_tr_b16 a[228:229], v9 offset:24576
  v_exp_f32 v39, v171
  v_add_f32 v30, v30, v36
  v_add_f32 v30, v30, v37
  v_cvt_pk_bf16_f32 v244, v36, v37
  v_mfma_f32_32x32x16_bf16 v[128:143], a[196:199], v[68:71], v[128:143]
  ds_read_b64_tr_b16 a[230:231], v9 offset:26624
  buffer_load_dwordx4 v26, s[12:15], s57 offen offset:1024 lds
  v_exp_f32 v40, v172
  v_mfma_f32_32x32x16_bf16 v[144:159], a[196:199], v[100:103], v[144:159]
  ds_read_b64_tr_b16 a[232:233], v10 offset:24576
  ds_read_b64_tr_b16 a[234:235], v10 offset:26624
  v_exp_f32 v41, v173
  v_add_f32 v30, v30, v38
  v_mfma_f32_32x32x16_bf16 v[128:143], a[200:203], v[72:75], v[128:143]
  ds_read_b64_tr_b16 a[236:237], v11 offset:24576
  v_add_f32 v30, v30, v39
  v_cvt_pk_bf16_f32 v245, v38, v39
  v_exp_f32 v42, v174
  v_mfma_f32_32x32x16_bf16 v[144:159], a[200:203], v[104:107], v[144:159]
  ds_read_b64_tr_b16 a[238:239], v11 offset:26624
  s_add_u32 s57, s57, 0x2000
  s_and_b32 s57, s57, 0x1ffff
  s_mov_b32 s53, 0x60000
  buffer_store_dwordx4 a[176:179], v27, s[36:39], s53 offen sc1
  v_mfma_f32_32x32x16_bf16 v[128:143], a[204:207], v[76:79], v[128:143]
  ds_read_b64_tr_b16 a[240:241], v8 offset:28672
  ds_read_b64_tr_b16 a[242:243], v8 offset:30720
  v_exp_f32 v43, v175
  v_add_f32 v30, v30, v40
  v_add_f32 v30, v30, v41
  v_mfma_f32_32x32x16_bf16 v[144:159], a[204:207], v[108:111], v[144:159]
  ds_read_b64_tr_b16 a[244:245], v9 offset:28672
  v_cvt_pk_bf16_f32 v246, v40, v41
  v_exp_f32 v32, v184
  v_mfma_f32_32x32x16_bf16 v[128:143], a[208:211], v[80:83], v[128:143]
  ds_read_b64_tr_b16 a[246:247], v9 offset:30720
  buffer_store_dwordx4 a[180:183], v27, s[36:39], s53 offen offset:1024 sc1
  v_exp_f32 v33, v185
  v_add_f32 v30, v30, v42
  v_mfma_f32_32x32x16_bf16 v[144:159], a[208:211], v[112:115], v[144:159]
  ds_read_b64_tr_b16 a[248:249], v10 offset:28672
  ds_read_b64_tr_b16 a[250:251], v10 offset:30720
  v_add_f32 v30, v30, v43
  v_cvt_pk_bf16_f32 v247, v42, v43
  v_mfma_f32_32x32x16_bf16 v[128:143], a[212:215], v[84:87], v[128:143]
  ds_read_b64_tr_b16 a[252:253], v11 offset:28672
  v_exp_f32 v34, v186
  v_exp_f32 v35, v187
  v_add_f32 v31, v31, v32
  v_mfma_f32_32x32x16_bf16 v[144:159], a[212:215], v[116:119], v[144:159]
  ds_read_b64_tr_b16 a[254:255], v11 offset:30720
  v_add_f32 v31, v31, v33
  v_cvt_pk_bf16_f32 v252, v32, v33
  v_exp_f32 v36, v188
  v_mfma_f32_32x32x16_bf16 v[128:143], a[216:219], v[88:91], v[128:143]
  v_exp_f32 v37, v189
  v_add_f32 v31, v31, v34
  v_add_f32 v31, v31, v35
  v_cvt_pk_bf16_f32 v253, v34, v35
  v_mfma_f32_32x32x16_bf16 v[144:159], a[216:219], v[120:123], v[144:159]
  v_exp_f32 v38, v190
  v_exp_f32 v39, v191
  v_add_f32 v31, v31, v36
  v_mfma_f32_32x32x16_bf16 v[128:143], a[220:223], v[92:95], v[128:143]
  v_add_f32 v31, v31, v37
  v_cvt_pk_bf16_f32 v254, v36, v37
  v_add_f32 v31, v31, v38
  v_add_f32 v31, v31, v39
  v_cvt_pk_bf16_f32 v255, v38, v39
  v_mfma_f32_32x32x16_bf16 v[144:159], a[220:223], v[124:127], v[144:159]
  v_max_f32 v32, v30, v31
  v_cmp_nge_f32 vcc, s50, v32
  s_waitcnt lgkmcnt(0)
  s_nop 0
  s_cbranch_vccz L_ok_7
  s_call_b64 s[60:61], L_slow_1
L_ok_7:
  v_mfma_f32_32x32x16_bf16 a[0:15], a[224:227], v[240:243], a[0:15]
  s_waitcnt vmcnt(9)
  s_barrier
  v_add_f32 v28, v28, v30
  v_add_f32 v29, v29, v31
  v_mfma_f32_32x32x16_bf16 a[16:31], a[224:227], v[248:251], a[16:31]
  ds_read_b128 a[192:195], v12 offset:49152
  v_exp_f32 v32, v128
  v_exp_f32 v33, v129
  v_mfma_f32_32x32x16_bf16 a[32:47], a[228:231], v[240:243], a[32:47]
  ds_read_b128 a[196:199], v13 offset:49152
  v_exp_f32 v34, v130
  v_exp_f32 v35, v131
  v_mfma_f32_32x32x16_bf16 a[48:63], a[228:231], v[248:251], a[48:63]
  ds_read_b128 a[200:203], v14 offset:49152
  v_add_f32 v30, v32, v33
  v_cvt_pk_bf16_f32 v224, v32, v33
  v_exp_f32 v36, v132
  v_mfma_f32_32x32x16_bf16 a[64:79], a[232:235], v[240:243], a[64:79]
  ds_read_b128 a[204:207], v15 offset:49152
  v_exp_f32 v37, v133
  v_add_f32 v30, v30, v34
  v_add_f32 v30, v30, v35
  v_cvt_pk_bf16_f32 v225, v34, v35
  v_mfma_f32_32x32x16_bf16 a[80:95], a[232:235], v[248:251], a[80:95]
  ds_read_b128 a[208:211], v16 offset:49152
  v_exp_f32 v38, v134
  v_exp_f32 v39, v135
  v_mfma_f32_32x32x16_bf16 a[96:111], a[236:239], v[240:243], a[96:111]
  ds_read_b128 a[212:215], v17 offset:49152
  v_add_f32 v30, v30, v36
  v_add_f32 v30, v30, v37
  v_cvt_pk_bf16_f32 v226, v36, v37
  v_mfma_f32_32x32x16_bf16 a[112:127], a[236:239], v[248:251], a[112:127]
  ds_read_b128 a[216:219], v18 offset:49152
  v_exp_f32 v40, v144
  v_exp_f32 v41, v145
  v_add_f32 v30, v30, v38
  v_mfma_f32_32x32x16_bf16 a[0:15], a[240:243], v[244:247], a[0:15]
  ds_read_b128 a[220:223], v19 offset:49152
  v_add_f32 v30, v30, v39
  v_cvt_pk_bf16_f32 v227, v38, v39
  v_exp_f32 v42, v146
  v_mfma_f32_32x32x16_bf16 a[16:31], a[240:243], v[252:255], a[16:31]
  s_add_u32 m0, s55, 0x4000
  s_nop 0
  buffer_load_dwordx4 v24, s[8:11], s56 offen lds
  v_exp_f32 v43, v147
  v_add_f32 v31, v40, v41
  v_mfma_f32_32x32x16_bf16 a[32:47], a[244:247], v[244:247], a[32:47]
  v_cvt_pk_bf16_f32 v232, v40, v41
  v_exp_f32 v32, v148
  v_exp_f32 v33, v149
  v_mfma_f32_32x32x16_bf16 a[48:63], a[244:247], v[252:255], a[48:63]
  v_add_f32 v31, v31, v42
  v_add_f32 v31, v31, v43
  v_cvt_pk_bf16_f32 v233, v42, v43
  v_exp_f32 v34, v150
  v_mfma_f32_32x32x16_bf16 a[64:79], a[248:251], v[244:247], a[64:79]
  buffer_load_dwordx4 v25, s[8:11], s56 offen offset:1024 lds
  v_exp_f32 v35, v151
  v_add_f32 v31, v31, v32
  v_add_f32 v31, v31, v33
  v_mfma_f32_32x32x16_bf16 a[80:95], a[248:251], v[252:255], a[80:95]
  v_cvt_pk_bf16_f32 v234, v32, v33
  v_exp_f32 v36, v136
  v_exp_f32 v37, v137
  v_mfma_f32_32x32x16_bf16 a[96:111], a[252:255], v[244:247], a[96:111]
  v_add_f32 v31, v31, v34
  v_add_f32 v31, v31, v35
  v_cvt_pk_bf16_f32 v235, v34, v35
  v_exp_f32 v38, v138
  v_mfma_f32_32x32x16_bf16 a[112:127], a[252:255], v[252:255], a[112:127]
  s_waitcnt lgkmcnt(0)
  s_add_u32 s56, s56, 0x2000
  s_and_b32 s56, s56, 0x1ffff
  s_add_u32 m0, s55, 0x2000
  s_nop 0
  buffer_load_dwordx4 v26, s[12:15], s57 offen lds
  v_mfma_f32_32x32x16_bf16 v[160:175], a[192:195], v[64:67], v[192:207]
  ds_read_b64_tr_b16 a[224:225], v8 offset:40960
  ds_read_b64_tr_b16 a[226:227], v8 offset:43008
  v_exp_f32 v39, v139
  v_add_f32 v30, v30, v36
  v_mfma_f32_32x32x16_bf16 v[176:191], a[192:195], v[96:99], v[208:223]
  ds_read_b64_tr_b16 a[228:229], v9 offset:40960
  v_add_f32 v30, v30, v37
  v_cvt_pk_bf16_f32 v228, v36, v37
  v_exp_f32 v40, v140
  v_mfma_f32_32x32x16_bf16 v[160:175], a[196:199], v[68:71], v[160:175]
  ds_read_b64_tr_b16 a[230:231], v9 offset:43008
  buffer_load_dwordx4 v26, s[12:15], s57 offen offset:1024 lds
  v_exp_f32 v41, v141
  v_add_f32 v30, v30, v38
  v_mfma_f32_32x32x16_bf16 v[176:191], a[196:199], v[100:103], v[176:191]
  ds_read_b64_tr_b16 a[232:233], v10 offset:40960
  ds_read_b64_tr_b16 a[234:235], v10 offset:43008
  v_add_f32 v30, v30, v39
  v_cvt_pk_bf16_f32 v229, v38, v39
  v_exp_f32 v42, v142
  v_mfma_f32_32x32x16_bf16 v[160:175], a[200:203], v[72:75], v[160:175]
  ds_read_b64_tr_b16 a[236:237], v11 offset:40960
  v_exp_f32 v43, v143
  v_add_f32 v30, v30, v40
  v_add_f32 v30, v30, v41
  v_mfma_f32_32x32x16_bf16 v[176:191], a[200:203], v[104:107], v[176:191]
  ds_read_b64_tr_b16 a[238:239], v11 offset:43008
  s_add_u32 s57, s57, 0x2000
  s_and_b32 s57, s57, 0x1ffff
  s_mov_b32 s53, 0x70000
  buffer_store_dwordx4 a[184:187], v27, s[36:39], s53 offen sc1
  v_mfma_f32_32x32x16_bf16 v[160:175], a[204:207], v[76:79], v[160:175]
  ds_read_b64_tr_b16 a[240:241], v8 offset:45056
  ds_read_b64_tr_b16 a[242:243], v8 offset:47104
  v_cvt_pk_bf16_f32 v230, v40, v41
  v_exp_f32 v32, v152
  v_mfma_f32_32x32x16_bf16 v[176:191], a[204:207], v[108:111], v[176:191]
  ds_read_b64_tr_b16 a[244:245], v9 offset:45056
  v_exp_f32 v33, v153
  v_add_f32 v30, v30, v42
  v_add_f32 v30, v30, v43
  v_mfma_f32_32x32x16_bf16 v[160:175], a[208:211], v[80:83], v[160:175]
  ds_read_b64_tr_b16 a[246:247], v9 offset:47104
  buffer_store_dwordx4 a[188:191], v27, s[36:39], s53 offen offset:1024 sc1
  v_cvt_pk_bf16_f32 v231, v42, v43
  v_exp_f32 v34, v154
  v_mfma_f32_32x32x16_bf16 v[176:191], a[208:211], v[112:115], v[176:191]
  ds_read_b64_tr_b16 a[248:249], v10 offset:45056
  ds_read_b64_tr_b16 a[250:251], v10 offset:47104
  v_exp_f32 v35, v155
  v_add_f32 v31, v31, v32
  v_mfma_f32_32x32x16_bf16 v[160:175], a[212:215], v[84:87], v[160:175]
  ds_read_b64_tr_b16 a[252:253], v11 offset:45056
  v_add_f32 v31, v31, v33
  v_cvt_pk_bf16_f32 v236, v32, v33
  v_exp_f32 v36, v156
  v_mfma_f32_32x32x16_bf16 v[176:191], a[212:215], v[116:119], v[176:191]
  ds_read_b64_tr_b16 a[254:255], v11 offset:47104
  s_mov_b32 s48, s62
  s_add_u32 m0, s47, 0
  s_nop 0
  buffer_load_dwordx4 v20, s[20:23], s48 offen lds
  v_mfma_f32_32x32x16_bf16 v[160:175], a[216:219], v[88:91], v[160:175]
  v_exp_f32 v37, v157
  v_add_f32 v31, v31, v34
  v_add_f32 v31, v31, v35
  v_cvt_pk_bf16_f32 v237, v34, v35
  v_mfma_f32_32x32x16_bf16 v[176:191], a[216:219], v[120:123], v[176:191]
  buffer_load_dwordx4 v21, s[20:23], s48 offen offset:1024 lds
  v_exp_f32 v38, v158
  v_exp_f32 v39, v159
  v_mfma_f32_32x32x16_bf16 v[160:175], a[220:223], v[92:95], v[160:175]
  v_add_f32 v31, v31, v36
  v_add_f32 v31, v31, v37
  v_cvt_pk_bf16_f32 v238, v36, v37
  v_add_f32 v31, v31, v38
  v_add_f32 v31, v31, v39
  v_cvt_pk_bf16_f32 v239, v38, v39
  v_mfma_f32_32x32x16_bf16 v[176:191], a[220:223], v[124:127], v[176:191]
  buffer_load_dwordx4 v22, s[20:23], s48 offen offset:2048 lds
  buffer_load_dwordx4 v23, s[20:23], s48 offen offset:3072 lds
  s_add_u32 s63, s48, 0x8000
  v_max_f32 v32, v30, v31
  v_cmp_nge_f32 vcc, s50, v32
  s_waitcnt lgkmcnt(0)
  s_nop 0
  s_cbranch_vccz L_ok_8
  s_call_b64 s[60:61], L_slow_0
L_ok_8:
  s_waitcnt vmcnt(16)
  v_readfirstlane_b32 s76, v61
  s_cmp_lg_u32 s76, 0
  s_cbranch_scc1 L_nonce_ok
  s_call_b64 s[60:61], L_spin_nonce
L_nonce_ok:
  v_mfma_f32_32x32x16_bf16 a[0:15], a[224:227], v[224:227], a[0:15]
  s_waitcnt vmcnt(12)
  s_barrier
  v_add_f32 v28, v28, v30
  v_add_f32 v29, v29, v31
  v_mfma_f32_32x32x16_bf16 a[16:31], a[224:227], v[232:235], a[16:31]
  ds_read_b128 a[192:195], v12
  v_exp_f32 v32, v160
  v_exp_f32 v33, v161
  v_mfma_f32_32x32x16_bf16 a[32:47], a[228:231], v[224:227], a[32:47]
  ds_read_b128 a[196:199], v13
  v_exp_f32 v34, v162
  v_exp_f32 v35, v163
  v_mfma_f32_32x32x16_bf16 a[48:63], a[228:231], v[232:235], a[48:63]
  ds_read_b128 a[200:203], v14
  v_add_f32 v30, v32, v33
  v_cvt_pk_bf16_f32 v240, v32, v33
  v_exp_f32 v36, v164
  v_mfma_f32_32x32x16_bf16 a[64:79], a[232:235], v[224:227], a[64:79]
  ds_read_b128 a[204:207], v15
  v_exp_f32 v37, v165
  v_add_f32 v30, v30, v34
  v_add_f32 v30, v30, v35
  v_cvt_pk_bf16_f32 v241, v34, v35
  v_mfma_f32_32x32x16_bf16 a[80:95], a[232:235], v[232:235], a[80:95]
  ds_read_b128 a[208:211], v16
  v_exp_f32 v38, v166
  v_exp_f32 v39, v167
  v_mfma_f32_32x32x16_bf16 a[96:111], a[236:239], v[224:227], a[96:111]
  ds_read_b128 a[212:215], v17
  v_add_f32 v30, v30, v36
  v_add_f32 v30, v30, v37
  v_cvt_pk_bf16_f32 v242, v36, v37
  v_mfma_f32_32x32x16_bf16 a[112:127], a[236:239], v[232:235], a[112:127]
  ds_read_b128 a[216:219], v18
  v_exp_f32 v40, v176
  v_exp_f32 v41, v177
  v_add_f32 v30, v30, v38
  v_mfma_f32_32x32x16_bf16 a[0:15], a[240:243], v[228:231], a[0:15]
  ds_read_b128 a[220:223], v19
  v_add_f32 v30, v30, v39
  v_cvt_pk_bf16_f32 v243, v38, v39
  v_exp_f32 v42, v178
  v_mfma_f32_32x32x16_bf16 a[16:31], a[240:243], v[236:239], a[16:31]
  s_add_u32 m0, s55, 0x8000
  s_nop 0
  buffer_load_dwordx4 v24, s[8:11], s56 offen lds
  v_exp_f32 v43, v179
  v_add_f32 v31, v40, v41
  v_mfma_f32_32x32x16_bf16 a[32:47], a[244:247], v[228:231], a[32:47]
  v_cvt_pk_bf16_f32 v248, v40, v41
  v_exp_f32 v32, v180
  v_exp_f32 v33, v181
  v_mfma_f32_32x32x16_bf16 a[48:63], a[244:247], v[236:239], a[48:63]
  v_add_f32 v31, v31, v42
  v_add_f32 v31, v31, v43
  v_cvt_pk_bf16_f32 v249, v42, v43
  v_exp_f32 v34, v182
  v_mfma_f32_32x32x16_bf16 a[64:79], a[248:251], v[228:231], a[64:79]
  buffer_load_dwordx4 v25, s[8:11], s56 offen offset:1024 lds
  v_exp_f32 v35, v183
  v_add_f32 v31, v31, v32
  v_add_f32 v31, v31, v33
  v_mfma_f32_32x32x16_bf16 a[80:95], a[248:251], v[236:239], a[80:95]
  v_cvt_pk_bf16_f32 v250, v32, v33
  v_exp_f32 v36, v168
  v_exp_f32 v37, v169
  v_mfma_f32_32x32x16_bf16 a[96:111], a[252:255], v[228:231], a[96:111]
  v_add_f32 v31, v31, v34
  v_add_f32 v31, v31, v35
  v_cvt_pk_bf16_f32 v251, v34, v35
  v_exp_f32 v38, v170
  v_mfma_f32_32x32x16_bf16 a[112:127], a[252:255], v[236:239], a[112:127]
  s_waitcnt lgkmcnt(0)
  s_add_u32 s56, s56, 0x2000
  s_and_b32 s56, s56, 0x1ffff
  s_add_u32 m0, s55, 0x6000
  s_nop 0
  buffer_load_dwordx4 v26, s[12:15], s57 offen lds
  v_mfma_f32_32x32x16_bf16 v[128:143], a[192:195], v[64:67], v[192:207]
  ds_read_b64_tr_b16 a[224:225], v8 offset:57344
  ds_read_b64_tr_b16 a[226:227], v8 offset:59392
  v_exp_f32 v39, v171
  v_add_f32 v30, v30, v36
  v_mfma_f32_32x32x16_bf16 v[144:159], a[192:195], v[96:99], v[208:223]
  ds_read_b64_tr_b16 a[228:229], v9 offset:57344
  v_add_f32 v30, v30, v37
  v_cvt_pk_bf16_f32 v244, v36, v37
  v_exp_f32 v40, v172
  v_mfma_f32_32x32x16_bf16 v[128:143], a[196:199], v[68:71], v[128:143]
  ds_read_b64_tr_b16 a[230:231], v9 offset:59392
  buffer_load_dwordx4 v26, s[12:15], s57 offen offset:1024 lds
  v_exp_f32 v41, v173
  v_add_f32 v30, v30, v38
  v_mfma_f32_32x32x16_bf16 v[144:159], a[196:199], v[100:103], v[144:159]
  ds_read_b64_tr_b16 a[232:233], v10 offset:57344
  ds_read_b64_tr_b16 a[234:235], v10 offset:59392
  v_add_f32 v30, v30, v39
  v_cvt_pk_bf16_f32 v245, v38, v39
  v_mfma_f32_32x32x16_bf16 v[128:143], a[200:203], v[72:75], v[128:143]
  ds_read_b64_tr_b16 a[236:237], v11 offset:57344
  v_exp_f32 v42, v174
  v_exp_f32 v43, v175
  v_add_f32 v30, v30, v40
  v_mfma_f32_32x32x16_bf16 v[144:159], a[200:203], v[104:107], v[144:159]
  ds_read_b64_tr_b16 a[238:239], v11 offset:59392
  s_add_u32 s57, s57, 0x2000
  s_and_b32 s57, s57, 0x1ffff
  s_add_u32 m0, s47, 0x1000
  s_nop 0
  buffer_load_dwordx4 v20, s[20:23], s63 offen lds
  v_mfma_f32_32x32x16_bf16 v[128:143], a[204:207], v[76:79], v[128:143]
  ds_read_b64_tr_b16 a[240:241], v8 offset:61440
  ds_read_b64_tr_b16 a[242:243], v8 offset:63488
  v_add_f32 v30, v30, v41
  v_cvt_pk_bf16_f32 v246, v40, v41
  v_exp_f32 v32, v184
  v_mfma_f32_32x32x16_bf16 v[144:159], a[204:207], v[108:111], v[144:159]
  ds_read_b64_tr_b16 a[244:245], v9 offset:61440
  v_exp_f32 v33, v185
  v_add_f32 v30, v30, v42
  v_add_f32 v30, v30, v43
  v_mfma_f32_32x32x16_bf16 v[128:143], a[208:211], v[80:83], v[128:143]
  ds_read_b64_tr_b16 a[246:247], v9 offset:63488
  buffer_load_dwordx4 v21, s[20:23], s63 offen offset:1024 lds
  v_cvt_pk_bf16_f32 v247, v42, v43
  v_mfma_f32_32x32x16_bf16 v[144:159], a[208:211], v[112:115], v[144:159]
  ds_read_b64_tr_b16 a[248:249], v10 offset:61440
  ds_read_b64_tr_b16 a[250:251], v10 offset:63488
  v_exp_f32 v34, v186
  v_exp_f32 v35, v187
  v_mfma_f32_32x32x16_bf16 v[128:143], a[212:215], v[84:87], v[128:143]
  ds_read_b64_tr_b16 a[252:253], v11 offset:61440
  v_add_f32 v31, v31, v32
  v_add_f32 v31, v31, v33
  v_cvt_pk_bf16_f32 v252, v32, v33
  v_exp_f32 v36, v188
  v_mfma_f32_32x32x16_bf16 v[144:159], a[212:215], v[116:119], v[144:159]
  ds_read_b64_tr_b16 a[254:255], v11 offset:63488
  buffer_load_dwordx4 v22, s[20:23], s63 offen offset:2048 lds
  v_exp_f32 v37, v189
  v_mfma_f32_32x32x16_bf16 v[128:143], a[216:219], v[88:91], v[128:143]
  v_add_f32 v31, v31, v34
  v_add_f32 v31, v31, v35
  v_cvt_pk_bf16_f32 v253, v34, v35
  v_exp_f32 v38, v190
  v_mfma_f32_32x32x16_bf16 v[144:159], a[216:219], v[120:123], v[144:159]
  buffer_load_dwordx4 v23, s[20:23], s63 offen offset:3072 lds
  s_add_u32 s48, s63, 0x8000
  v_exp_f32 v39, v191
  v_add_f32 v31, v31, v36
  v_mfma_f32_32x32x16_bf16 v[128:143], a[220:223], v[92:95], v[128:143]
  v_add_f32 v31, v31, v37
  v_cvt_pk_bf16_f32 v254, v36, v37
  v_add_f32 v31, v31, v38
  v_add_f32 v31, v31, v39
  v_cvt_pk_bf16_f32 v255, v38, v39
  v_mfma_f32_32x32x16_bf16 v[144:159], a[220:223], v[124:127], v[144:159]
  v_max_f32 v32, v30, v31
  v_cmp_nge_f32 vcc, s50, v32
  s_waitcnt lgkmcnt(0)
  s_nop 0
  s_cbranch_vccz L_ok_9
  s_call_b64 s[60:61], L_slow_1
L_ok_9:
  s_waitcnt vmcnt(12)
  v_mfma_f32_32x32x16_bf16 a[0:15], a[224:227], v[240:243], a[0:15]
  s_barrier
  v_add_f32 v28, v28, v30
  v_add_f32 v29, v29, v31
  v_mfma_f32_32x32x16_bf16 a[16:31], a[224:227], v[248:251], a[16:31]
  ds_read_b128 a[192:195], v12 offset:16384
  v_exp_f32 v32, v128
  v_exp_f32 v33, v129
  v_mfma_f32_32x32x16_bf16 a[32:47], a[228:231], v[240:243], a[32:47]
  ds_read_b128 a[196:199], v13 offset:16384
  v_exp_f32 v34, v130
  v_exp_f32 v35, v131
  v_mfma_f32_32x32x16_bf16 a[48:63], a[228:231], v[248:251], a[48:63]
  ds_read_b128 a[200:203], v14 offset:16384
  v_add_f32 v30, v32, v33
  v_cvt_pk_bf16_f32 v224, v32, v33
  v_exp_f32 v36, v132
  v_mfma_f32_32x32x16_bf16 a[64:79], a[232:235], v[240:243], a[64:79]
  ds_read_b128 a[204:207], v15 offset:16384
  v_exp_f32 v37, v133
  v_add_f32 v30, v30, v34
  v_add_f32 v30, v30, v35
  v_cvt_pk_bf16_f32 v225, v34, v35
  v_mfma_f32_32x32x16_bf16 a[80:95], a[232:235], v[248:251], a[80:95]
  ds_read_b128 a[208:211], v16 offset:16384
  v_exp_f32 v38, v134
  v_exp_f32 v39, v135
  v_mfma_f32_32x32x16_bf16 a[96:111], a[236:239], v[240:243], a[96:111]
  ds_read_b128 a[212:215], v17 offset:16384
  v_add_f32 v30, v30, v36
  v_add_f32 v30, v30, v37
  v_cvt_pk_bf16_f32 v226, v36, v37
  v_mfma_f32_32x32x16_bf16 a[112:127], a[236:239], v[248:251], a[112:127]
  ds_read_b128 a[216:219], v18 offset:16384
  v_exp_f32 v40, v144
  v_exp_f32 v41, v145
  v_add_f32 v30, v30, v38
  v_mfma_f32_32x32x16_bf16 a[0:15], a[240:243], v[244:247], a[0:15]
  ds_read_b128 a[220:223], v19 offset:16384
  v_add_f32 v30, v30, v39
  v_cvt_pk_bf16_f32 v227, v38, v39
  v_exp_f32 v42, v146
  v_mfma_f32_32x32x16_bf16 a[16:31], a[240:243], v[252:255], a[16:31]
  s_add_u32 m0, s55, 0xc000
  s_nop 0
  buffer_load_dwordx4 v24, s[8:11], s56 offen lds
  v_exp_f32 v43, v147
  v_add_f32 v31, v40, v41
  v_mfma_f32_32x32x16_bf16 a[32:47], a[244:247], v[244:247], a[32:47]
  v_cvt_pk_bf16_f32 v232, v40, v41
  v_exp_f32 v32, v148
  v_exp_f32 v33, v149
  v_mfma_f32_32x32x16_bf16 a[48:63], a[244:247], v[252:255], a[48:63]
  v_add_f32 v31, v31, v42
  v_add_f32 v31, v31, v43
  v_cvt_pk_bf16_f32 v233, v42, v43
  v_exp_f32 v34, v150
  v_mfma_f32_32x32x16_bf16 a[64:79], a[248:251], v[244:247], a[64:79]
  buffer_load_dwordx4 v25, s[8:11], s56 offen offset:1024 lds
  v_exp_f32 v35, v151
  v_add_f32 v31, v31, v32
  v_add_f32 v31, v31, v33
  v_mfma_f32_32x32x16_bf16 a[80:95], a[248:251], v[252:255], a[80:95]
  v_cvt_pk_bf16_f32 v234, v32, v33
  v_exp_f32 v36, v136
  v_exp_f32 v37, v137
  v_mfma_f32_32x32x16_bf16 a[96:111], a[252:255], v[244:247], a[96:111]
  v_add_f32 v31, v31, v34
  v_add_f32 v31, v31, v35
  v_cvt_pk_bf16_f32 v235, v34, v35
  v_exp_f32 v38, v138
  v_mfma_f32_32x32x16_bf16 a[112:127], a[252:255], v[252:255], a[112:127]
  s_waitcnt lgkmcnt(0)
  s_add_u32 s56, s56, 0x2000
  s_and_b32 s56, s56, 0x1ffff
  s_add_u32 m0, s55, 0xa000
  s_nop 0
  buffer_load_dwordx4 v26, s[12:15], s57 offen lds
  v_mfma_f32_32x32x16_bf16 v[160:175], a[192:195], v[64:67], v[192:207]
  ds_read_b64_tr_b16 a[224:225], v8 offset:8192
  ds_read_b64_tr_b16 a[226:227], v8 offset:10240
  v_exp_f32 v39, v139
  v_add_f32 v30, v30, v36
  v_mfma_f32_32x32x16_bf16 v[176:191], a[192:195], v[96:99], v[208:223]
  ds_read_b64_tr_b16 a[228:229], v9 offset:8192
  v_add_f32 v30, v30, v37
  v_cvt_pk_bf16_f32 v228, v36, v37
  v_exp_f32 v40, v140
  v_mfma_f32_32x32x16_bf16 v[160:175], a[196:199], v[68:71], v[160:175]
  ds_read_b64_tr_b16 a[230:231], v9 offset:10240
  buffer_load_dwordx4 v26, s[12:15], s57 offen offset:1024 lds
  v_exp_f32 v41, v141
  v_add_f32 v30, v30, v38
  v_mfma_f32_32x32x16_bf16 v[176:191], a[196:199], v[100:103], v[176:191]
  ds_read_b64_tr_b16 a[232:233], v10 offset:8192
  ds_read_b64_tr_b16 a[234:235], v10 offset:10240
  v_add_f32 v30, v30, v39
  v_cvt_pk_bf16_f32 v229, v38, v39
  v_mfma_f32_32x32x16_bf16 v[160:175], a[200:203], v[72:75], v[160:175]
  ds_read_b64_tr_b16 a[236:237], v11 offset:8192
  v_exp_f32 v42, v142
  v_exp_f32 v43, v143
  v_add_f32 v30, v30, v40
  v_mfma_f32_32x32x16_bf16 v[176:191], a[200:203], v[104:107], v[176:191]
  ds_read_b64_tr_b16 a[238:239], v11 offset:10240
  s_add_u32 s57, s57, 0x2000
  s_and_b32 s57, s57, 0x1ffff
  s_add_u32 m0, s47, 0x2000
  s_nop 0
  buffer_load_dwordx4 v20, s[20:23], s48 offen lds
  v_mfma_f32_32x32x16_bf16 v[160:175], a[204:207], v[76:79], v[160:175]
  ds_read_b64_tr_b16 a[240:241], v8 offset:12288
  ds_read_b64_tr_b16 a[242:243], v8 offset:14336
  v_add_f32 v30, v30, v41
  v_cvt_pk_bf16_f32 v230, v40, v41
  v_exp_f32 v32, v152
  v_mfma_f32_32x32x16_bf16 v[176:191], a[204:207], v[108:111], v[176:191]
  ds_read_b64_tr_b16 a[244:245], v9 offset:12288
  v_exp_f32 v33, v153
  v_add_f32 v30, v30, v42
  v_add_f32 v30, v30, v43
  v_mfma_f32_32x32x16_bf16 v[160:175], a[208:211], v[80:83], v[160:175]
  ds_read_b64_tr_b16 a[246:247], v9 offset:14336
  buffer_load_dwordx4 v21, s[20:23], s48 offen offset:1024 lds
  v_cvt_pk_bf16_f32 v231, v42, v43
  v_mfma_f32_32x32x16_bf16 v[176:191], a[208:211], v[112:115], v[176:191]
  ds_read_b64_tr_b16 a[248:249], v10 offset:12288
  ds_read_b64_tr_b16 a[250:251], v10 offset:14336
  v_exp_f32 v34, v154
  v_exp_f32 v35, v155
  v_mfma_f32_32x32x16_bf16 v[160:175], a[212:215], v[84:87], v[160:175]
  ds_read_b64_tr_b16 a[252:253], v11 offset:12288
  v_add_f32 v31, v31, v32
  v_add_f32 v31, v31, v33
  v_cvt_pk_bf16_f32 v236, v32, v33
  v_exp_f32 v36, v156
  v_mfma_f32_32x32x16_bf16 v[176:191], a[212:215], v[116:119], v[176:191]
  ds_read_b64_tr_b16 a[254:255], v11 offset:14336
  buffer_load_dwordx4 v22, s[20:23], s48 offen offset:2048 lds
  v_exp_f32 v37, v157
  v_mfma_f32_32x32x16_bf16 v[160:175], a[216:219], v[88:91], v[160:175]
  v_add_f32 v31, v31, v34
  v_add_f32 v31, v31, v35
  v_cvt_pk_bf16_f32 v237, v34, v35
  v_exp_f32 v38, v158
  v_mfma_f32_32x32x16_bf16 v[176:191], a[216:219], v[120:123], v[176:191]
  buffer_load_dwordx4 v23, s[20:23], s48 offen offset:3072 lds
  s_add_u32 s63, s48, 0x8000
  v_exp_f32 v39, v159
  v_add_f32 v31, v31, v36
  v_mfma_f32_32x32x16_bf16 v[160:175], a[220:223], v[92:95], v[160:175]
  v_add_f32 v31, v31, v37
  v_cvt_pk_bf16_f32 v238, v36, v37
  v_add_f32 v31, v31, v38
  v_add_f32 v31, v31, v39
  v_cvt_pk_bf16_f32 v239, v38, v39
  v_mfma_f32_32x32x16_bf16 v[176:191], a[220:223], v[124:127], v[176:191]
  v_max_f32 v32, v30, v31
  v_cmp_nge_f32 vcc, s50, v32
  s_waitcnt lgkmcnt(0)
  s_nop 0
  s_cbranch_vccz L_ok_10
  s_call_b64 s[60:61], L_slow_0
L_ok_10:
  s_cmp_eq_u32 s46, 1
  s_cbranch_scc0 L_noflag_0
  s_lshl_b32 s49, s44, 2
  s_add_u32 s49, s49, 0
  v_mov_b32 v62, s49
  v_mov_b32 v60, s76
  buffer_store_dword v60, v62, s[72:75], 0 offen sc1
L_noflag_0:
  s_nop 1
  v_mfma_f32_32x32x16_bf16 a[0:15], a[224:227], v[224:227], a[0:15]
  s_waitcnt vmcnt(12)
  s_barrier
  v_add_f32 v28, v28, v30
  v_add_f32 v29, v29, v31
  v_mfma_f32_32x32x16_bf16 a[16:31], a[224:227], v[232:235], a[16:31]
  ds_read_b128 a[192:195], v12 offset:32768
  v_exp_f32 v32, v160
  v_exp_f32 v33, v161
  v_mfma_f32_32x32x16_bf16 a[32:47], a[228:231], v[224:227], a[32:47]
  ds_read_b128 a[196:199], v13 offset:32768
  v_exp_f32 v34, v162
  v_exp_f32 v35, v163
  v_mfma_f32_32x32x16_bf16 a[48:63], a[228:231], v[232:235], a[48:63]
  ds_read_b128 a[200:203], v14 offset:32768
  v_add_f32 v30, v32, v33
  v_cvt_pk_bf16_f32 v240, v32, v33
  v_exp_f32 v36, v164
  v_mfma_f32_32x32x16_bf16 a[64:79], a[232:235], v[224:227], a[64:79]
  ds_read_b128 a[204:207], v15 offset:32768
  v_exp_f32 v37, v165
  v_add_f32 v30, v30, v34
  v_add_f32 v30, v30, v35
  v_cvt_pk_bf16_f32 v241, v34, v35
  v_mfma_f32_32x32x16_bf16 a[80:95], a[232:235], v[232:235], a[80:95]
  ds_read_b128 a[208:211], v16 offset:32768
  v_exp_f32 v38, v166
  v_exp_f32 v39, v167
  v_mfma_f32_32x32x16_bf16 a[96:111], a[236:239], v[224:227], a[96:111]
  ds_read_b128 a[212:215], v17 offset:32768
  v_add_f32 v30, v30, v36
  v_add_f32 v30, v30, v37
  v_cvt_pk_bf16_f32 v242, v36, v37
  v_mfma_f32_32x32x16_bf16 a[112:127], a[236:239], v[232:235], a[112:127]
  ds_read_b128 a[216:219], v18 offset:32768
  v_exp_f32 v40, v176
  v_exp_f32 v41, v177
  v_add_f32 v30, v30, v38
  v_mfma_f32_32x32x16_bf16 a[0:15], a[240:243], v[228:231], a[0:15]
  ds_read_b128 a[220:223], v19 offset:32768
  v_add_f32 v30, v30, v39
  v_cvt_pk_bf16_f32 v243, v38, v39
  v_exp_f32 v42, v178
  v_mfma_f32_32x32x16_bf16 a[16:31], a[240:243], v[236:239], a[16:31]
  s_add_u32 m0, s55, 0
  s_nop 0
  buffer_load_dwordx4 v24, s[8:11], s56 offen lds
  v_exp_f32 v43, v179
  v_add_f32 v31, v40, v41
  v_mfma_f32_32x32x16_bf16 a[32:47], a[244:247], v[228:231], a[32:47]
  v_cvt_pk_bf16_f32 v248, v40, v41
  v_exp_f32 v32, v180
  v_exp_f32 v33, v181
  v_mfma_f32_32x32x16_bf16 a[48:63], a[244:247], v[236:239], a[48:63]
  v_add_f32 v31, v31, v42
  v_add_f32 v31, v31, v43
  v_cvt_pk_bf16_f32 v249, v42, v43
  v_exp_f32 v34, v182
  v_mfma_f32_32x32x16_bf16 a[64:79], a[248:251], v[228:231], a[64:79]
  buffer_load_dwordx4 v25, s[8:11], s56 offen offset:1024 lds
  v_exp_f32 v35, v183
  v_add_f32 v31, v31, v32
  v_add_f32 v31, v31, v33
  v_mfma_f32_32x32x16_bf16 a[80:95], a[248:251], v[236:239], a[80:95]
  v_cvt_pk_bf16_f32 v250, v32, v33
  v_exp_f32 v36, v168
  v_exp_f32 v37, v169
  v_mfma_f32_32x32x16_bf16 a[96:111], a[252:255], v[228:231], a[96:111]
  v_add_f32 v31, v31, v34
  v_add_f32 v31, v31, v35
  v_cvt_pk_bf16_f32 v251, v34, v35
  v_exp_f32 v38, v170
  v_mfma_f32_32x32x16_bf16 a[112:127], a[252:255], v[236:239], a[112:127]
  s_waitcnt lgkmcnt(0)
  s_add_u32 s56, s56, 0x2000
  s_and_b32 s56, s56, 0x1ffff
  s_add_u32 m0, s55, 0xe000
  s_nop 0
  buffer_load_dwordx4 v26, s[12:15], s57 offen lds
  v_mfma_f32_32x32x16_bf16 v[128:143], a[192:195], v[64:67], v[192:207]
  ds_read_b64_tr_b16 a[224:225], v8 offset:24576
  ds_read_b64_tr_b16 a[226:227], v8 offset:26624
  v_exp_f32 v39, v171
  v_add_f32 v30, v30, v36
  v_mfma_f32_32x32x16_bf16 v[144:159], a[192:195], v[96:99], v[208:223]
  ds_read_b64_tr_b16 a[228:229], v9 offset:24576
  v_add_f32 v30, v30, v37
  v_cvt_pk_bf16_f32 v244, v36, v37
  v_exp_f32 v40, v172
  v_mfma_f32_32x32x16_bf16 v[128:143], a[196:199], v[68:71], v[128:143]
  ds_read_b64_tr_b16 a[230:231], v9 offset:26624
  buffer_load_dwordx4 v26, s[12:15], s57 offen offset:1024 lds
  v_exp_f32 v41, v173
  v_add_f32 v30, v30, v38
  v_mfma_f32_32x32x16_bf16 v[144:159], a[196:199], v[100:103], v[144:159]
  ds_read_b64_tr_b16 a[232:233], v10 offset:24576
  ds_read_b64_tr_b16 a[234:235], v10 offset:26624
  v_add_f32 v30, v30, v39
  v_cvt_pk_bf16_f32 v245, v38, v39
  v_mfma_f32_32x32x16_bf16 v[128:143], a[200:203], v[72:75], v[128:143]
  ds_read_b64_tr_b16 a[236:237], v11 offset:24576
  v_exp_f32 v42, v174
  v_exp_f32 v43, v175
  v_add_f32 v30, v30, v40
  v_mfma_f32_32x32x16_bf16 v[144:159], a[200:203], v[104:107], v[144:159]
  ds_read_b64_tr_b16 a[238:239], v11 offset:26624
  s_add_u32 s57, s57, 0x2000
  s_and_b32 s57, s57, 0x1ffff
  s_add_u32 m0, s47, 0x3000
  s_nop 0
  buffer_load_dwordx4 v20, s[20:23], s63 offen lds
  v_mfma_f32_32x32x16_bf16 v[128:143], a[204:207], v[76:79], v[128:143]
  ds_read_b64_tr_b16 a[240:241], v8 offset:28672
  ds_read_b64_tr_b16 a[242:243], v8 offset:30720
  v_add_f32 v30, v30, v41
  v_cvt_pk_bf16_f32 v246, v40, v41
  v_exp_f32 v32, v184
  v_mfma_f32_32x32x16_bf16 v[144:159], a[204:207], v[108:111], v[144:159]
  ds_read_b64_tr_b16 a[244:245], v9 offset:28672
  v_exp_f32 v33, v185
  v_add_f32 v30, v30, v42
  v_add_f32 v30, v30, v43
  v_mfma_f32_32x32x16_bf16 v[128:143], a[208:211], v[80:83], v[128:143]
  ds_read_b64_tr_b16 a[246:247], v9 offset:30720
  buffer_load_dwordx4 v21, s[20:23], s63 offen offset:1024 lds
  v_cvt_pk_bf16_f32 v247, v42, v43
  v_mfma_f32_32x32x16_bf16 v[144:159], a[208:211], v[112:115], v[144:159]
  ds_read_b64_tr_b16 a[248:249], v10 offset:28672
  ds_read_b64_tr_b16 a[250:251], v10 offset:30720
  v_exp_f32 v34, v186
  v_exp_f32 v35, v187
  v_mfma_f32_32x32x16_bf16 v[128:143], a[212:215], v[84:87], v[128:143]
  ds_read_b64_tr_b16 a[252:253], v11 offset:28672
  v_add_f32 v31, v31, v32
  v_add_f32 v31, v31, v33
  v_cvt_pk_bf16_f32 v252, v32, v33
  v_exp_f32 v36, v188
  v_mfma_f32_32x32x16_bf16 v[144:159], a[212:215], v[116:119], v[144:159]
  ds_read_b64_tr_b16 a[254:255], v11 offset:30720
  buffer_load_dwordx4 v22, s[20:23], s63 offen offset:2048 lds
  v_exp_f32 v37, v189
  v_mfma_f32_32x32x16_bf16 v[128:143], a[216:219], v[88:91], v[128:143]
  v_add_f32 v31, v31, v34
  v_add_f32 v31, v31, v35
  v_cvt_pk_bf16_f32 v253, v34, v35
  v_exp_f32 v38, v190
  v_mfma_f32_32x32x16_bf16 v[144:159], a[216:219], v[120:123], v[144:159]
  buffer_load_dwordx4 v23, s[20:23], s63 offen offset:3072 lds
  s_mov_b32 s48, s59
  v_exp_f32 v39, v191
  v_add_f32 v31, v31, v36
  v_mfma_f32_32x32x16_bf16 v[128:143], a[220:223], v[92:95], v[128:143]
  v_add_f32 v31, v31, v37
  v_cvt_pk_bf16_f32 v254, v36, v37
  v_add_f32 v31, v31, v38
  v_add_f32 v31, v31, v39
  v_cvt_pk_bf16_f32 v255, v38, v39
  v_mfma_f32_32x32x16_bf16 v[144:159], a[220:223], v[124:127], v[144:159]
  v_max_f32 v32, v30, v31
  v_cmp_nge_f32 vcc, s50, v32
  s_waitcnt lgkmcnt(0)
  s_nop 0
  s_cbranch_vccz L_ok_11
  s_call_b64 s[60:61], L_slow_1
L_ok_11:
  v_mfma_f32_32x32x16_bf16 a[0:15], a[224:227], v[240:243], a[0:15]
  s_waitcnt vmcnt(12)
  s_barrier
  v_add_f32 v28, v28, v30
  v_add_f32 v29, v29, v31
  v_mfma_f32_32x32x16_bf16 a[16:31], a[224:227], v[248:251], a[16:31]
  ds_read_b128 a[192:195], v12 offset:49152
  v_exp_f32 v32, v128
  v_exp_f32 v33, v129
  v_mfma_f32_32x32x16_bf16 a[32:47], a[228:231], v[240:243], a[32:47]
  ds_read_b128 a[196:199], v13 offset:49152
  v_exp_f32 v34, v130
  v_exp_f32 v35, v131
  v_mfma_f32_32x32x16_bf16 a[48:63], a[228:231], v[248:251], a[48:63]
  ds_read_b128 a[200:203], v14 offset:49152
  v_add_f32 v30, v32, v33
  v_cvt_pk_bf16_f32 v224, v32, v33
  v_exp_f32 v36, v132
  v_mfma_f32_32x32x16_bf16 a[64:79], a[232:235], v[240:243], a[64:79]
  ds_read_b128 a[204:207], v15 offset:49152
  v_exp_f32 v37, v133
  v_add_f32 v30, v30, v34
  v_add_f32 v30, v30, v35
  v_cvt_pk_bf16_f32 v225, v34, v35
  v_mfma_f32_32x32x16_bf16 a[80:95], a[232:235], v[248:251], a[80:95]
  ds_read_b128 a[208:211], v16 offset:49152
  v_exp_f32 v38, v134
  v_exp_f32 v39, v135
  v_mfma_f32_32x32x16_bf16 a[96:111], a[236:239], v[240:243], a[96:111]
  ds_read_b128 a[212:215], v17 offset:49152
  v_add_f32 v30, v30, v36
  v_add_f32 v30, v30, v37
  v_cvt_pk_bf16_f32 v226, v36, v37
  v_mfma_f32_32x32x16_bf16 a[112:127], a[236:239], v[248:251], a[112:127]
  ds_read_b128 a[216:219], v18 offset:49152
  v_exp_f32 v40, v144
  v_exp_f32 v41, v145
  v_add_f32 v30, v30, v38
  v_mfma_f32_32x32x16_bf16 a[0:15], a[240:243], v[244:247], a[0:15]
  ds_read_b128 a[220:223], v19 offset:49152
  v_add_f32 v30, v30, v39
  v_cvt_pk_bf16_f32 v227, v38, v39
  v_exp_f32 v42, v146
  v_mfma_f32_32x32x16_bf16 a[16:31], a[240:243], v[252:255], a[16:31]
  s_add_u32 m0, s55, 0x4000
  s_nop 0
  buffer_load_dwordx4 v24, s[8:11], s56 offen lds
  v_exp_f32 v43, v147
  v_add_f32 v31, v40, v41
  v_mfma_f32_32x32x16_bf16 a[32:47], a[244:247], v[244:247], a[32:47]
  v_cvt_pk_bf16_f32 v232, v40, v41
  v_exp_f32 v32, v148
  v_exp_f32 v33, v149
  v_mfma_f32_32x32x16_bf16 a[48:63], a[244:247], v[252:255], a[48:63]
  v_add_f32 v31, v31, v42
  v_add_f32 v31, v31, v43
  v_cvt_pk_bf16_f32 v233, v42, v43
  v_exp_f32 v34, v150
  v_mfma_f32_32x32x16_bf16 a[64:79], a[248:251], v[244:247], a[64:79]
  buffer_load_dwordx4 v25, s[8:11], s56 offen offset:1024 lds
  v_exp_f32 v35, v151
  v_add_f32 v31, v31, v32
  v_mfma_f32_32x32x16_bf16 a[80:95], a[248:251], v[252:255], a[80:95]
  v_add_f32 v31, v31, v33
  v_cvt_pk_bf16_f32 v234, v32, v33
  v_exp_f32 v36, v136
  v_mfma_f32_32x32x16_bf16 a[96:111], a[252:255], v[244:247], a[96:111]
  v_exp_f32 v37, v137
  v_add_f32 v31, v31, v34
  v_add_f32 v31, v31, v35
  v_cvt_pk_bf16_f32 v235, v34, v35
  v_mfma_f32_32x32x16_bf16 a[112:127], a[252:255], v[252:255], a[112:127]
  s_waitcnt lgkmcnt(0)
  s_add_u32 s56, s56, 0x2000
  s_and_b32 s56, s56, 0x1ffff
  s_add_u32 m0, s55, 0x2000
  s_nop 0
  buffer_load_dwordx4 v26, s[12:15], s57 offen lds
  v_mfma_f32_32x32x16_bf16 v[160:175], a[192:195], v[64:67], v[192:207]
  ds_read_b64_tr_b16 a[224:225], v8 offset:40960
  ds_read_b64_tr_b16 a[226:227], v8 offset:43008
  v_exp_f32 v38, v138
  v_exp_f32 v39, v139
  v_mfma_f32_32x32x16_bf16 v[176:191], a[192:195], v[96:99], v[208:223]
  ds_read_b64_tr_b16 a[228:229], v9 offset:40960
  v_add_f32 v30, v30, v36
  v_add_f32 v30, v30, v37
  v_cvt_pk_bf16_f32 v228, v36, v37
  v_exp_f32 v40, v140
  v_mfma_f32_32x32x16_bf16 v[160:175], a[196:199], v[68:71], v[160:175]
  ds_read_b64_tr_b16 a[230:231], v9 offset:43008
  buffer_load_dwordx4 v26, s[12:15], s57 offen offset:1024 lds
  v_exp_f32 v41, v141
  v_mfma_f32_32x32x16_bf16 v[176:191], a[196:199], v[100:103], v[176:191]
  ds_read_b64_tr_b16 a[232:233], v10 offset:40960
  ds_read_b64_tr_b16 a[234:235], v10 offset:43008
  v_add_f32 v30, v30, v38
  v_add_f32 v30, v30, v39
  v_cvt_pk_bf16_f32 v229, v38, v39
  v_mfma_f32_32x32x16_bf16 v[160:175], a[200:203], v[72:75], v[160:175]
  ds_read_b64_tr_b16 a[236:237], v11 offset:40960
  v_exp_f32 v42, v142
  v_exp_f32 v43, v143
  v_add_f32 v30, v30, v40
  v_mfma_f32_32x32x16_bf16 v[176:191], a[200:203], v[104:107], v[176:191]
  ds_read_b64_tr_b16 a[238:239], v11 offset:43008
  s_add_u32 s57, s57, 0x2000
  s_and_b32 s57, s57, 0x1ffff
  buffer_load_dword v60, v58, s[72:75], 0 offen sc1
  v_add_f32 v30, v30, v41
  v_mfma_f32_32x32x16_bf16 v[160:175], a[204:207], v[76:79], v[160:175]
  ds_read_b64_tr_b16 a[240:241], v8 offset:45056
  ds_read_b64_tr_b16 a[242:243], v8 offset:47104
  v_cvt_pk_bf16_f32 v230, v40, v41
  v_exp_f32 v32, v152
  v_mfma_f32_32x32x16_bf16 v[176:191], a[204:207], v[108:111], v[176:191]
  ds_read_b64_tr_b16 a[244:245], v9 offset:45056
  v_exp_f32 v33, v153
  v_add_f32 v30, v30, v42
  v_add_f32 v30, v30, v43
  v_mfma_f32_32x32x16_bf16 v[160:175], a[208:211], v[80:83], v[160:175]
  ds_read_b64_tr_b16 a[246:247], v9 offset:47104
  s_add_u32 m0, s47, 0x4000
  s_nop 0
  buffer_load_dwordx4 v20, s[20:23], s48 offen lds
  v_cvt_pk_bf16_f32 v231, v42, v43
  v_mfma_f32_32x32x16_bf16 v[176:191], a[208:211], v[112:115], v[176:191]
  ds_read_b64_tr_b16 a[248:249], v10 offset:45056
  ds_read_b64_tr_b16 a[250:251], v10 offset:47104
  v_exp_f32 v34, v154
  v_exp_f32 v35, v155
  v_mfma_f32_32x32x16_bf16 v[160:175], a[212:215], v[84:87], v[160:175]
  ds_read_b64_tr_b16 a[252:253], v11 offset:45056
  v_add_f32 v31, v31, v32
  v_add_f32 v31, v31, v33
  v_cvt_pk_bf16_f32 v236, v32, v33
  v_mfma_f32_32x32x16_bf16 v[176:191], a[212:215], v[116:119], v[176:191]
  ds_read_b64_tr_b16 a[254:255], v11 offset:47104
  buffer_load_dwordx4 v21, s[20:23], s48 offen offset:1024 lds
  v_exp_f32 v36, v156
  v_mfma_f32_32x32x16_bf16 v[160:175], a[216:219], v[88:91], v[160:175]
  v_exp_f32 v37, v157
  v_add_f32 v31, v31, v34
  v_add_f32 v31, v31, v35
  v_cvt_pk_bf16_f32 v237, v34, v35
  v_mfma_f32_32x32x16_bf16 v[176:191], a[216:219], v[120:123], v[176:191]
  buffer_load_dwordx4 v22, s[20:23], s48 offen offset:2048 lds
  v_exp_f32 v38, v158
  v_exp_f32 v39, v159
  v_mfma_f32_32x32x16_bf16 v[160:175], a[220:223], v[92:95], v[160:175]
  v_add_f32 v31, v31, v36
  v_add_f32 v31, v31, v37
  v_cvt_pk_bf16_f32 v238, v36, v37
  v_add_f32 v31, v31, v38
  v_add_f32 v31, v31, v39
  v_cvt_pk_bf16_f32 v239, v38, v39
  v_mfma_f32_32x32x16_bf16 v[176:191], a[220:223], v[124:127], v[176:191]
  buffer_load_dwordx4 v23, s[20:23], s48 offen offset:3072 lds
  s_add_u32 s63, s48, 0x8000
  s_and_b32 s63, s63, 0x7ffff
  s_cmp_eq_u32 s63, s62
  s_cselect_b32 s63, s54, s63
  v_max_f32 v32, v30, v31
  v_cmp_nge_f32 vcc, s50, v32
  s_waitcnt lgkmcnt(0)
  s_nop 0
  s_cbranch_vccz L_ok_12
  s_call_b64 s[60:61], L_slow_0
L_ok_12:
  s_waitcnt vmcnt(4)
  v_cmp_ne_u32 vcc, s76, v60
  s_nop 1
  s_cbranch_vccz L_flag_ok_0
  s_call_b64 s[60:61], L_spin_flag_0
L_flag_ok_0:
  v_mfma_f32_32x32x16_bf16 a[0:15], a[224:227], v[224:227], a[0:15]
  s_barrier
  v_add_f32 v28, v28, v30
  v_add_f32 v29, v29, v31
  v_mfma_f32_32x32x16_bf16 a[16:31], a[224:227], v[232:235], a[16:31]
  ds_read_b128 a[192:195], v12
  v_exp_f32 v32, v160
  v_exp_f32 v33, v161
  v_mfma_f32_32x32x16_bf16 a[32:47], a[228:231], v[224:227], a[32:47]
  ds_read_b128 a[196:199], v13
  v_exp_f32 v34, v162
  v_exp_f32 v35, v163
  v_mfma_f32_32x32x16_bf16 a[48:63], a[228:231], v[232:235], a[48:63]
  ds_read_b128 a[200:203], v14
  v_add_f32 v30, v32, v33
  v_cvt_pk_bf16_f32 v240, v32, v33
  v_exp_f32 v36, v164
  v_mfma_f32_32x32x16_bf16 a[64:79], a[232:235], v[224:227], a[64:79]
  ds_read_b128 a[204:207], v15
  v_exp_f32 v37, v165
  v_add_f32 v30, v30, v34
  v_add_f32 v30, v30, v35
  v_mfma_f32_32x32x16_bf16 a[80:95], a[232:235], v[232:235], a[80:95]
  ds_read_b128 a[208:211], v16
  v_cvt_pk_bf16_f32 v241, v34, v35
  v_exp_f32 v38, v166
  v_mfma_f32_32x32x16_bf16 a[96:111], a[236:239], v[224:227], a[96:111]
  ds_read_b128 a[212:215], v17
  v_exp_f32 v39, v167
  v_add_f32 v30, v30, v36
  v_add_f32 v30, v30, v37
  v_cvt_pk_bf16_f32 v242, v36, v37
  v_mfma_f32_32x32x16_bf16 a[112:127], a[236:239], v[232:235], a[112:127]
  ds_read_b128 a[216:219], v18
  v_exp_f32 v40, v176
  v_exp_f32 v41, v177
  v_mfma_f32_32x32x16_bf16 a[0:15], a[240:243], v[228:231], a[0:15]
  ds_read_b128 a[220:223], v19
  v_add_f32 v30, v30, v38
  v_add_f32 v30, v30, v39
  v_cvt_pk_bf16_f32 v243, v38, v39
  v_mfma_f32_32x32x16_bf16 a[16:31], a[240:243], v[236:239], a[16:31]
  s_add_u32 m0, s55, 0x6000
  s_nop 0
  buffer_load_dwordx4 v26, s[12:15], s57 offen lds
  v_exp_f32 v42, v178
  v_mfma_f32_32x32x16_bf16 a[32:47], a[244:247], v[228:231], a[32:47]
  v_exp_f32 v43, v179
  v_add_f32 v31, v40, v41
  v_cvt_pk_bf16_f32 v248, v40, v41
  v_exp_f32 v32, v180
  v_mfma_f32_32x32x16_bf16 a[48:63], a[244:247], v[236:239], a[48:63]
  v_exp_f32 v33, v181
  v_add_f32 v31, v31, v42
  v_add_f32 v31, v31, v43
  v_cvt_pk_bf16_f32 v249, v42, v43
  v_mfma_f32_32x32x16_bf16 a[64:79], a[248:251], v[228:231], a[64:79]
  buffer_load_dwordx4 v26, s[12:15], s57 offen offset:1024 lds
  v_exp_f32 v34, v182
  v_mfma_f32_32x32x16_bf16 a[80:95], a[248:251], v[236:239], a[80:95]
  v_exp_f32 v35, v183
  v_add_f32 v31, v31, v32
  v_add_f32 v31, v31, v33
  v_cvt_pk_bf16_f32 v250, v32, v33
  v_mfma_f32_32x32x16_bf16 a[96:111], a[252:255], v[228:231], a[96:111]
  v_exp_f32 v36, v168
  v_exp_f32 v37, v169
  v_add_f32 v31, v31, v34
  v_mfma_f32_32x32x16_bf16 a[112:127], a[252:255], v[236:239], a[112:127]
  s_waitcnt lgkmcnt(0)
  s_add_u32 s57, s57, 0x2000
  s_and_b32 s57, s57, 0x1ffff
  s_add_u32 s53, s78, 0
  buffer_load_dwordx4 a[128:131], v59, s[36:39], s53 offen sc1
  v_mfma_f32_32x32x16_bf16 v[128:143], a[192:195], v[64:67], v[192:207]
  ds_read_b64_tr_b16 a[224:225], v8 offset:57344
  ds_read_b64_tr_b16 a[226:227], v8 offset:59392
  v_add_f32 v31, v31, v35
  v_cvt_pk_bf16_f32 v251, v34, v35
  v_mfma_f32_32x32x16_bf16 v[144:159], a[192:195], v[96:99], v[208:223]
  ds_read_b64_tr_b16 a[228:229], v9 offset:57344
  v_exp_f32 v38, v170
  v_exp_f32 v39, v171
  v_add_f32 v30, v30, v36
  v_mfma_f32_32x32x16_bf16 v[128:143], a[196:199], v[68:71], v[128:143]
  ds_read_b64_tr_b16 a[230:231], v9 offset:59392
  buffer_load_dwordx4 a[132:135], v59, s[36:39], s53 offen offset:1024 sc1
  v_add_f32 v30, v30, v37
  v_cvt_pk_bf16_f32 v244, v36, v37
  v_mfma_f32_32x32x16_bf16 v[144:159], a[196:199], v[100:103], v[144:159]
  ds_read_b64_tr_b16 a[232:233], v10 offset:57344
  ds_read_b64_tr_b16 a[234:235], v10 offset:59392
  v_exp_f32 v40, v172
  v_exp_f32 v41, v173
  v_mfma_f32_32x32x16_bf16 v[128:143], a[200:203], v[72:75], v[128:143]
  ds_read_b64_tr_b16 a[236:237], v11 offset:57344
  v_add_f32 v30, v30, v38
  v_add_f32 v30, v30, v39
  v_cvt_pk_bf16_f32 v245, v38, v39
  v_mfma_f32_32x32x16_bf16 v[144:159], a[200:203], v[104:107], v[144:159]
  ds_read_b64_tr_b16 a[238:239], v11 offset:59392
  buffer_load_dwordx4 a[136:139], v59, s[36:39], s53 offen offset:2048 sc1
  v_exp_f32 v42, v174
  v_mfma_f32_32x32x16_bf16 v[128:143], a[204:207], v[76:79], v[128:143]
  ds_read_b64_tr_b16 a[240:241], v8 offset:61440
  ds_read_b64_tr_b16 a[242:243], v8 offset:63488
  v_exp_f32 v43, v175
  v_add_f32 v30, v30, v40
  v_add_f32 v30, v30, v41
  v_mfma_f32_32x32x16_bf16 v[144:159], a[204:207], v[108:111], v[144:159]
  ds_read_b64_tr_b16 a[244:245], v9 offset:61440
  v_cvt_pk_bf16_f32 v246, v40, v41
  v_exp_f32 v32, v184
  v_mfma_f32_32x32x16_bf16 v[128:143], a[208:211], v[80:83], v[128:143]
  ds_read_b64_tr_b16 a[246:247], v9 offset:63488
  buffer_load_dwordx4 a[140:143], v59, s[36:39], s53 offen offset:3072 sc1
  v_exp_f32 v33, v185
  v_add_f32 v30, v30, v42
  v_mfma_f32_32x32x16_bf16 v[144:159], a[208:211], v[112:115], v[144:159]
  ds_read_b64_tr_b16 a[248:249], v10 offset:61440
  ds_read_b64_tr_b16 a[250:251], v10 offset:63488
  v_add_f32 v30, v30, v43
  v_cvt_pk_bf16_f32 v247, v42, v43
  v_exp_f32 v34, v186
  v_mfma_f32_32x32x16_bf16 v[128:143], a[212:215], v[84:87], v[128:143]
  ds_read_b64_tr_b16 a[252:253], v11 offset:61440
  v_exp_f32 v35, v187
  v_add_f32 v31, v31, v32
  v_add_f32 v31, v31, v33
  v_mfma_f32_32x32x16_bf16 v[144:159], a[212:215], v[116:119], v[144:159]
  ds_read_b64_tr_b16 a[254:255], v11 offset:63488
  v_cvt_pk_bf16_f32 v252, v32, v33
  v_exp_f32 v36, v188
  v_mfma_f32_32x32x16_bf16 v[128:143], a[216:219], v[88:91], v[128:143]
  v_exp_f32 v37, v189
  v_add_f32 v31, v31, v34
  v_add_f32 v31, v31, v35
  v_cvt_pk_bf16_f32 v253, v34, v35
  v_mfma_f32_32x32x16_bf16 v[144:159], a[216:219], v[120:123], v[144:159]
  v_exp_f32 v38, v190
  v_exp_f32 v39, v191
  v_add_f32 v31, v31, v36
  v_mfma_f32_32x32x16_bf16 v[128:143], a[220:223], v[92:95], v[128:143]
  v_add_f32 v31, v31, v37
  v_cvt_pk_bf16_f32 v254, v36, v37
  v_add_f32 v31, v31, v38
  v_add_f32 v31, v31, v39
  v_cvt_pk_bf16_f32 v255, v38, v39
  v_mfma_f32_32x32x16_bf16 v[144:159], a[220:223], v[124:127], v[144:159]
  v_max_f32 v32, v30, v31
  v_cmp_nge_f32 vcc, s50, v32
  s_waitcnt lgkmcnt(0)
  s_nop 0
  s_cbranch_vccz L_ok_13
  s_call_b64 s[60:61], L_slow_1
L_ok_13:
  v_mfma_f32_32x32x16_bf16 a[0:15], a[224:227], v[240:243], a[0:15]
  s_barrier
  v_add_f32 v28, v28, v30
  v_add_f32 v29, v29, v31
  v_mfma_f32_32x32x16_bf16 a[16:31], a[224:227], v[248:251], a[16:31]
  ds_read_b128 a[192:195], v12 offset:16384
  v_exp_f32 v32, v128
  v_exp_f32 v33, v129
  v_mfma_f32_32x32x16_bf16 a[32:47], a[228:231], v[240:243], a[32:47]
  ds_read_b128 a[196:199], v13 offset:16384
  v_exp_f32 v34, v130
  v_exp_f32 v35, v131
  v_mfma_f32_32x32x16_bf16 a[48:63], a[228:231], v[248:251], a[48:63]
  ds_read_b128 a[200:203], v14 offset:16384
  v_add_f32 v30, v32, v33
  v_cvt_pk_bf16_f32 v224, v32, v33
  v_mfma_f32_32x32x16_bf16 a[64:79], a[232:235], v[240:243], a[64:79]
  ds_read_b128 a[204:207], v15 offset:16384
  v_exp_f32 v36, v132
  v_exp_f32 v37, v133
  v_add_f32 v30, v30, v34
  v_mfma_f32_32x32x16_bf16 a[80:95], a[232:235], v[248:251], a[80:95]
  ds_read_b128 a[208:211], v16 offset:16384
  v_add_f32 v30, v30, v35
  v_cvt_pk_bf16_f32 v225, v34, v35
  v_exp_f32 v38, v134
  v_mfma_f32_32x32x16_bf16 a[96:111], a[236:239], v[240:243], a[96:111]
  ds_read_b128 a[212:215], v17 offset:16384
  v_exp_f32 v39, v135
  v_add_f32 v30, v30, v36
  v_add_f32 v30, v30, v37
  v_mfma_f32_32x32x16_bf16 a[112:127], a[236:239], v[248:251], a[112:127]
  ds_read_b128 a[216:219], v18 offset:16384
  v_cvt_pk_bf16_f32 v226, v36, v37
  v_exp_f32 v40, v144
  v_mfma_f32_32x32x16_bf16 a[0:15], a[240:243], v[244:247], a[0:15]
  ds_read_b128 a[220:223], v19 offset:16384
  v_exp_f32 v41, v145
  v_add_f32 v30, v30, v38
  v_add_f32 v30, v30, v39
  v_mfma_f32_32x32x16_bf16 a[16:31], a[240:243], v[252:255], a[16:31]
  s_add_u32 s53, s78, 0x1000
  buffer_load_dwordx4 a[144:147], v59, s[36:39], s53 offen sc1
  v_cvt_pk_bf16_f32 v227, v38, v39
  v_mfma_f32_32x32x16_bf16 a[32:47], a[244:247], v[244:247], a[32:47]
  v_exp_f32 v42, v146
  v_exp_f32 v43, v147
  v_add_f32 v31, v40, v41
  v_cvt_pk_bf16_f32 v232, v40, v41
  v_mfma_f32_32x32x16_bf16 a[48:63], a[244:247], v[252:255], a[48:63]
  v_exp_f32 v32, v148
  v_exp_f32 v33, v149
  v_mfma_f32_32x32x16_bf16 a[64:79], a[248:251], v[244:247], a[64:79]
  buffer_load_dwordx4 a[148:151], v59, s[36:39], s53 offen offset:1024 sc1
  v_add_f32 v31, v31, v42
  v_add_f32 v31, v31, v43
  v_cvt_pk_bf16_f32 v233, v42, v43
  v_mfma_f32_32x32x16_bf16 a[80:95], a[248:251], v[252:255], a[80:95]
  v_exp_f32 v34, v150
  v_exp_f32 v35, v151
  v_add_f32 v31, v31, v32
  v_mfma_f32_32x32x16_bf16 a[96:111], a[252:255], v[244:247], a[96:111]
  v_add_f32 v31, v31, v33
  v_cvt_pk_bf16_f32 v234, v32, v33
  v_exp_f32 v36, v136
  v_mfma_f32_32x32x16_bf16 a[112:127], a[252:255], v[252:255], a[112:127]
  s_waitcnt lgkmcnt(0)
  buffer_load_dwordx4 a[152:155], v59, s[36:39], s53 offen offset:2048 sc1
  v_exp_f32 v37, v137
  v_add_f32 v31, v31, v34
  v_mfma_f32_32x32x16_bf16 v[160:175], a[192:195], v[64:67], v[192:207]
  ds_read_b64_tr_b16 a[224:225], v8 offset:8192
  ds_read_b64_tr_b16 a[226:227], v8 offset:10240
  v_add_f32 v31, v31, v35
  v_cvt_pk_bf16_f32 v235, v34, v35
  v_mfma_f32_32x32x16_bf16 v[176:191], a[192:195], v[96:99], v[208:223]
  ds_read_b64_tr_b16 a[228:229], v9 offset:8192
  v_exp_f32 v38, v138
  v_exp_f32 v39, v139
  v_add_f32 v30, v30, v36
  v_mfma_f32_32x32x16_bf16 v[160:175], a[196:199], v[68:71], v[160:175]
  ds_read_b64_tr_b16 a[230:231], v9 offset:10240
  buffer_load_dwordx4 a[156:159], v59, s[36:39], s53 offen offset:3072 sc1
  v_add_f32 v30, v30, v37
  v_cvt_pk_bf16_f32 v228, v36, v37
  v_mfma_f32_32x32x16_bf16 v[176:191], a[196:199], v[100:103], v[176:191]
  ds_read_b64_tr_b16 a[232:233], v10 offset:8192
  ds_read_b64_tr_b16 a[234:235], v10 offset:10240
  v_exp_f32 v40, v140
  v_mfma_f32_32x32x16_bf16 v[160:175], a[200:203], v[72:75], v[160:175]
  ds_read_b64_tr_b16 a[236:237], v11 offset:8192
  v_exp_f32 v41, v141
  v_add_f32 v30, v30, v38
  v_add_f32 v30, v30, v39
  v_cvt_pk_bf16_f32 v229, v38, v39
  v_mfma_f32_32x32x16_bf16 v[176:191], a[200:203], v[104:107], v[176:191]
  ds_read_b64_tr_b16 a[238:239], v11 offset:10240
  v_exp_f32 v42, v142
  v_mfma_f32_32x32x16_bf16 v[160:175], a[204:207], v[76:79], v[160:175]
  ds_read_b64_tr_b16 a[240:241], v8 offset:12288
  ds_read_b64_tr_b16 a[242:243], v8 offset:14336
  v_exp_f32 v43, v143
  v_add_f32 v30, v30, v40
  v_add_f32 v30, v30, v41
  v_mfma_f32_32x32x16_bf16 v[176:191], a[204:207], v[108:111], v[176:191]
  ds_read_b64_tr_b16 a[244:245], v9 offset:12288
  v_cvt_pk_bf16_f32 v230, v40, v41
  v_exp_f32 v32, v152
  v_mfma_f32_32x32x16_bf16 v[160:175], a[208:211], v[80:83], v[160:175]
  ds_read_b64_tr_b16 a[246:247], v9 offset:14336
  v_exp_f32 v33, v153
  v_add_f32 v30, v30, v42
  v_add_f32 v30, v30, v43
  v_cvt_pk_bf16_f32 v231, v42, v43
  v_mfma_f32_32x32x16_bf16 v[176:191], a[208:211], v[112:115], v[176:191]
  ds_read_b64_tr_b16 a[248:249], v10 offset:12288
  ds_read_b64_tr_b16 a[250:251], v10 offset:14336
  v_exp_f32 v34, v154
  v_mfma_f32_32x32x16_bf16 v[160:175], a[212:215], v[84:87], v[160:175]
  ds_read_b64_tr_b16 a[252:253], v11 offset:12288
  v_exp_f32 v35, v155
  v_add_f32 v31, v31, v32
  v_add_f32 v31, v31, v33
  v_cvt_pk_bf16_f32 v236, v32, v33
  v_mfma_f32_32x32x16_bf16 v[176:191], a[212:215], v[116:119], v[176:191]
  ds_read_b64_tr_b16 a[254:255], v11 offset:14336
  v_exp_f32 v36, v156
  v_mfma_f32_32x32x16_bf16 v[160:175], a[216:219], v[88:91], v[160:175]
  v_exp_f32 v37, v157
  v_add_f32 v31, v31, v34
  v_add_f32 v31, v31, v35
  v_cvt_pk_bf16_f32 v237, v34, v35
  v_mfma_f32_32x32x16_bf16 v[176:191], a[216:219], v[120:123], v[176:191]
  v_exp_f32 v38, v158
  v_exp_f32 v39, v159
  v_add_f32 v31, v31, v36
  v_mfma_f32_32x32x16_bf16 v[160:175], a[220:223], v[92:95], v[160:175]
  v_add_f32 v31, v31, v37
  v_cvt_pk_bf16_f32 v238, v36, v37
  v_add_f32 v31, v31, v38
  v_add_f32 v31, v31, v39
  v_cvt_pk_bf16_f32 v239, v38, v39
  v_mfma_f32_32x32x16_bf16 v[176:191], a[220:223], v[124:127], v[176:191]
  v_max_f32 v32, v30, v31
  v_cmp_nge_f32 vcc, s50, v32
  s_waitcnt lgkmcnt(0)
  s_nop 0
  s_cbranch_vccz L_ok_14
  s_call_b64 s[60:61], L_slow_0
L_ok_14:
  v_mfma_f32_32x32x16_bf16 a[0:15], a[224:227], v[224:227], a[0:15]
  s_waitcnt vmcnt(8)
  s_barrier
  v_add_f32 v28, v28, v30
  v_add_f32 v29, v29, v31
  v_mfma_f32_32x32x16_bf16 a[16:31], a[224:227], v[232:235], a[16:31]
  s_add_u32 s53, s78, 0x2000
  buffer_load_dwordx4 a[160:163], v59, s[36:39], s53 offen sc1
  v_exp_f32 v32, v160
  v_mfma_f32_32x32x16_bf16 a[32:47], a[228:231], v[224:227], a[32:47]
  v_exp_f32 v33, v161
  v_exp_f32 v34, v162
  v_exp_f32 v35, v163
  v_mfma_f32_32x32x16_bf16 a[48:63], a[228:231], v[232:235], a[48:63]
  buffer_load_dwordx4 a[164:167], v59, s[36:39], s53 offen offset:1024 sc1
  v_add_f32 v30, v32, v33
  v_cvt_pk_bf16_f32 v240, v32, v33
  v_exp_f32 v36, v164
  v_mfma_f32_32x32x16_bf16 a[64:79], a[232:235], v[224:227], a[64:79]
  v_exp_f32 v37, v165
  v_add_f32 v30, v30, v34
  v_add_f32 v30, v30, v35
  v_cvt_pk_bf16_f32 v241, v34, v35
  v_mfma_f32_32x32x16_bf16 a[80:95], a[232:235], v[232:235], a[80:95]
  buffer_load_dwordx4 a[168:171], v59, s[36:39], s53 offen offset:2048 sc1
  v_exp_f32 v38, v166
  v_exp_f32 v39, v167
  v_mfma_f32_32x32x16_bf16 a[96:111], a[236:239], v[224:227], a[96:111]
  v_add_f32 v30, v30, v36
  v_add_f32 v30, v30, v37
  v_cvt_pk_bf16_f32 v242, v36, v37
  v_exp_f32 v40, v176
  v_mfma_f32_32x32x16_bf16 a[112:127], a[236:239], v[232:235], a[112:127]
  buffer_load_dwordx4 a[172:175], v59, s[36:39], s53 offen offset:3072 sc1
  v_exp_f32 v41, v177
  v_add_f32 v30, v30, v38
  v_add_f32 v30, v30, v39
  v_mfma_f32_32x32x16_bf16 a[0:15], a[240:243], v[228:231], a[0:15]
  v_cvt_pk_bf16_f32 v243, v38, v39
  v_exp_f32 v42, v178
  v_exp_f32 v43, v179
  v_add_f32 v31, v40, v41
  v_mfma_f32_32x32x16_bf16 a[16:31], a[240:243], v[236:239], a[16:31]
  v_cvt_pk_bf16_f32 v248, v40, v41
  v_exp_f32 v32, v180
  v_exp_f32 v33, v181
  v_add_f32 v31, v31, v42
  v_mfma_f32_32x32x16_bf16 a[32:47], a[244:247], v[228:231], a[32:47]
  v_add_f32 v31, v31, v43
  v_cvt_pk_bf16_f32 v249, v42, v43
  v_exp_f32 v34, v182
  v_exp_f32 v35, v183
  v_mfma_f32_32x32x16_bf16 a[48:63], a[244:247], v[236:239], a[48:63]
  v_add_f32 v31, v31, v32
  v_add_f32 v31, v31, v33
  v_cvt_pk_bf16_f32 v250, v32, v33
  v_exp_f32 v36, v168
  v_mfma_f32_32x32x16_bf16 a[64:79], a[248:251], v[228:231], a[64:79]
  v_exp_f32 v37, v169
  v_add_f32 v31, v31, v34
  v_add_f32 v31, v31, v35
  v_cvt_pk_bf16_f32 v251, v34, v35
  v_mfma_f32_32x32x16_bf16 a[80:95], a[248:251], v[236:239], a[80:95]
  v_exp_f32 v38, v170
  v_exp_f32 v39, v171
  v_add_f32 v30, v30, v36
  v_add_f32 v30, v30, v37
  v_mfma_f32_32x32x16_bf16 a[96:111], a[252:255], v[228:231], a[96:111]
  v_cvt_pk_bf16_f32 v244, v36, v37
  v_exp_f32 v40, v172
  v_exp_f32 v41, v173
  v_add_f32 v30, v30, v38
  v_add_f32 v30, v30, v39
  v_cvt_pk_bf16_f32 v245, v38, v39
  v_exp_f32 v42, v174
  v_exp_f32 v43, v175
  v_add_f32 v30, v30, v40
  v_add_f32 v30, v30, v41
  v_cvt_pk_bf16_f32 v246, v40, v41
  v_exp_f32 v32, v184
  v_exp_f32 v33, v185
  v_add_f32 v30, v30, v42
  v_add_f32 v30, v30, v43
  v_cvt_pk_bf16_f32 v247, v42, v43
  v_exp_f32 v34, v186
  v_exp_f32 v35, v187
  v_add_f32 v31, v31, v32
  v_add_f32 v31, v31, v33
  v_cvt_pk_bf16_f32 v252, v32, v33
  v_exp_f32 v36, v188
  v_exp_f32 v37, v189
  v_add_f32 v31, v31, v34
  v_add_f32 v31, v31, v35
  v_cvt_pk_bf16_f32 v253, v34, v35
  v_exp_f32 v38, v190
  v_exp_f32 v39, v191
  v_add_f32 v31, v31, v36
  v_add_f32 v31, v31, v37
  v_cvt_pk_bf16_f32 v254, v36, v37
  v_add_f32 v31, v31, v38
  v_add_f32 v31, v31, v39
  v_cvt_pk_bf16_f32 v255, v38, v39
  v_mfma_f32_32x32x16_bf16 a[112:127], a[252:255], v[236:239], a[112:127]
  ds_read_b64_tr_b16 a[224:225], v8 offset:24576
  ds_read_b64_tr_b16 a[226:227], v8 offset:26624
  ds_read_b64_tr_b16 a[228:229], v9 offset:24576
  ds_read_b64_tr_b16 a[230:231], v9 offset:26624
  ds_read_b64_tr_b16 a[232:233], v10 offset:24576
  ds_read_b64_tr_b16 a[234:235], v10 offset:26624
  ds_read_b64_tr_b16 a[236:237], v11 offset:24576
  ds_read_b64_tr_b16 a[238:239], v11 offset:26624
  ds_read_b64_tr_b16 a[240:241], v8 offset:28672
  ds_read_b64_tr_b16 a[242:243], v8 offset:30720
  ds_read_b64_tr_b16 a[244:245], v9 offset:28672
  ds_read_b64_tr_b16 a[246:247], v9 offset:30720
  ds_read_b64_tr_b16 a[248:249], v10 offset:28672
  ds_read_b64_tr_b16 a[250:251], v10 offset:30720
  ds_read_b64_tr_b16 a[252:253], v11 offset:28672
  ds_read_b64_tr_b16 a[254:255], v11 offset:30720
  v_max_f32 v32, v30, v31
  v_cmp_nge_f32 vcc, s50, v32
  s_waitcnt lgkmcnt(0)
  s_nop 0
  s_cbranch_vccz L_ok_15
  s_call_b64 s[60:61], L_slow_1
L_ok_15:
  v_mfma_f32_32x32x16_bf16 a[0:15], a[224:227], v[240:243], a[0:15]
  s_barrier
  v_add_f32 v28, v28, v30
  v_add_f32 v29, v29, v31
  v_mfma_f32_32x32x16_bf16 a[16:31], a[224:227], v[248:251], a[16:31]
  s_add_u32 s53, s78, 0x3000
  buffer_load_dwordx4 a[176:179], v59, s[36:39], s53 offen sc1
  v_permlane32_swap_b32 v28, v29
  v_add_f32 v28, v28, v29
  v_mov_b32 v29, v28
  s_nop 1
  v_permlane32_swap_b32 v28, v29
  v_rcp_f32 v28, v28
  v_rcp_f32 v29, v29
  s_lshl_b32 s49, s46, 14
  v_add_u32 v44, s49, v2
  v_mfma_f32_32x32x16_bf16 a[0:15], a[240:243], v[244:247], a[0:15]
  v_mfma_f32_32x32x16_bf16 a[16:31], a[240:243], v[252:255], a[16:31]
  buffer_load_dwordx4 a[180:183], v59, s[36:39], s53 offen offset:1024 sc1
  v_mfma_f32_32x32x16_bf16 a[32:47], a[228:231], v[240:243], a[32:47]
  v_mfma_f32_32x32x16_bf16 a[48:63], a[228:231], v[248:251], a[48:63]
  buffer_load_dwordx4 a[184:187], v59, s[36:39], s53 offen offset:2048 sc1
  v_mfma_f32_32x32x16_bf16 a[32:47], a[244:247], v[244:247], a[32:47]
  v_mfma_f32_32x32x16_bf16 a[48:63], a[244:247], v[252:255], a[48:63]
  buffer_load_dwordx4 a[188:191], v59, s[36:39], s53 offen offset:3072 sc1
  s_nop 3
  v_accvgpr_read_b32 v46, a0
  v_accvgpr_read_b32 v47, a1
  v_accvgpr_read_b32 v48, a2
  v_accvgpr_read_b32 v49, a3
  v_mfma_f32_32x32x16_bf16 a[64:79], a[232:235], v[240:243], a[64:79]
  v_accvgpr_read_b32 v50, a4
  v_accvgpr_read_b32 v51, a5
  v_accvgpr_read_b32 v52, a6
  v_accvgpr_read_b32 v53, a7
  v_mul_f32 v46, v46, v28
  v_mul_f32 v47, v47, v28
  v_mfma_f32_32x32x16_bf16 a[80:95], a[232:235], v[248:251], a[80:95]
  v_mul_f32 v48, v48, v28
  v_mul_f32 v49, v49, v28
  v_mul_f32 v50, v50, v28
  v_mul_f32 v51, v51, v28
  v_mul_f32 v52, v52, v28
  v_mul_f32 v53, v53, v28
  v_mfma_f32_32x32x16_bf16 a[64:79], a[248:251], v[244:247], a[64:79]
  v_cvt_pk_bf16_f32 v64, v46, v47
  v_cvt_pk_bf16_f32 v65, v48, v49
  v_cvt_pk_bf16_f32 v66, v50, v51
  v_cvt_pk_bf16_f32 v67, v52, v53
  v_mfma_f32_32x32x16_bf16 a[80:95], a[248:251], v[252:255], a[80:95]
  ds_write_b128 v44, v[64:67]
  v_accvgpr_read_b32 v32, a16
  v_accvgpr_read_b32 v33, a17
  v_accvgpr_read_b32 v34, a18
  v_accvgpr_read_b32 v35, a19
  v_mfma_f32_32x32x16_bf16 a[96:111], a[236:239], v[240:243], a[96:111]
  v_accvgpr_read_b32 v36, a20
  v_accvgpr_read_b32 v37, a21
  v_accvgpr_read_b32 v38, a22
  v_accvgpr_read_b32 v39, a23
  v_mul_f32 v32, v32, v29
  v_mul_f32 v33, v33, v29
  v_mfma_f32_32x32x16_bf16 a[112:127], a[236:239], v[248:251], a[112:127]
  v_mul_f32 v34, v34, v29
  v_mul_f32 v35, v35, v29
  v_mul_f32 v36, v36, v29
  v_mul_f32 v37, v37, v29
  v_mul_f32 v38, v38, v29
  v_mul_f32 v39, v39, v29
  v_mfma_f32_32x32x16_bf16 a[96:111], a[252:255], v[244:247], a[96:111]
  v_cvt_pk_bf16_f32 v68, v32, v33
  v_cvt_pk_bf16_f32 v69, v34, v35
  v_cvt_pk_bf16_f32 v70, v36, v37
  v_cvt_pk_bf16_f32 v71, v38, v39
  v_mfma_f32_32x32x16_bf16 a[112:127], a[252:255], v[252:255], a[112:127]
  ds_write_b128 v44, v[68:71] offset:1024
  v_accvgpr_read_b32 v46, a8
  v_accvgpr_read_b32 v47, a9
  v_accvgpr_read_b32 v48, a10
  v_accvgpr_read_b32 v49, a11
  v_accvgpr_read_b32 v50, a12
  v_accvgpr_read_b32 v51, a13
  v_accvgpr_read_b32 v52, a14
  v_accvgpr_read_b32 v53, a15
  v_mul_f32 v46, v46, v28
  v_mul_f32 v47, v47, v28
  v_mul_f32 v48, v48, v28
  v_mul_f32 v49, v49, v28
  v_mul_f32 v50, v50, v28
  v_mul_f32 v51, v51, v28
  v_mul_f32 v52, v52, v28
  v_mul_f32 v53, v53, v28
  v_cvt_pk_bf16_f32 v72, v46, v47
  v_cvt_pk_bf16_f32 v73, v48, v49
  v_cvt_pk_bf16_f32 v74, v50, v51
  v_cvt_pk_bf16_f32 v75, v52, v53
  ds_write_b128 v44, v[72:75] offset:2048
  v_accvgpr_read_b32 v32, a24
  v_accvgpr_read_b32 v33, a25
  v_accvgpr_read_b32 v34, a26
  v_accvgpr_read_b32 v35, a27
  v_accvgpr_read_b32 v36, a28
  v_accvgpr_read_b32 v37, a29
  v_accvgpr_read_b32 v38, a30
  v_accvgpr_read_b32 v39, a31
  v_mul_f32 v32, v32, v29
  v_mul_f32 v33, v33, v29
  v_mul_f32 v34, v34, v29
  v_mul_f32 v35, v35, v29
  v_mul_f32 v36, v36, v29
  v_mul_f32 v37, v37, v29
  v_mul_f32 v38, v38, v29
  v_mul_f32 v39, v39, v29
  v_cvt_pk_bf16_f32 v76, v32, v33
  v_cvt_pk_bf16_f32 v77, v34, v35
  v_cvt_pk_bf16_f32 v78, v36, v37
  v_cvt_pk_bf16_f32 v79, v38, v39
  ds_write_b128 v44, v[76:79] offset:3072
  s_lshl_b32 s9, s79, 11
  s_xor_b32 s10, s9, 0x40000
  s_lshr_b32 s8, s62, 3
  s_lshr_b32 s13, s54, 3
  s_and_b32 s49, s44, 4
  s_lshl_b32 s12, s49, 11
  s_add_u32 s12, s12, s78
  s_xor_b32 s11, s12, 0x2000
  s_mov_b32 s15, 0x3f80
  s_mov_b32 s3, 0x3f800000
  ds_read_b64_tr_b16 a[192:193], v4
  ds_read_b64_tr_b16 a[194:195], v4 offset:1024
  ds_read_b64_tr_b16 a[196:197], v5
  ds_read_b64_tr_b16 a[198:199], v5 offset:1024
  ds_read_b64_tr_b16 a[200:201], v4 offset:2048
  ds_read_b64_tr_b16 a[202:203], v4 offset:3072
  ds_read_b64_tr_b16 a[204:205], v5 offset:2048
  ds_read_b64_tr_b16 a[206:207], v5 offset:3072
  s_waitcnt lgkmcnt(0)
  v_mfma_f32_32x32x16_bf16 v[128:143], a[192:195], v[64:67], 0
  ds_read_b64_tr_b16 a[208:209], v4 offset:4096
  ds_read_b64_tr_b16 a[210:211], v4 offset:5120
  s_add_u32 m0, s47, 0x5000
  v_accvgpr_read_b32 v46, a32
  v_accvgpr_read_b32 v47, a33
  v_mfma_f32_32x32x16_bf16 v[144:159], a[192:195], v[68:71], 0
  buffer_load_dwordx4 v20, s[20:23], s63 offen lds
  v_accvgpr_read_b32 v48, a34
  v_accvgpr_read_b32 v49, a35
  v_accvgpr_read_b32 v50, a36
  v_accvgpr_read_b32 v51, a37
  v_mfma_f32_32x32x16_bf16 v[160:175], a[196:199], v[64:67], 0
  ds_read_b64_tr_b16 a[212:213], v5 offset:4096
  ds_read_b64_tr_b16 a[214:215], v5 offset:5120
  s_add_u32 s48, s63, 0x8000
  s_and_b32 s48, s48, 0x7ffff
  v_accvgpr_read_b32 v52, a38
  v_accvgpr_read_b32 v53, a39
  v_mfma_f32_32x32x16_bf16 v[176:191], a[196:199], v[68:71], 0
  buffer_load_dwordx4 v21, s[20:23], s63 offen offset:1024 lds
  v_mul_f32 v46, v46, v28
  v_mul_f32 v47, v47, v28
  v_mul_f32 v48, v48, v28
  v_mul_f32 v49, v49, v28
  v_mfma_f32_32x32x16_bf16 v[128:143], a[200:203], v[72:75], v[128:143]
  ds_read_b64_tr_b16 a[216:217], v4 offset:6144
  ds_read_b64_tr_b16 a[218:219], v4 offset:7168
  s_cmp_eq_u32 s48, s62
  s_cselect_b32 s48, s54, s48
  v_mul_f32 v50, v50, v28
  v_mul_f32 v51, v51, v28
  v_mfma_f32_32x32x16_bf16 v[144:159], a[200:203], v[76:79], v[144:159]
  buffer_load_dwordx4 v22, s[20:23], s63 offen offset:2048 lds
  v_mul_f32 v52, v52, v28
  v_mul_f32 v53, v53, v28
  v_cvt_pk_bf16_f32 v80, v46, v47
  v_cvt_pk_bf16_f32 v81, v48, v49
  v_mfma_f32_32x32x16_bf16 v[160:175], a[204:207], v[72:75], v[160:175]
  ds_read_b64_tr_b16 a[220:221], v5 offset:6144
  ds_read_b64_tr_b16 a[222:223], v5 offset:7168
  v_cvt_pk_bf16_f32 v82, v50, v51
  v_cvt_pk_bf16_f32 v83, v52, v53
  v_mfma_f32_32x32x16_bf16 v[176:191], a[204:207], v[76:79], v[176:191]
  buffer_load_dwordx4 v23, s[20:23], s63 offen offset:3072 lds
  ds_write_b128 v44, v[80:83] offset:4096
  v_accvgpr_read_b32 v32, a48
  v_accvgpr_read_b32 v33, a49
  v_accvgpr_read_b32 v34, a50
  v_accvgpr_read_b32 v35, a51
  v_accvgpr_read_b32 v36, a52
  v_accvgpr_read_b32 v37, a53
  v_accvgpr_read_b32 v38, a54
  v_accvgpr_read_b32 v39, a55
  v_mul_f32 v32, v32, v29
  v_mul_f32 v33, v33, v29
  v_mul_f32 v34, v34, v29
  v_mul_f32 v35, v35, v29
  v_mul_f32 v36, v36, v29
  v_mul_f32 v37, v37, v29
  v_mul_f32 v38, v38, v29
  v_mul_f32 v39, v39, v29
  v_cvt_pk_bf16_f32 v84, v32, v33
  v_cvt_pk_bf16_f32 v85, v34, v35
  v_cvt_pk_bf16_f32 v86, v36, v37
  v_cvt_pk_bf16_f32 v87, v38, v39
  ds_write_b128 v44, v[84:87] offset:5120
  v_accvgpr_read_b32 v46, a40
  v_accvgpr_read_b32 v47, a41
  v_accvgpr_read_b32 v48, a42
  v_accvgpr_read_b32 v49, a43
  v_accvgpr_read_b32 v50, a44
  v_accvgpr_read_b32 v51, a45
  v_accvgpr_read_b32 v52, a46
  v_accvgpr_read_b32 v53, a47
  v_mul_f32 v46, v46, v28
  v_mul_f32 v47, v47, v28
  v_mul_f32 v48, v48, v28
  v_mul_f32 v49, v49, v28
  v_mul_f32 v50, v50, v28
  v_mul_f32 v51, v51, v28
  v_mul_f32 v52, v52, v28
  v_mul_f32 v53, v53, v28
  v_cvt_pk_bf16_f32 v88, v46, v47
  v_cvt_pk_bf16_f32 v89, v48, v49
  v_cvt_pk_bf16_f32 v90, v50, v51
  v_cvt_pk_bf16_f32 v91, v52, v53
  ds_write_b128 v44, v[88:91] offset:6144
  v_accvgpr_read_b32 v32, a56
  v_accvgpr_read_b32 v33, a57
  v_accvgpr_read_b32 v34, a58
  v_accvgpr_read_b32 v35, a59
  v_accvgpr_read_b32 v36, a60
  v_accvgpr_read_b32 v37, a61
  v_accvgpr_read_b32 v38, a62
  v_accvgpr_read_b32 v39, a63
  v_mul_f32 v32, v32, v29
  v_mul_f32 v33, v33, v29
  v_mul_f32 v34, v34, v29
  v_mul_f32 v35, v35, v29
  v_mul_f32 v36, v36, v29
  v_mul_f32 v37, v37, v29
  v_mul_f32 v38, v38, v29
  v_mul_f32 v39, v39, v29
  v_cvt_pk_bf16_f32 v92, v32, v33
  v_cvt_pk_bf16_f32 v93, v34, v35
  v_cvt_pk_bf16_f32 v94, v36, v37
  v_cvt_pk_bf16_f32 v95, v38, v39
  ds_write_b128 v44, v[92:95] offset:7168
  s_waitcnt lgkmcnt(4)
  v_mfma_f32_32x32x16_bf16 v[128:143], a[208:211], v[80:83], v[128:143]
  ds_read_b64_tr_b16 a[192:193], v4 offset:8192
  ds_read_b64_tr_b16 a[194:195], v4 offset:9216
  s_add_u32 m0, s47, 0
  v_accvgpr_read_b32 v46, a64
  v_accvgpr_read_b32 v47, a65
  v_mfma_f32_32x32x16_bf16 v[144:159], a[208:211], v[84:87], v[144:159]
  buffer_load_dwordx4 v20, s[20:23], s48 offen lds
  v_accvgpr_read_b32 v48, a66
  v_accvgpr_read_b32 v49, a67
  v_accvgpr_read_b32 v50, a68
  v_accvgpr_read_b32 v51, a69
  v_mfma_f32_32x32x16_bf16 v[160:175], a[212:215], v[80:83], v[160:175]
  ds_read_b64_tr_b16 a[196:197], v5 offset:8192
  ds_read_b64_tr_b16 a[198:199], v5 offset:9216
  s_add_u32 s63, s48, 0x8000
  s_and_b32 s63, s63, 0x7ffff
  v_accvgpr_read_b32 v52, a70
  v_accvgpr_read_b32 v53, a71
  v_mfma_f32_32x32x16_bf16 v[176:191], a[212:215], v[84:87], v[176:191]
  buffer_load_dwordx4 v21, s[20:23], s48 offen offset:1024 lds
  v_mul_f32 v46, v46, v28
  v_mul_f32 v47, v47, v28
  v_mul_f32 v48, v48, v28
  v_mul_f32 v49, v49, v28
  v_mfma_f32_32x32x16_bf16 v[128:143], a[216:219], v[88:91], v[128:143]
  ds_read_b64_tr_b16 a[200:201], v4 offset:10240
  ds_read_b64_tr_b16 a[202:203], v4 offset:11264
  s_cmp_eq_u32 s63, s62
  s_cselect_b32 s63, s54, s63
  v_mul_f32 v50, v50, v28
  v_mul_f32 v51, v51, v28
  v_mfma_f32_32x32x16_bf16 v[144:159], a[216:219], v[92:95], v[144:159]
  buffer_load_dwordx4 v22, s[20:23], s48 offen offset:2048 lds
  v_mul_f32 v52, v52, v28
  v_mul_f32 v53, v53, v28
  v_cvt_pk_bf16_f32 v96, v46, v47
  v_cvt_pk_bf16_f32 v97, v48, v49
  v_mfma_f32_32x32x16_bf16 v[160:175], a[220:223], v[88:91], v[160:175]
  ds_read_b64_tr_b16 a[204:205], v5 offset:10240
  ds_read_b64_tr_b16 a[206:207], v5 offset:11264
  v_cvt_pk_bf16_f32 v98, v50, v51
  v_cvt_pk_bf16_f32 v99, v52, v53
  v_mfma_f32_32x32x16_bf16 v[176:191], a[220:223], v[92:95], v[176:191]
  buffer_load_dwordx4 v23, s[20:23], s48 offen offset:3072 lds
  ds_write_b128 v44, v[96:99] offset:8192
  v_accvgpr_read_b32 v32, a80
  v_accvgpr_read_b32 v33, a81
  v_accvgpr_read_b32 v34, a82
  v_accvgpr_read_b32 v35, a83
  v_accvgpr_read_b32 v36, a84
  v_accvgpr_read_b32 v37, a85
  v_accvgpr_read_b32 v38, a86
  v_accvgpr_read_b32 v39, a87
  v_mul_f32 v32, v32, v29
  v_mul_f32 v33, v33, v29
  v_mul_f32 v34, v34, v29
  v_mul_f32 v35, v35, v29
  v_mul_f32 v36, v36, v29
  v_mul_f32 v37, v37, v29
  v_mul_f32 v38, v38, v29
  v_mul_f32 v39, v39, v29
  v_cvt_pk_bf16_f32 v100, v32, v33
  v_cvt_pk_bf16_f32 v101, v34, v35
  v_cvt_pk_bf16_f32 v102, v36, v37
  v_cvt_pk_bf16_f32 v103, v38, v39
  ds_write_b128 v44, v[100:103] offset:9216
  v_accvgpr_read_b32 v46, a72
  v_accvgpr_read_b32 v47, a73
  v_accvgpr_read_b32 v48, a74
  v_accvgpr_read_b32 v49, a75
  v_accvgpr_read_b32 v50, a76
  v_accvgpr_read_b32 v51, a77
  v_accvgpr_read_b32 v52, a78
  v_accvgpr_read_b32 v53, a79
  v_mul_f32 v46, v46, v28
  v_mul_f32 v47, v47, v28
  v_mul_f32 v48, v48, v28
  v_mul_f32 v49, v49, v28
  v_mul_f32 v50, v50, v28
  v_mul_f32 v51, v51, v28
  v_mul_f32 v52, v52, v28
  v_mul_f32 v53, v53, v28
  v_cvt_pk_bf16_f32 v104, v46, v47
  v_cvt_pk_bf16_f32 v105, v48, v49
  v_cvt_pk_bf16_f32 v106, v50, v51
  v_cvt_pk_bf16_f32 v107, v52, v53
  ds_write_b128 v44, v[104:107] offset:10240
  v_accvgpr_read_b32 v32, a88
  v_accvgpr_read_b32 v33, a89
  v_accvgpr_read_b32 v34, a90
  v_accvgpr_read_b32 v35, a91
  v_accvgpr_read_b32 v36, a92
  v_accvgpr_read_b32 v37, a93
  v_accvgpr_read_b32 v38, a94
  v_accvgpr_read_b32 v39, a95
  v_mul_f32 v32, v32, v29
  v_mul_f32 v33, v33, v29
  v_mul_f32 v34, v34, v29
  v_mul_f32 v35, v35, v29
  v_mul_f32 v36, v36, v29
  v_mul_f32 v37, v37, v29
  v_mul_f32 v38, v38, v29
  v_mul_f32 v39, v39, v29
  v_cvt_pk_bf16_f32 v108, v32, v33
  v_cvt_pk_bf16_f32 v109, v34, v35
  v_cvt_pk_bf16_f32 v110, v36, v37
  v_cvt_pk_bf16_f32 v111, v38, v39
  ds_write_b128 v44, v[108:111] offset:11264
  s_waitcnt lgkmcnt(4)
  v_mfma_f32_32x32x16_bf16 v[128:143], a[192:195], v[96:99], v[128:143]
  ds_read_b64_tr_b16 a[208:209], v4 offset:12288
  ds_read_b64_tr_b16 a[210:211], v4 offset:13312
  s_add_u32 m0, s47, 0x1000
  v_accvgpr_read_b32 v46, a96
  v_accvgpr_read_b32 v47, a97
  v_mfma_f32_32x32x16_bf16 v[144:159], a[192:195], v[100:103], v[144:159]
  buffer_load_dwordx4 v20, s[20:23], s63 offen lds
  v_accvgpr_read_b32 v48, a98
  v_accvgpr_read_b32 v49, a99
  v_accvgpr_read_b32 v50, a100
  v_accvgpr_read_b32 v51, a101
  v_mfma_f32_32x32x16_bf16 v[160:175], a[196:199], v[96:99], v[160:175]
  ds_read_b64_tr_b16 a[212:213], v5 offset:12288
  ds_read_b64_tr_b16 a[214:215], v5 offset:13312
  s_add_u32 s48, s63, 0x8000
  s_and_b32 s48, s48, 0x7ffff
  v_accvgpr_read_b32 v52, a102
  v_accvgpr_read_b32 v53, a103
  v_mfma_f32_32x32x16_bf16 v[176:191], a[196:199], v[100:103], v[176:191]
  buffer_load_dwordx4 v21, s[20:23], s63 offen offset:1024 lds
  v_mul_f32 v46, v46, v28
  v_mul_f32 v47, v47, v28
  v_mul_f32 v48, v48, v28
  v_mul_f32 v49, v49, v28
  v_mfma_f32_32x32x16_bf16 v[128:143], a[200:203], v[104:107], v[128:143]
  ds_read_b64_tr_b16 a[216:217], v4 offset:14336
  ds_read_b64_tr_b16 a[218:219], v4 offset:15360
  s_cmp_eq_u32 s48, s62
  s_cselect_b32 s48, s54, s48
  v_mul_f32 v50, v50, v28
  v_mul_f32 v51, v51, v28
  v_mfma_f32_32x32x16_bf16 v[144:159], a[200:203], v[108:111], v[144:159]
  buffer_load_dwordx4 v22, s[20:23], s63 offen offset:2048 lds
  s_lshr_b32 s58, s59, 3
  v_mul_f32 v52, v52, v28
  v_mul_f32 v53, v53, v28
  v_cvt_pk_bf16_f32 v112, v46, v47
  v_mfma_f32_32x32x16_bf16 v[160:175], a[204:207], v[104:107], v[160:175]
  ds_read_b64_tr_b16 a[220:221], v5 offset:14336
  ds_read_b64_tr_b16 a[222:223], v5 offset:15360
  v_cvt_pk_bf16_f32 v113, v48, v49
  v_cvt_pk_bf16_f32 v114, v50, v51
  v_cvt_pk_bf16_f32 v115, v52, v53
  v_mfma_f32_32x32x16_bf16 v[176:191], a[204:207], v[108:111], v[176:191]
  buffer_load_dwordx4 v23, s[20:23], s63 offen offset:3072 lds
  v_add_u32 v0, s58, v2
  ds_write_b128 v44, v[112:115] offset:12288
  v_accvgpr_read_b32 v32, a112
  v_accvgpr_read_b32 v33, a113
  v_accvgpr_read_b32 v34, a114
  v_accvgpr_read_b32 v35, a115
  v_accvgpr_read_b32 v36, a116
  v_accvgpr_read_b32 v37, a117
  v_accvgpr_read_b32 v38, a118
  v_accvgpr_read_b32 v39, a119
  v_mul_f32 v32, v32, v29
  v_mul_f32 v33, v33, v29
  v_mul_f32 v34, v34, v29
  v_mul_f32 v35, v35, v29
  v_mul_f32 v36, v36, v29
  v_mul_f32 v37, v37, v29
  v_mul_f32 v38, v38, v29
  v_mul_f32 v39, v39, v29
  v_cvt_pk_bf16_f32 v116, v32, v33
  v_cvt_pk_bf16_f32 v117, v34, v35
  v_cvt_pk_bf16_f32 v118, v36, v37
  v_cvt_pk_bf16_f32 v119, v38, v39
  ds_write_b128 v44, v[116:119] offset:13312
  v_accvgpr_read_b32 v46, a104
  v_accvgpr_read_b32 v47, a105
  v_accvgpr_read_b32 v48, a106
  v_accvgpr_read_b32 v49, a107
  v_accvgpr_read_b32 v50, a108
  v_accvgpr_read_b32 v51, a109
  v_accvgpr_read_b32 v52, a110
  v_accvgpr_read_b32 v53, a111
  v_mul_f32 v46, v46, v28
  v_mul_f32 v47, v47, v28
  v_mul_f32 v48, v48, v28
  v_mul_f32 v49, v49, v28
  v_mul_f32 v50, v50, v28
  v_mul_f32 v51, v51, v28
  v_mul_f32 v52, v52, v28
  v_mul_f32 v53, v53, v28
  v_cvt_pk_bf16_f32 v120, v46, v47
  v_cvt_pk_bf16_f32 v121, v48, v49
  v_cvt_pk_bf16_f32 v122, v50, v51
  v_cvt_pk_bf16_f32 v123, v52, v53
  ds_write_b128 v44, v[120:123] offset:14336
  v_accvgpr_read_b32 v32, a120
  v_accvgpr_read_b32 v33, a121
  v_accvgpr_read_b32 v34, a122
  v_accvgpr_read_b32 v35, a123
  v_accvgpr_read_b32 v36, a124
  v_accvgpr_read_b32 v37, a125
  v_accvgpr_read_b32 v38, a126
  v_accvgpr_read_b32 v39, a127
  v_mul_f32 v32, v32, v29
  v_mul_f32 v33, v33, v29
  v_mul_f32 v34, v34, v29
  v_mul_f32 v35, v35, v29
  v_mul_f32 v36, v36, v29
  v_mul_f32 v37, v37, v29
  v_mul_f32 v38, v38, v29
  v_mul_f32 v39, v39, v29
  v_cvt_pk_bf16_f32 v124, v32, v33
  v_cvt_pk_bf16_f32 v125, v34, v35
  v_cvt_pk_bf16_f32 v126, v36, v37
  v_cvt_pk_bf16_f32 v127, v38, v39
  ds_write_b128 v44, v[124:127] offset:15360
  s_waitcnt lgkmcnt(4)
  v_mfma_f32_32x32x16_bf16 v[128:143], a[208:211], v[112:115], v[128:143]
  ds_read_b64_tr_b16 a[192:193], v4 offset:16384
  ds_read_b64_tr_b16 a[194:195], v4 offset:17408
  s_add_u32 m0, s47, 0x2000
  v_mfma_f32_32x32x16_bf16 v[144:159], a[208:211], v[116:119], v[144:159]
  s_waitcnt lgkmcnt(0)
  s_barrier
  buffer_load_dwordx4 v20, s[20:23], s48 offen lds
  v_mfma_f32_32x32x16_bf16 v[160:175], a[212:215], v[112:115], v[160:175]
  ds_read_b64_tr_b16 a[196:197], v5 offset:16384
  ds_read_b64_tr_b16 a[198:199], v5 offset:17408
  s_add_u32 s63, s48, 0x8000
  s_and_b32 s63, s63, 0x7ffff
  v_mfma_f32_32x32x16_bf16 v[176:191], a[212:215], v[116:119], v[176:191]
  ds_read_b128 a[224:227], v0
  ds_read_b128 a[228:231], v0 offset:1024
  buffer_load_dwordx4 v21, s[20:23], s48 offen offset:1024 lds
  v_mfma_f32_32x32x16_bf16 v[128:143], a[216:219], v[120:123], v[128:143]
  ds_read_b64_tr_b16 a[200:201], v4 offset:18432
  ds_read_b64_tr_b16 a[202:203], v4 offset:19456
  s_cmp_eq_u32 s63, s62
  s_cselect_b32 s63, s54, s63
  v_mfma_f32_32x32x16_bf16 v[144:159], a[216:219], v[124:127], v[144:159]
  ds_read_b128 a[232:235], v0 offset:2048
  ds_read_b128 a[236:239], v0 offset:3072
  buffer_load_dwordx4 v22, s[20:23], s48 offen offset:2048 lds
  s_add_u32 s58, s58, 0x1000
  s_and_b32 s58, s58, 0xffff
  v_mfma_f32_32x32x16_bf16 v[160:175], a[220:223], v[120:123], v[160:175]
  ds_read_b64_tr_b16 a[204:205], v5 offset:18432
  ds_read_b64_tr_b16 a[206:207], v5 offset:19456
  s_cmp_eq_u32 s58, s8
  s_cselect_b32 s58, s13, s58
  v_mfma_f32_32x32x16_bf16 v[176:191], a[220:223], v[124:127], v[176:191]
  buffer_load_dwordx4 v23, s[20:23], s48 offen offset:3072 lds
  v_add_u32 v0, s58, v2
  s_waitcnt lgkmcnt(0)
  v_mfma_f32_32x32x16_bf16 v[128:143], a[192:195], a[224:227], v[128:143]
  s_waitcnt vmcnt(12)
  ds_read_b64_tr_b16 a[208:209], v4 offset:20480
  ds_read_b64_tr_b16 a[210:211], v4 offset:21504
  s_add_u32 m0, s47, 0x3000
  v_accvgpr_read_b32 v50, a128
  v_accvgpr_read_b32 v51, a129
  v_mfma_f32_32x32x16_bf16 v[144:159], a[192:195], a[228:231], v[144:159]
  ds_read_b128 a[240:243], v0
  ds_read_b128 a[244:247], v0 offset:1024
  buffer_load_dwordx4 v20, s[20:23], s63 offen lds
  v_accvgpr_read_b32 v52, a130
  v_accvgpr_read_b32 v53, a131
  v_mfma_f32_32x32x16_bf16 v[160:175], a[196:199], a[224:227], v[160:175]
  ds_read_b64_tr_b16 a[212:213], v5 offset:20480
  ds_read_b64_tr_b16 a[214:215], v5 offset:21504
  s_add_u32 s48, s63, 0x8000
  s_and_b32 s48, s48, 0x7ffff
  v_lshlrev_b32 v28, 16, v50
  v_and_b32 v29, 0xffff0000, v50
  v_mfma_f32_32x32x16_bf16 v[176:191], a[196:199], a[228:231], v[176:191]
  ds_read_b128 a[248:251], v0 offset:2048
  ds_read_b128 a[252:255], v0 offset:3072
  buffer_load_dwordx4 v21, s[20:23], s63 offen offset:1024 lds
  v_lshlrev_b32 v30, 16, v51
  v_and_b32 v31, 0xffff0000, v51
  v_mfma_f32_32x32x16_bf16 v[128:143], a[200:203], a[232:235], v[128:143]
  ds_read_b64_tr_b16 a[216:217], v4 offset:22528
  ds_read_b64_tr_b16 a[218:219], v4 offset:23552
  s_cmp_eq_u32 s48, s62
  s_cselect_b32 s48, s54, s48
  v_lshlrev_b32 v32, 16, v52
  v_and_b32 v33, 0xffff0000, v52
  v_mfma_f32_32x32x16_bf16 v[144:159], a[200:203], a[236:239], v[144:159]
  buffer_load_dwordx4 v22, s[20:23], s63 offen offset:2048 lds
  s_add_u32 s58, s58, 0x1000
  s_and_b32 s58, s58, 0xffff
  v_lshlrev_b32 v34, 16, v53
  v_and_b32 v35, 0xffff0000, v53
  v_mfma_f32_32x32x16_bf16 v[160:175], a[204:207], a[232:235], v[160:175]
  ds_read_b64_tr_b16 a[220:221], v5 offset:22528
  ds_read_b64_tr_b16 a[222:223], v5 offset:23552
  s_cmp_eq_u32 s58, s8
  s_cselect_b32 s58, s13, s58
  v_accvgpr_read_b32 v54, a132
  v_accvgpr_read_b32 v55, a133
  v_mfma_f32_32x32x16_bf16 v[176:191], a[204:207], a[236:239], v[176:191]
  buffer_load_dwordx4 v23, s[20:23], s63 offen offset:3072 lds
  v_add_u32 v0, s58, v2
  s_lshl_b32 s49, s45, 6
  s_and_b32 s51, s44, 1
  s_lshl_b32 s51, s51, 5
  s_add_u32 s49, s49, s51
  v_and_b32 v13, 31, v1
  v_add_u32 v13, s49, v13
  v_lshlrev_b32 v13, 10, v13
  v_lshrrev_b32 v62, 5, v1
  v_lshl_add_u32 v13, v62, 4, v13
  s_lshl_b32 s49, s46, 8
  s_lshr_b32 s51, s44, 1
  s_lshl_b32 s51, s51, 6
  s_add_u32 s49, s49, s51
  v_add_u32 v13, s49, v13
  s_mov_b32 s52, 0xc2b17218
  s_mov_b32 s14, 0x4275fdf0
  buffer_load_dwordx4 v[8:11], v13, s[4:7], 0 offen
  buffer_load_dwordx4 v[14:17], v13, s[4:7], 0 offen offset:32
  s_waitcnt lgkmcnt(0)
  v_mfma_f32_32x32x16_bf16 v[128:143], a[208:211], a[240:243], v[128:143]
  s_waitcnt vmcnt(14)
  ds_read_b64_tr_b16 a[192:193], v4
  ds_read_b64_tr_b16 a[194:195], v4 offset:1024
  s_add_u32 m0, s47, 0x4000
  v_accvgpr_read_b32 v56, a134
  v_accvgpr_read_b32 v57, a135
  v_mfma_f32_32x32x16_bf16 v[144:159], a[208:211], a[244:247], v[144:159]
  ds_read_b128 a[224:227], v0
  ds_read_b128 a[228:231], v0 offset:1024
  buffer_load_dwordx4 v20, s[20:23], s48 offen lds
  v_lshlrev_b32 v36, 16, v54
  v_and_b32 v37, 0xffff0000, v54
  v_mfma_f32_32x32x16_bf16 v[160:175], a[212:215], a[240:243], v[160:175]
  ds_read_b64_tr_b16 a[196:197], v5
  ds_read_b64_tr_b16 a[198:199], v5 offset:1024
  s_add_u32 s63, s48, 0x8000
  s_and_b32 s63, s63, 0x7ffff
  v_lshlrev_b32 v38, 16, v55
  v_and_b32 v39, 0xffff0000, v55
  v_mfma_f32_32x32x16_bf16 v[176:191], a[212:215], a[244:247], v[176:191]
  ds_read_b128 a[232:235], v0 offset:2048
  ds_read_b128 a[236:239], v0 offset:3072
  buffer_load_dwordx4 v21, s[20:23], s48 offen offset:1024 lds
  v_lshlrev_b32 v40, 16, v56
  v_and_b32 v41, 0xffff0000, v56
  v_mfma_f32_32x32x16_bf16 v[128:143], a[216:219], a[248:251], v[128:143]
  ds_read_b64_tr_b16 a[200:201], v4 offset:2048
  ds_read_b64_tr_b16 a[202:203], v4 offset:3072
  s_cmp_eq_u32 s63, s62
  s_cselect_b32 s63, s54, s63
  v_lshlrev_b32 v42, 16, v57
  v_and_b32 v43, 0xffff0000, v57
  v_mfma_f32_32x32x16_bf16 v[144:159], a[216:219], a[252:255], v[144:159]
  buffer_load_dwordx4 v22, s[20:23], s48 offen offset:2048 lds
  s_add_u32 s58, s58, 0x1000
  s_and_b32 s58, s58, 0xffff
  v_accvgpr_read_b32 v50, a136
  v_accvgpr_read_b32 v51, a137
  v_mfma_f32_32x32x16_bf16 v[160:175], a[220:223], a[248:251], v[160:175]
  ds_read_b64_tr_b16 a[204:205], v5 offset:2048
  ds_read_b64_tr_b16 a[206:207], v5 offset:3072
  s_cmp_eq_u32 s58, s8
  s_cselect_b32 s58, s13, s58
  v_accvgpr_read_b32 v52, a138
  v_accvgpr_read_b32 v53, a139
  v_mfma_f32_32x32x16_bf16 v[176:191], a[220:223], a[252:255], v[176:191]
  buffer_load_dwordx4 v23, s[20:23], s48 offen offset:3072 lds
  v_add_u32 v0, s58, v2
  v_dot2_f32_bf16 v28, v50, s15, v28
  v_dot2_f32_bf16 v29, v50, s3, v29
  s_waitcnt lgkmcnt(0)
  v_mfma_f32_32x32x16_bf16 v[128:143], a[192:195], a[224:227], v[128:143]
  s_waitcnt vmcnt(14)
  ds_read_b64_tr_b16 a[208:209], v4 offset:4096
  ds_read_b64_tr_b16 a[210:211], v4 offset:5120
  s_add_u32 m0, s47, 0x5000
  v_dot2_f32_bf16 v30, v51, s15, v30
  v_dot2_f32_bf16 v31, v51, s3, v31
  v_mfma_f32_32x32x16_bf16 v[144:159], a[192:195], a[228:231], v[144:159]
  ds_read_b128 a[240:243], v0
  ds_read_b128 a[244:247], v0 offset:1024
  buffer_load_dwordx4 v20, s[20:23], s63 offen lds
  v_dot2_f32_bf16 v32, v52, s15, v32
  v_dot2_f32_bf16 v33, v52, s3, v33
  v_mfma_f32_32x32x16_bf16 v[160:175], a[196:199], a[224:227], v[160:175]
  ds_read_b64_tr_b16 a[212:213], v5 offset:4096
  ds_read_b64_tr_b16 a[214:215], v5 offset:5120
  s_add_u32 s48, s63, 0x8000
  s_and_b32 s48, s48, 0x7ffff
  v_dot2_f32_bf16 v34, v53, s15, v34
  v_dot2_f32_bf16 v35, v53, s3, v35
  v_mfma_f32_32x32x16_bf16 v[176:191], a[196:199], a[228:231], v[176:191]
  ds_read_b128 a[248:251], v0 offset:2048
  ds_read_b128 a[252:255], v0 offset:3072
  buffer_load_dwordx4 v21, s[20:23], s63 offen offset:1024 lds
  v_accvgpr_read_b32 v54, a140
  v_accvgpr_read_b32 v55, a141
  v_mfma_f32_32x32x16_bf16 v[128:143], a[200:203], a[232:235], v[128:143]
  ds_read_b64_tr_b16 a[216:217], v4 offset:6144
  ds_read_b64_tr_b16 a[218:219], v4 offset:7168
  s_cmp_eq_u32 s48, s62
  s_cselect_b32 s48, s54, s48
  v_accvgpr_read_b32 v56, a142
  v_accvgpr_read_b32 v57, a143
  v_mfma_f32_32x32x16_bf16 v[144:159], a[200:203], a[236:239], v[144:159]
  buffer_load_dwordx4 v22, s[20:23], s63 offen offset:2048 lds
  s_add_u32 s58, s58, 0x1000
  s_and_b32 s58, s58, 0xffff
  v_dot2_f32_bf16 v36, v54, s15, v36
  v_dot2_f32_bf16 v37, v54, s3, v37
  v_mfma_f32_32x32x16_bf16 v[160:175], a[204:207], a[232:235], v[160:175]
  ds_read_b64_tr_b16 a[220:221], v5 offset:6144
  ds_read_b64_tr_b16 a[222:223], v5 offset:7168
  s_cmp_eq_u32 s58, s8
  s_cselect_b32 s58, s13, s58
  v_dot2_f32_bf16 v38, v55, s15, v38
  v_dot2_f32_bf16 v39, v55, s3, v39
  v_mfma_f32_32x32x16_bf16 v[176:191], a[204:207], a[236:239], v[176:191]
  buffer_load_dwordx4 v23, s[20:23], s63 offen offset:3072 lds
  v_add_u32 v0, s58, v2
  v_dot2_f32_bf16 v40, v56, s15, v40
  v_dot2_f32_bf16 v41, v56, s3, v41
  s_waitcnt lgkmcnt(0)
  v_mfma_f32_32x32x16_bf16 v[128:143], a[208:211], a[240:243], v[128:143]
  s_waitcnt vmcnt(14)
  ds_read_b64_tr_b16 a[192:193], v4 offset:8192
  ds_read_b64_tr_b16 a[194:195], v4 offset:9216
  s_add_u32 m0, s47, 0
  v_dot2_f32_bf16 v42, v57, s15, v42
  v_dot2_f32_bf16 v43, v57, s3, v43
  v_mfma_f32_32x32x16_bf16 v[144:159], a[208:211], a[244:247], v[144:159]
  ds_read_b128 a[224:227], v0
  ds_read_b128 a[228:231], v0 offset:1024
  buffer_load_dwordx4 v20, s[20:23], s48 offen lds
  v_accvgpr_read_b32 v50, a144
  v_accvgpr_read_b32 v51, a145
  v_mfma_f32_32x32x16_bf16 v[160:175], a[212:215], a[240:243], v[160:175]
  ds_read_b64_tr_b16 a[196:197], v5 offset:8192
  ds_read_b64_tr_b16 a[198:199], v5 offset:9216
  s_add_u32 s63, s48, 0x8000
  s_and_b32 s63, s63, 0x7ffff
  v_accvgpr_read_b32 v52, a146
  v_accvgpr_read_b32 v53, a147
  v_mfma_f32_32x32x16_bf16 v[176:191], a[212:215], a[244:247], v[176:191]
  ds_read_b128 a[232:235], v0 offset:2048
  ds_read_b128 a[236:239], v0 offset:3072
  buffer_load_dwordx4 v21, s[20:23], s48 offen offset:1024 lds
  v_dot2_f32_bf16 v28, v50, s15, v28
  v_dot2_f32_bf16 v29, v50, s3, v29
  v_mfma_f32_32x32x16_bf16 v[128:143], a[216:219], a[248:251], v[128:143]
  ds_read_b64_tr_b16 a[200:201], v4 offset:10240
  ds_read_b64_tr_b16 a[202:203], v4 offset:11264
  s_cmp_eq_u32 s63, s62
  s_cselect_b32 s63, s54, s63
  v_dot2_f32_bf16 v30, v51, s15, v30
  v_dot2_f32_bf16 v31, v51, s3, v31
  v_mfma_f32_32x32x16_bf16 v[144:159], a[216:219], a[252:255], v[144:159]
  buffer_load_dwordx4 v22, s[20:23], s48 offen offset:2048 lds
  s_add_u32 s58, s58, 0x1000
  s_and_b32 s58, s58, 0xffff
  v_dot2_f32_bf16 v32, v52, s15, v32
  v_dot2_f32_bf16 v33, v52, s3, v33
  v_mfma_f32_32x32x16_bf16 v[160:175], a[220:223], a[248:251], v[160:175]
  ds_read_b64_tr_b16 a[204:205], v5 offset:10240
  ds_read_b64_tr_b16 a[206:207], v5 offset:11264
  s_cmp_eq_u32 s58, s8
  s_cselect_b32 s58, s13, s58
  v_dot2_f32_bf16 v34, v53, s15, v34
  v_dot2_f32_bf16 v35, v53, s3, v35
  v_mfma_f32_32x32x16_bf16 v[176:191], a[220:223], a[252:255], v[176:191]
  buffer_load_dwordx4 v23, s[20:23], s48 offen offset:3072 lds
  v_add_u32 v0, s58, v2
  v_accvgpr_read_b32 v54, a148
  v_accvgpr_read_b32 v55, a149
  s_waitcnt lgkmcnt(0)
  v_mfma_f32_32x32x16_bf16 v[128:143], a[192:195], a[224:227], v[128:143]
  s_waitcnt vmcnt(14)
  ds_read_b64_tr_b16 a[208:209], v4 offset:12288
  ds_read_b64_tr_b16 a[210:211], v4 offset:13312
  s_add_u32 m0, s47, 0x1000
  v_accvgpr_read_b32 v56, a150
  v_accvgpr_read_b32 v57, a151
  v_mfma_f32_32x32x16_bf16 v[144:159], a[192:195], a[228:231], v[144:159]
  ds_read_b128 a[240:243], v0
  ds_read_b128 a[244:247], v0 offset:1024
  buffer_load_dwordx4 v20, s[20:23], s63 offen lds
  v_dot2_f32_bf16 v36, v54, s15, v36
  v_dot2_f32_bf16 v37, v54, s3, v37
  v_mfma_f32_32x32x16_bf16 v[160:175], a[196:199], a[224:227], v[160:175]
  ds_read_b64_tr_b16 a[212:213], v5 offset:12288
  ds_read_b64_tr_b16 a[214:215], v5 offset:13312
  s_add_u32 s48, s63, 0x8000
  s_and_b32 s48, s48, 0x7ffff
  v_dot2_f32_bf16 v38, v55, s15, v38
  v_dot2_f32_bf16 v39, v55, s3, v39
  v_mfma_f32_32x32x16_bf16 v[176:191], a[196:199], a[228:231], v[176:191]
  ds_read_b128 a[248:251], v0 offset:2048
  ds_read_b128 a[252:255], v0 offset:3072
  buffer_load_dwordx4 v21, s[20:23], s63 offen offset:1024 lds
  v_dot2_f32_bf16 v40, v56, s15, v40
  v_dot2_f32_bf16 v41, v56, s3, v41
  v_mfma_f32_32x32x16_bf16 v[128:143], a[200:203], a[232:235], v[128:143]
  ds_read_b64_tr_b16 a[216:217], v4 offset:14336
  ds_read_b64_tr_b16 a[218:219], v4 offset:15360
  s_cmp_eq_u32 s48, s62
  s_cselect_b32 s48, s54, s48
  v_dot2_f32_bf16 v42, v57, s15, v42
  v_dot2_f32_bf16 v43, v57, s3, v43
  v_mfma_f32_32x32x16_bf16 v[144:159], a[200:203], a[236:239], v[144:159]
  buffer_load_dwordx4 v22, s[20:23], s63 offen offset:2048 lds
  s_add_u32 s58, s58, 0x1000
  s_and_b32 s58, s58, 0xffff
  v_accvgpr_read_b32 v50, a152
  v_accvgpr_read_b32 v51, a153
  v_mfma_f32_32x32x16_bf16 v[160:175], a[204:207], a[232:235], v[160:175]
  ds_read_b64_tr_b16 a[220:221], v5 offset:14336
  ds_read_b64_tr_b16 a[222:223], v5 offset:15360
  s_cmp_eq_u32 s58, s8
  s_cselect_b32 s58, s13, s58
  v_accvgpr_read_b32 v52, a154
  v_accvgpr_read_b32 v53, a155
  v_mfma_f32_32x32x16_bf16 v[176:191], a[204:207], a[236:239], v[176:191]
  buffer_load_dwordx4 v23, s[20:23], s63 offen offset:3072 lds
  v_add_u32 v0, s58, v2
  v_dot2_f32_bf16 v28, v50, s15, v28
  v_dot2_f32_bf16 v29, v50, s3, v29
  s_waitcnt lgkmcnt(0)
  v_mfma_f32_32x32x16_bf16 v[128:143], a[208:211], a[240:243], v[128:143]
  s_waitcnt vmcnt(12)
  ds_read_b64_tr_b16 a[192:193], v4 offset:16384
  ds_read_b64_tr_b16 a[194:195], v4 offset:17408
  s_add_u32 m0, s47, 0x2000
  v_dot2_f32_bf16 v30, v51, s15, v30
  v_dot2_f32_bf16 v31, v51, s3, v31
  v_mfma_f32_32x32x16_bf16 v[144:159], a[208:211], a[244:247], v[144:159]
  ds_read_b128 a[224:227], v0
  ds_read_b128 a[228:231], v0 offset:1024
  buffer_load_dwordx4 v20, s[20:23], s48 offen lds
  v_dot2_f32_bf16 v32, v52, s15, v32
  v_dot2_f32_bf16 v33, v52, s3, v33
  v_mfma_f32_32x32x16_bf16 v[160:175], a[212:215], a[240:243], v[160:175]
  ds_read_b64_tr_b16 a[196:197], v5 offset:16384
  ds_read_b64_tr_b16 a[198:199], v5 offset:17408
  s_add_u32 s63, s48, 0x8000
  s_and_b32 s63, s63, 0x7ffff
  v_dot2_f32_bf16 v34, v53, s15, v34
  v_dot2_f32_bf16 v35, v53, s3, v35
  v_mfma_f32_32x32x16_bf16 v[176:191], a[212:215], a[244:247], v[176:191]
  ds_read_b128 a[232:235], v0 offset:2048
  ds_read_b128 a[236:239], v0 offset:3072
  buffer_load_dwordx4 v21, s[20:23], s48 offen offset:1024 lds
  v_accvgpr_read_b32 v54, a156
  v_accvgpr_read_b32 v55, a157
  v_mfma_f32_32x32x16_bf16 v[128:143], a[216:219], a[248:251], v[128:143]
  ds_read_b64_tr_b16 a[200:201], v4 offset:18432
  ds_read_b64_tr_b16 a[202:203], v4 offset:19456
  s_cmp_eq_u32 s63, s62
  s_cselect_b32 s63, s54, s63
  v_accvgpr_read_b32 v56, a158
  v_accvgpr_read_b32 v57, a159
  v_mfma_f32_32x32x16_bf16 v[144:159], a[216:219], a[252:255], v[144:159]
  buffer_load_dwordx4 v22, s[20:23], s48 offen offset:2048 lds
  s_add_u32 s58, s58, 0x1000
  s_and_b32 s58, s58, 0xffff
  v_dot2_f32_bf16 v36, v54, s15, v36
  v_dot2_f32_bf16 v37, v54, s3, v37
  v_mfma_f32_32x32x16_bf16 v[160:175], a[220:223], a[248:251], v[160:175]
  ds_read_b64_tr_b16 a[204:205], v5 offset:18432
  ds_read_b64_tr_b16 a[206:207], v5 offset:19456
  s_cmp_eq_u32 s58, s8
  s_cselect_b32 s58, s13, s58
  v_dot2_f32_bf16 v38, v55, s15, v38
  v_dot2_f32_bf16 v39, v55, s3, v39
  v_mfma_f32_32x32x16_bf16 v[176:191], a[220:223], a[252:255], v[176:191]
  buffer_load_dwordx4 v23, s[20:23], s48 offen offset:3072 lds
  v_add_u32 v0, s58, v2
  v_dot2_f32_bf16 v40, v56, s15, v40
  v_dot2_f32_bf16 v41, v56, s3, v41
  s_waitcnt lgkmcnt(0)
  v_mfma_f32_32x32x16_bf16 v[128:143], a[192:195], a[224:227], v[128:143]
  s_waitcnt vmcnt(12)
  ds_read_b64_tr_b16 a[208:209], v4 offset:20480
  ds_read_b64_tr_b16 a[210:211], v4 offset:21504
  s_add_u32 m0, s47, 0x3000
  v_dot2_f32_bf16 v42, v57, s15, v42
  v_dot2_f32_bf16 v43, v57, s3, v43
  v_mfma_f32_32x32x16_bf16 v[144:159], a[192:195], a[228:231], v[144:159]
  ds_read_b128 a[240:243], v0
  ds_read_b128 a[244:247], v0 offset:1024
  buffer_load_dwordx4 v20, s[20:23], s63 offen lds
  v_accvgpr_read_b32 v50, a160
  v_accvgpr_read_b32 v51, a161
  v_mfma_f32_32x32x16_bf16 v[160:175], a[196:199], a[224:227], v[160:175]
  ds_read_b64_tr_b16 a[212:213], v5 offset:20480
  ds_read_b64_tr_b16 a[214:215], v5 offset:21504
  s_lshr_b32 s48, s100, 1
  s_and_b32 s48, s48, 15
  v_accvgpr_read_b32 v52, a162
  v_accvgpr_read_b32 v53, a163
  v_mfma_f32_32x32x16_bf16 v[176:191], a[196:199], a[228:231], v[176:191]
  ds_read_b128 a[248:251], v0 offset:2048
  ds_read_b128 a[252:255], v0 offset:3072
  buffer_load_dwordx4 v21, s[20:23], s63 offen offset:1024 lds
  v_dot2_f32_bf16 v28, v50, s15, v28
  v_dot2_f32_bf16 v29, v50, s3, v29
  v_mfma_f32_32x32x16_bf16 v[128:143], a[200:203], a[232:235], v[128:143]
  ds_read_b64_tr_b16 a[216:217], v4 offset:22528
  ds_read_b64_tr_b16 a[218:219], v4 offset:23552
  s_lshl_b32 s48, s48, 15
  v_dot2_f32_bf16 v30, v51, s15, v30
  v_dot2_f32_bf16 v31, v51, s3, v31
  v_dot2_f32_bf16 v32, v52, s15, v32
  v_mfma_f32_32x32x16_bf16 v[144:159], a[200:203], a[236:239], v[144:159]
  buffer_load_dwordx4 v22, s[20:23], s63 offen offset:2048 lds
  s_add_u32 s58, s58, 0x1000
  s_and_b32 s58, s58, 0xffff
  v_dot2_f32_bf16 v33, v52, s3, v33
  v_dot2_f32_bf16 v34, v53, s15, v34
  v_mfma_f32_32x32x16_bf16 v[160:175], a[204:207], a[232:235], v[160:175]
  ds_read_b64_tr_b16 a[220:221], v5 offset:22528
  ds_read_b64_tr_b16 a[222:223], v5 offset:23552
  s_cmp_eq_u32 s58, s8
  s_cselect_b32 s58, s13, s58
  v_dot2_f32_bf16 v35, v53, s3, v35
  v_accvgpr_read_b32 v54, a164
  v_mfma_f32_32x32x16_bf16 v[176:191], a[204:207], a[236:239], v[176:191]
  buffer_load_dwordx4 v23, s[20:23], s63 offen offset:3072 lds
  v_add_u32 v0, s58, v2
  v_accvgpr_read_b32 v55, a165
  v_accvgpr_read_b32 v56, a166
  s_waitcnt lgkmcnt(0)
  v_mfma_f32_32x32x16_bf16 v[128:143], a[208:211], a[240:243], v[128:143]
  s_waitcnt vmcnt(12)
  ds_read_b64_tr_b16 a[192:193], v4
  ds_read_b64_tr_b16 a[194:195], v4 offset:1024
  s_add_u32 m0, s47, 0x4000
  v_xor_b32 v20, 0x80, v20
  v_xor_b32 v21, 0x80, v21
  v_xor_b32 v22, 0x80, v22
  v_xor_b32 v23, 0x80, v23
  v_mfma_f32_32x32x16_bf16 v[144:159], a[208:211], a[244:247], v[144:159]
  ds_read_b128 a[224:227], v0
  ds_read_b128 a[228:231], v0 offset:1024
  buffer_load_dwordx4 v20, s[20:23], s48 offen lds
  v_accvgpr_read_b32 v57, a167
  v_dot2_f32_bf16 v36, v54, s15, v36
  v_mfma_f32_32x32x16_bf16 v[160:175], a[212:215], a[240:243], v[160:175]
  ds_read_b64_tr_b16 a[196:197], v5
  ds_read_b64_tr_b16 a[198:199], v5 offset:1024
  s_add_u32 s63, s48, 0x8000
  s_and_b32 s63, s63, 0x7ffff
  v_dot2_f32_bf16 v37, v54, s3, v37
  v_dot2_f32_bf16 v38, v55, s15, v38
  v_mfma_f32_32x32x16_bf16 v[176:191], a[212:215], a[244:247], v[176:191]
  ds_read_b128 a[232:235], v0 offset:2048
  ds_read_b128 a[236:239], v0 offset:3072
  buffer_load_dwordx4 v21, s[20:23], s48 offen offset:1024 lds
  v_dot2_f32_bf16 v39, v55, s3, v39
  v_dot2_f32_bf16 v40, v56, s15, v40
  v_mfma_f32_32x32x16_bf16 v[128:143], a[216:219], a[248:251], v[128:143]
  ds_read_b64_tr_b16 a[200:201], v4 offset:2048
  ds_read_b64_tr_b16 a[202:203], v4 offset:3072
  v_dot2_f32_bf16 v41, v56, s3, v41
  v_dot2_f32_bf16 v42, v57, s15, v42
  v_dot2_f32_bf16 v43, v57, s3, v43
  v_mfma_f32_32x32x16_bf16 v[144:159], a[216:219], a[252:255], v[144:159]
  buffer_load_dwordx4 v22, s[20:23], s48 offen offset:2048 lds
  s_add_u32 s58, s58, 0x1000
  s_and_b32 s58, s58, 0xffff
  v_mfma_f32_32x32x16_bf16 v[160:175], a[220:223], a[248:251], v[160:175]
  ds_read_b64_tr_b16 a[204:205], v5 offset:2048
  ds_read_b64_tr_b16 a[206:207], v5 offset:3072
  s_cmp_eq_u32 s58, s8
  s_cselect_b32 s58, s13, s58
  v_mfma_f32_32x32x16_bf16 v[176:191], a[220:223], a[252:255], v[176:191]
  buffer_load_dwordx4 v23, s[20:23], s48 offen offset:3072 lds
  v_add_u32 v0, s58, v2
  s_waitcnt lgkmcnt(0)
  v_mfma_f32_32x32x16_bf16 v[128:143], a[192:195], a[224:227], v[128:143]
  s_waitcnt vmcnt(12)
  ds_read_b64_tr_b16 a[208:209], v4 offset:4096
  ds_read_b64_tr_b16 a[210:211], v4 offset:5120
  s_add_u32 m0, s47, 0x5000
  v_mfma_f32_32x32x16_bf16 v[144:159], a[192:195], a[228:231], v[144:159]
  ds_read_b128 a[240:243], v0
  ds_read_b128 a[244:247], v0 offset:1024
  buffer_load_dwordx4 v20, s[20:23], s63 offen lds
  v_mfma_f32_32x32x16_bf16 v[160:175], a[196:199], a[224:227], v[160:175]
  ds_read_b64_tr_b16 a[212:213], v5 offset:4096
  ds_read_b64_tr_b16 a[214:215], v5 offset:5120
  s_add_u32 s48, s63, 0x8000
  s_and_b32 s48, s48, 0x7ffff
  v_mfma_f32_32x32x16_bf16 v[176:191], a[196:199], a[228:231], v[176:191]
  ds_read_b128 a[248:251], v0 offset:2048
  ds_read_b128 a[252:255], v0 offset:3072
  buffer_load_dwordx4 v21, s[20:23], s63 offen offset:1024 lds
  v_mfma_f32_32x32x16_bf16 v[128:143], a[200:203], a[232:235], v[128:143]
  ds_read_b64_tr_b16 a[216:217], v4 offset:6144
  ds_read_b64_tr_b16 a[218:219], v4 offset:7168
  v_mfma_f32_32x32x16_bf16 v[144:159], a[200:203], a[236:239], v[144:159]
  buffer_load_dwordx4 v22, s[20:23], s63 offen offset:2048 lds
  s_add_u32 s58, s58, 0x1000
  s_and_b32 s58, s58, 0xffff
  v_mfma_f32_32x32x16_bf16 v[160:175], a[204:207], a[232:235], v[160:175]
  ds_read_b64_tr_b16 a[220:221], v5 offset:6144
  ds_read_b64_tr_b16 a[222:223], v5 offset:7168
  s_cmp_eq_u32 s58, s8
  s_cselect_b32 s58, s13, s58
  v_mfma_f32_32x32x16_bf16 v[176:191], a[204:207], a[236:239], v[176:191]
  buffer_load_dwordx4 v23, s[20:23], s63 offen offset:3072 lds
  v_add_u32 v0, s58, v2
  s_waitcnt lgkmcnt(0)
  v_mfma_f32_32x32x16_bf16 v[128:143], a[208:211], a[240:243], v[128:143]
  s_waitcnt vmcnt(12)
  ds_read_b64_tr_b16 a[192:193], v4 offset:8192
  ds_read_b64_tr_b16 a[194:195], v4 offset:9216
  s_add_u32 m0, s47, 0
  v_mfma_f32_32x32x16_bf16 v[144:159], a[208:211], a[244:247], v[144:159]
  ds_read_b128 a[224:227], v0
  ds_read_b128 a[228:231], v0 offset:1024
  buffer_load_dwordx4 v20, s[20:23], s48 offen lds
  v_mfma_f32_32x32x16_bf16 v[160:175], a[212:215], a[240:243], v[160:175]
  ds_read_b64_tr_b16 a[196:197], v5 offset:8192
  ds_read_b64_tr_b16 a[198:199], v5 offset:9216
  s_add_u32 s63, s48, 0x8000
  s_and_b32 s63, s63, 0x7ffff
  v_mfma_f32_32x32x16_bf16 v[176:191], a[212:215], a[244:247], v[176:191]
  ds_read_b128 a[232:235], v0 offset:2048
  ds_read_b128 a[236:239], v0 offset:3072
  buffer_load_dwordx4 v21, s[20:23], s48 offen offset:1024 lds
  v_mfma_f32_32x32x16_bf16 v[128:143], a[216:219], a[248:251], v[128:143]
  ds_read_b64_tr_b16 a[200:201], v4 offset:10240
  ds_read_b64_tr_b16 a[202:203], v4 offset:11264
  v_mfma_f32_32x32x16_bf16 v[144:159], a[216:219], a[252:255], v[144:159]
  buffer_load_dwordx4 v22, s[20:23], s48 offen offset:2048 lds
  s_add_u32 s58, s58, 0x1000
  s_and_b32 s58, s58, 0xffff
  v_mfma_f32_32x32x16_bf16 v[160:175], a[220:223], a[248:251], v[160:175]
  ds_read_b64_tr_b16 a[204:205], v5 offset:10240
  ds_read_b64_tr_b16 a[206:207], v5 offset:11264
  s_cmp_eq_u32 s58, s8
  s_cselect_b32 s58, s13, s58
  v_mfma_f32_32x32x16_bf16 v[176:191], a[220:223], a[252:255], v[176:191]
  buffer_load_dwordx4 v23, s[20:23], s48 offen offset:3072 lds
  v_add_u32 v0, s58, v2
  s_waitcnt lgkmcnt(0)
  v_mfma_f32_32x32x16_bf16 v[128:143], a[192:195], a[224:227], v[128:143]
  s_waitcnt vmcnt(12)
  ds_read_b64_tr_b16 a[208:209], v4 offset:12288
  ds_read_b64_tr_b16 a[210:211], v4 offset:13312
  s_add_u32 m0, s47, 0x1000
  v_mfma_f32_32x32x16_bf16 v[144:159], a[192:195], a[228:231], v[144:159]
  ds_read_b128 a[240:243], v0
  ds_read_b128 a[244:247], v0 offset:1024
  buffer_load_dwordx4 v20, s[20:23], s63 offen lds
  v_mfma_f32_32x32x16_bf16 v[160:175], a[196:199], a[224:227], v[160:175]
  ds_read_b64_tr_b16 a[212:213], v5 offset:12288
  ds_read_b64_tr_b16 a[214:215], v5 offset:13312
  s_add_u32 s48, s63, 0x8000
  s_and_b32 s48, s48, 0x7ffff
  v_mfma_f32_32x32x16_bf16 v[176:191], a[196:199], a[228:231], v[176:191]
  ds_read_b128 a[248:251], v0 offset:2048
  ds_read_b128 a[252:255], v0 offset:3072
  buffer_load_dwordx4 v21, s[20:23], s63 offen offset:1024 lds
  v_mfma_f32_32x32x16_bf16 v[128:143], a[200:203], a[232:235], v[128:143]
  ds_read_b64_tr_b16 a[216:217], v4 offset:14336
  ds_read_b64_tr_b16 a[218:219], v4 offset:15360
  v_mfma_f32_32x32x16_bf16 v[144:159], a[200:203], a[236:239], v[144:159]
  buffer_load_dwordx4 v22, s[20:23], s63 offen offset:2048 lds
  s_lshr_b32 s58, s100, 1
  s_and_b32 s58, s58, 15
  v_mfma_f32_32x32x16_bf16 v[160:175], a[204:207], a[232:235], v[160:175]
  ds_read_b64_tr_b16 a[220:221], v5 offset:14336
  ds_read_b64_tr_b16 a[222:223], v5 offset:15360
  s_lshl_b32 s58, s58, 12
  v_mfma_f32_32x32x16_bf16 v[176:191], a[204:207], a[236:239], v[176:191]
  buffer_load_dwordx4 v23, s[20:23], s63 offen offset:3072 lds
  v_add_u32 v0, s58, v3
  v_xor_b32 v12, 0x400, v0
  s_waitcnt lgkmcnt(0)
  v_mfma_f32_32x32x16_bf16 v[128:143], a[208:211], a[240:243], v[128:143]
  s_waitcnt vmcnt(12)
  ds_read_b64_tr_b16 a[192:193], v6 offset:16384
  ds_read_b64_tr_b16 a[194:195], v6 offset:17408
  s_add_u32 m0, s47, 0x2000
  v_mfma_f32_32x32x16_bf16 v[144:159], a[208:211], a[244:247], v[144:159]
  ds_read_b128 a[224:227], v0
  ds_read_b128 a[228:231], v12
  buffer_load_dwordx4 v20, s[20:23], s48 offen lds
  v_mfma_f32_32x32x16_bf16 v[160:175], a[212:215], a[240:243], v[160:175]
  ds_read_b64_tr_b16 a[196:197], v7 offset:16384
  ds_read_b64_tr_b16 a[198:199], v7 offset:17408
  s_add_u32 s63, s48, 0x8000
  s_and_b32 s63, s63, 0x7ffff
  v_mfma_f32_32x32x16_bf16 v[176:191], a[212:215], a[244:247], v[176:191]
  ds_read_b128 a[232:235], v0 offset:2048
  ds_read_b128 a[236:239], v12 offset:2048
  buffer_load_dwordx4 v21, s[20:23], s48 offen offset:1024 lds
  v_mfma_f32_32x32x16_bf16 v[128:143], a[216:219], a[248:251], v[128:143]
  ds_read_b64_tr_b16 a[200:201], v6 offset:18432
  ds_read_b64_tr_b16 a[202:203], v6 offset:19456
  v_mfma_f32_32x32x16_bf16 v[144:159], a[216:219], a[252:255], v[144:159]
  buffer_load_dwordx4 v22, s[20:23], s48 offen offset:2048 lds
  s_add_u32 s58, s58, 0x1000
  s_and_b32 s58, s58, 0xffff
  v_mfma_f32_32x32x16_bf16 v[160:175], a[220:223], a[248:251], v[160:175]
  ds_read_b64_tr_b16 a[204:205], v7 offset:18432
  ds_read_b64_tr_b16 a[206:207], v7 offset:19456
  v_mfma_f32_32x32x16_bf16 v[176:191], a[220:223], a[252:255], v[176:191]
  buffer_load_dwordx4 v23, s[20:23], s48 offen offset:3072 lds
  v_add_u32 v0, s58, v3
  v_xor_b32 v12, 0x400, v0
  s_waitcnt lgkmcnt(0)
  v_mfma_f32_32x32x16_bf16 v[192:207], a[192:195], a[224:227], 0
  s_waitcnt vmcnt(12)
  ds_read_b64_tr_b16 a[208:209], v6 offset:20480
  ds_read_b64_tr_b16 a[210:211], v6 offset:21504
  s_add_u32 m0, s47, 0x3000
  v_mfma_f32_32x32x16_bf16 v[208:223], a[192:195], a[228:231], 0
  ds_read_b128 a[240:243], v0
  ds_read_b128 a[244:247], v12
  buffer_load_dwordx4 v20, s[20:23], s63 offen lds
  v_mfma_f32_32x32x16_bf16 v[224:239], a[196:199], a[224:227], 0
  ds_read_b64_tr_b16 a[212:213], v7 offset:20480
  ds_read_b64_tr_b16 a[214:215], v7 offset:21504
  s_add_u32 s48, s63, 0x8000
  s_and_b32 s48, s48, 0x7ffff
  v_cvt_pk_bf16_f32 v128, v128, v129
  v_cvt_pk_bf16_f32 v129, v130, v131
  v_mfma_f32_32x32x16_bf16 v[240:255], a[196:199], a[228:231], 0
  ds_read_b128 a[248:251], v0 offset:2048
  ds_read_b128 a[252:255], v12 offset:2048
  buffer_load_dwordx4 v21, s[20:23], s63 offen offset:1024 lds
  v_mfma_f32_32x32x16_bf16 v[192:207], a[200:203], a[232:235], v[192:207]
  ds_read_b64_tr_b16 a[216:217], v6 offset:22528
  ds_read_b64_tr_b16 a[218:219], v6 offset:23552
  v_cvt_pk_bf16_f32 v130, v132, v133
  v_cvt_pk_bf16_f32 v131, v134, v135
  v_mfma_f32_32x32x16_bf16 v[208:223], a[200:203], a[236:239], v[208:223]
  buffer_load_dwordx4 v22, s[20:23], s63 offen offset:2048 lds
  s_add_u32 s58, s58, 0x1000
  s_and_b32 s58, s58, 0xffff
  s_add_u32 s53, s9, 0
  v_mfma_f32_32x32x16_bf16 v[224:239], a[204:207], a[232:235], v[224:239]
  ds_read_b64_tr_b16 a[220:221], v7 offset:22528
  ds_read_b64_tr_b16 a[222:223], v7 offset:23552
  buffer_store_dwordx4 v[128:131], v27, s[40:43], s53 offen sc1
  v_mfma_f32_32x32x16_bf16 v[240:255], a[204:207], a[236:239], v[240:255]
  buffer_load_dwordx4 v23, s[20:23], s63 offen offset:3072 lds
  v_add_u32 v0, s58, v3
  v_xor_b32 v12, 0x400, v0
  s_waitcnt lgkmcnt(0)
  v_mfma_f32_32x32x16_bf16 v[192:207], a[208:211], a[240:243], v[192:207]
  s_waitcnt vmcnt(13)
  ds_read_b64_tr_b16 a[192:193], v6
  ds_read_b64_tr_b16 a[194:195], v6 offset:1024
  s_add_u32 m0, s47, 0x4000
  v_mfma_f32_32x32x16_bf16 v[208:223], a[208:211], a[244:247], v[208:223]
  ds_read_b128 a[224:227], v0
  ds_read_b128 a[228:231], v12
  buffer_load_dwordx4 v20, s[20:23], s48 offen lds
  v_mfma_f32_32x32x16_bf16 v[224:239], a[212:215], a[240:243], v[224:239]
  ds_read_b64_tr_b16 a[196:197], v7
  ds_read_b64_tr_b16 a[198:199], v7 offset:1024
  s_add_u32 s63, s48, 0x8000
  s_and_b32 s63, s63, 0x7ffff
  v_cvt_pk_bf16_f32 v136, v136, v137
  v_cvt_pk_bf16_f32 v137, v138, v139
  v_mfma_f32_32x32x16_bf16 v[240:255], a[212:215], a[244:247], v[240:255]
  ds_read_b128 a[232:235], v0 offset:2048
  ds_read_b128 a[236:239], v12 offset:2048
  buffer_load_dwordx4 v21, s[20:23], s48 offen offset:1024 lds
  v_mfma_f32_32x32x16_bf16 v[192:207], a[216:219], a[248:251], v[192:207]
  ds_read_b64_tr_b16 a[200:201], v6 offset:2048
  ds_read_b64_tr_b16 a[202:203], v6 offset:3072
  v_cvt_pk_bf16_f32 v138, v140, v141
  v_cvt_pk_bf16_f32 v139, v142, v143
  v_mfma_f32_32x32x16_bf16 v[208:223], a[216:219], a[252:255], v[208:223]
  buffer_load_dwordx4 v22, s[20:23], s48 offen offset:2048 lds
  s_add_u32 s58, s58, 0x1000
  s_and_b32 s58, s58, 0xffff
  v_mfma_f32_32x32x16_bf16 v[224:239], a[220:223], a[248:251], v[224:239]
  ds_read_b64_tr_b16 a[204:205], v7 offset:2048
  ds_read_b64_tr_b16 a[206:207], v7 offset:3072
  buffer_store_dwordx4 v[136:139], v27, s[40:43], s53 offen offset:1024 sc1
  v_mfma_f32_32x32x16_bf16 v[240:255], a[220:223], a[252:255], v[240:255]
  buffer_load_dwordx4 v23, s[20:23], s48 offen offset:3072 lds
  v_add_u32 v0, s58, v3
  v_xor_b32 v12, 0x400, v0
  s_waitcnt lgkmcnt(0)
  v_mfma_f32_32x32x16_bf16 v[192:207], a[192:195], a[224:227], v[192:207]
  s_waitcnt vmcnt(14)
  ds_read_b64_tr_b16 a[208:209], v6 offset:4096
  ds_read_b64_tr_b16 a[210:211], v6 offset:5120
  s_add_u32 m0, s47, 0x5000
  v_mfma_f32_32x32x16_bf16 v[208:223], a[192:195], a[228:231], v[208:223]
  ds_read_b128 a[240:243], v0
  ds_read_b128 a[244:247], v12
  buffer_load_dwordx4 v20, s[20:23], s63 offen lds
  v_mfma_f32_32x32x16_bf16 v[224:239], a[196:199], a[224:227], v[224:239]
  ds_read_b64_tr_b16 a[212:213], v7 offset:4096
  ds_read_b64_tr_b16 a[214:215], v7 offset:5120
  s_add_u32 s48, s63, 0x8000
  s_and_b32 s48, s48, 0x7ffff
  v_mfma_f32_32x32x16_bf16 v[240:255], a[196:199], a[228:231], v[240:255]
  ds_read_b128 a[248:251], v0 offset:2048
  ds_read_b128 a[252:255], v12 offset:2048
  buffer_load_dwordx4 v21, s[20:23], s63 offen offset:1024 lds
  v_mfma_f32_32x32x16_bf16 v[192:207], a[200:203], a[232:235], v[192:207]
  ds_read_b64_tr_b16 a[216:217], v6 offset:6144
  ds_read_b64_tr_b16 a[218:219], v6 offset:7168
  v_mfma_f32_32x32x16_bf16 v[208:223], a[200:203], a[236:239], v[208:223]
  buffer_load_dwordx4 v22, s[20:23], s63 offen offset:2048 lds
  s_add_u32 s58, s58, 0x1000
  s_and_b32 s58, s58, 0xffff
  v_mfma_f32_32x32x16_bf16 v[224:239], a[204:207], a[232:235], v[224:239]
  ds_read_b64_tr_b16 a[220:221], v7 offset:6144
  ds_read_b64_tr_b16 a[222:223], v7 offset:7168
  v_mfma_f32_32x32x16_bf16 v[240:255], a[204:207], a[236:239], v[240:255]
  buffer_load_dwordx4 v23, s[20:23], s63 offen offset:3072 lds
  v_add_u32 v0, s58, v3
  v_xor_b32 v12, 0x400, v0
  s_waitcnt lgkmcnt(0)
  v_mfma_f32_32x32x16_bf16 v[192:207], a[208:211], a[240:243], v[192:207]
  s_waitcnt vmcnt(14)
  ds_read_b64_tr_b16 a[192:193], v6 offset:8192
  ds_read_b64_tr_b16 a[194:195], v6 offset:9216
  s_add_u32 m0, s47, 0
  v_mfma_f32_32x32x16_bf16 v[208:223], a[208:211], a[244:247], v[208:223]
  ds_read_b128 a[224:227], v0
  ds_read_b128 a[228:231], v12
  buffer_load_dwordx4 v20, s[20:23], s48 offen lds
  v_mfma_f32_32x32x16_bf16 v[224:239], a[212:215], a[240:243], v[224:239]
  ds_read_b64_tr_b16 a[196:197], v7 offset:8192
  ds_read_b64_tr_b16 a[198:199], v7 offset:9216
  s_add_u32 s63, s48, 0x8000
  s_and_b32 s63, s63, 0x7ffff
  v_cvt_pk_bf16_f32 v144, v144, v145
  v_cvt_pk_bf16_f32 v145, v146, v147
  v_mfma_f32_32x32x16_bf16 v[240:255], a[212:215], a[244:247], v[240:255]
  ds_read_b128 a[232:235], v0 offset:2048
  ds_read_b128 a[236:239], v12 offset:2048
  buffer_load_dwordx4 v21, s[20:23], s48 offen offset:1024 lds
  v_mfma_f32_32x32x16_bf16 v[192:207], a[216:219], a[248:251], v[192:207]
  ds_read_b64_tr_b16 a[200:201], v6 offset:10240
  ds_read_b64_tr_b16 a[202:203], v6 offset:11264
  v_cvt_pk_bf16_f32 v146, v148, v149
  v_cvt_pk_bf16_f32 v147, v150, v151
  v_mfma_f32_32x32x16_bf16 v[208:223], a[216:219], a[252:255], v[208:223]
  buffer_load_dwordx4 v22, s[20:23], s48 offen offset:2048 lds
  s_add_u32 s58, s58, 0x1000
  s_and_b32 s58, s58, 0xffff
  s_add_u32 s53, s9, 0x10000
  v_mfma_f32_32x32x16_bf16 v[224:239], a[220:223], a[248:251], v[224:239]
  ds_read_b64_tr_b16 a[204:205], v7 offset:10240
  ds_read_b64_tr_b16 a[206:207], v7 offset:11264
  buffer_store_dwordx4 v[144:147], v27, s[40:43], s53 offen sc1
  v_mfma_f32_32x32x16_bf16 v[240:255], a[220:223], a[252:255], v[240:255]
  buffer_load_dwordx4 v23, s[20:23], s48 offen offset:3072 lds
  v_add_u32 v0, s58, v3
  v_xor_b32 v12, 0x400, v0
  s_waitcnt lgkmcnt(0)
  v_mfma_f32_32x32x16_bf16 v[192:207], a[192:195], a[224:227], v[192:207]
  s_waitcnt vmcnt(14)
  ds_read_b64_tr_b16 a[208:209], v6 offset:12288
  ds_read_b64_tr_b16 a[210:211], v6 offset:13312
  s_add_u32 m0, s47, 0x1000
  v_mfma_f32_32x32x16_bf16 v[208:223], a[192:195], a[228:231], v[208:223]
  ds_read_b128 a[240:243], v0
  ds_read_b128 a[244:247], v12
  buffer_load_dwordx4 v20, s[20:23], s63 offen lds
  v_mfma_f32_32x32x16_bf16 v[224:239], a[196:199], a[224:227], v[224:239]
  ds_read_b64_tr_b16 a[212:213], v7 offset:12288
  ds_read_b64_tr_b16 a[214:215], v7 offset:13312
  s_add_u32 s48, s63, 0x8000
  s_and_b32 s48, s48, 0x7ffff
  v_cvt_pk_bf16_f32 v152, v152, v153
  v_cvt_pk_bf16_f32 v153, v154, v155
  v_mfma_f32_32x32x16_bf16 v[240:255], a[196:199], a[228:231], v[240:255]
  ds_read_b128 a[248:251], v0 offset:2048
  ds_read_b128 a[252:255], v12 offset:2048
  buffer_load_dwordx4 v21, s[20:23], s63 offen offset:1024 lds
  v_mfma_f32_32x32x16_bf16 v[192:207], a[200:203], a[232:235], v[192:207]
  ds_read_b64_tr_b16 a[216:217], v6 offset:14336
  ds_read_b64_tr_b16 a[218:219], v6 offset:15360
  v_cvt_pk_bf16_f32 v154, v156, v157
  v_cvt_pk_bf16_f32 v155, v158, v159
  v_mfma_f32_32x32x16_bf16 v[208:223], a[200:203], a[236:239], v[208:223]
  buffer_load_dwordx4 v22, s[20:23], s63 offen offset:2048 lds
  s_add_u32 s58, s58, 0x1000
  s_and_b32 s58, s58, 0xffff
  v_mfma_f32_32x32x16_bf16 v[224:239], a[204:207], a[232:235], v[224:239]
  ds_read_b64_tr_b16 a[220:221], v7 offset:14336
  ds_read_b64_tr_b16 a[222:223], v7 offset:15360
  buffer_store_dwordx4 v[152:155], v27, s[40:43], s53 offen offset:1024 sc1
  v_mfma_f32_32x32x16_bf16 v[240:255], a[204:207], a[236:239], v[240:255]
  buffer_load_dwordx4 v23, s[20:23], s63 offen offset:3072 lds
  v_add_u32 v0, s58, v3
  v_xor_b32 v12, 0x400, v0
  s_waitcnt lgkmcnt(0)
  v_mfma_f32_32x32x16_bf16 v[192:207], a[208:211], a[240:243], v[192:207]
  s_waitcnt vmcnt(14)
  ds_read_b64_tr_b16 a[192:193], v6 offset:16384
  ds_read_b64_tr_b16 a[194:195], v6 offset:17408
  s_add_u32 m0, s47, 0x2000
  v_mfma_f32_32x32x16_bf16 v[208:223], a[208:211], a[244:247], v[208:223]
  ds_read_b128 a[224:227], v0
  ds_read_b128 a[228:231], v12
  buffer_load_dwordx4 v20, s[20:23], s48 offen lds
  v_mfma_f32_32x32x16_bf16 v[224:239], a[212:215], a[240:243], v[224:239]
  ds_read_b64_tr_b16 a[196:197], v7 offset:16384
  ds_read_b64_tr_b16 a[198:199], v7 offset:17408
  s_add_u32 s63, s48, 0x8000
  s_and_b32 s63, s63, 0x7ffff
  v_cvt_pk_bf16_f32 v160, v160, v161
  v_cvt_pk_bf16_f32 v161, v162, v163
  v_mfma_f32_32x32x16_bf16 v[240:255], a[212:215], a[244:247], v[240:255]
  ds_read_b128 a[232:235], v0 offset:2048
  ds_read_b128 a[236:239], v12 offset:2048
  buffer_load_dwordx4 v21, s[20:23], s48 offen offset:1024 lds
  v_mfma_f32_32x32x16_bf16 v[192:207], a[216:219], a[248:251], v[192:207]
  ds_read_b64_tr_b16 a[200:201], v6 offset:18432
  ds_read_b64_tr_b16 a[202:203], v6 offset:19456
  v_cvt_pk_bf16_f32 v162, v164, v165
  v_cvt_pk_bf16_f32 v163, v166, v167
  v_mfma_f32_32x32x16_bf16 v[208:223], a[216:219], a[252:255], v[208:223]
  buffer_load_dwordx4 v22, s[20:23], s48 offen offset:2048 lds
  s_add_u32 s58, s58, 0x1000
  s_and_b32 s58, s58, 0xffff
  s_add_u32 s53, s9, 0x20000
  v_mfma_f32_32x32x16_bf16 v[224:239], a[220:223], a[248:251], v[224:239]
  ds_read_b64_tr_b16 a[204:205], v7 offset:18432
  ds_read_b64_tr_b16 a[206:207], v7 offset:19456
  buffer_store_dwordx4 v[160:163], v27, s[40:43], s53 offen sc1
  v_mfma_f32_32x32x16_bf16 v[240:255], a[220:223], a[252:255], v[240:255]
  buffer_load_dwordx4 v23, s[20:23], s48 offen offset:3072 lds
  v_add_u32 v0, s58, v3
  v_xor_b32 v12, 0x400, v0
  s_waitcnt lgkmcnt(0)
  v_mfma_f32_32x32x16_bf16 v[192:207], a[192:195], a[224:227], v[192:207]
  s_waitcnt vmcnt(15)
  ds_read_b64_tr_b16 a[208:209], v6 offset:20480
  ds_read_b64_tr_b16 a[210:211], v6 offset:21504
  s_add_u32 m0, s47, 0x3000
  v_mfma_f32_32x32x16_bf16 v[208:223], a[192:195], a[228:231], v[208:223]
  ds_read_b128 a[240:243], v0
  ds_read_b128 a[244:247], v12
  buffer_load_dwordx4 v20, s[20:23], s63 offen lds
  v_mfma_f32_32x32x16_bf16 v[224:239], a[196:199], a[224:227], v[224:239]
  ds_read_b64_tr_b16 a[212:213], v7 offset:20480
  ds_read_b64_tr_b16 a[214:215], v7 offset:21504
  s_add_u32 s48, s63, 0x8000
  s_and_b32 s48, s48, 0x7ffff
  v_mfma_f32_32x32x16_bf16 v[240:255], a[196:199], a[228:231], v[240:255]
  ds_read_b128 a[248:251], v0 offset:2048
  ds_read_b128 a[252:255], v12 offset:2048
  buffer_load_dwordx4 v21, s[20:23], s63 offen offset:1024 lds
  v_mfma_f32_32x32x16_bf16 v[192:207], a[200:203], a[232:235], v[192:207]
  ds_read_b64_tr_b16 a[216:217], v6 offset:22528
  ds_read_b64_tr_b16 a[218:219], v6 offset:23552
  v_mfma_f32_32x32x16_bf16 v[208:223], a[200:203], a[236:239], v[208:223]
  buffer_load_dwordx4 v22, s[20:23], s63 offen offset:2048 lds
  s_add_u32 s58, s58, 0x1000
  s_and_b32 s58, s58, 0xffff
  v_mfma_f32_32x32x16_bf16 v[224:239], a[204:207], a[232:235], v[224:239]
  ds_read_b64_tr_b16 a[220:221], v7 offset:22528
  ds_read_b64_tr_b16 a[222:223], v7 offset:23552
  v_mfma_f32_32x32x16_bf16 v[240:255], a[204:207], a[236:239], v[240:255]
  buffer_load_dwordx4 v23, s[20:23], s63 offen offset:3072 lds
  v_add_u32 v0, s58, v3
  v_xor_b32 v12, 0x400, v0
  s_waitcnt lgkmcnt(0)
  v_mfma_f32_32x32x16_bf16 v[192:207], a[208:211], a[240:243], v[192:207]
  s_waitcnt vmcnt(14)
  ds_read_b64_tr_b16 a[192:193], v6
  ds_read_b64_tr_b16 a[194:195], v6 offset:1024
  s_add_u32 m0, s47, 0x4000
  v_mfma_f32_32x32x16_bf16 v[208:223], a[208:211], a[244:247], v[208:223]
  ds_read_b128 a[224:227], v0
  ds_read_b128 a[228:231], v12
  buffer_load_dwordx4 v20, s[20:23], s48 offen lds
  v_mfma_f32_32x32x16_bf16 v[224:239], a[212:215], a[240:243], v[224:239]
  ds_read_b64_tr_b16 a[196:197], v7
  ds_read_b64_tr_b16 a[198:199], v7 offset:1024
  s_add_u32 s63, s48, 0x8000
  s_and_b32 s63, s63, 0x7ffff
  v_cvt_pk_bf16_f32 v168, v168, v169
  v_cvt_pk_bf16_f32 v169, v170, v171
  v_mfma_f32_32x32x16_bf16 v[240:255], a[212:215], a[244:247], v[240:255]
  ds_read_b128 a[232:235], v0 offset:2048
  ds_read_b128 a[236:239], v12 offset:2048
  buffer_load_dwordx4 v21, s[20:23], s48 offen offset:1024 lds
  v_mfma_f32_32x32x16_bf16 v[192:207], a[216:219], a[248:251], v[192:207]
  ds_read_b64_tr_b16 a[200:201], v6 offset:2048
  ds_read_b64_tr_b16 a[202:203], v6 offset:3072
  v_cvt_pk_bf16_f32 v170, v172, v173
  v_cvt_pk_bf16_f32 v171, v174, v175
  v_mfma_f32_32x32x16_bf16 v[208:223], a[216:219], a[252:255], v[208:223]
  buffer_load_dwordx4 v22, s[20:23], s48 offen offset:2048 lds
  s_add_u32 s58, s58, 0x1000
  s_and_b32 s58, s58, 0xffff
  v_mfma_f32_32x32x16_bf16 v[224:239], a[220:223], a[248:251], v[224:239]
  ds_read_b64_tr_b16 a[204:205], v7 offset:2048
  ds_read_b64_tr_b16 a[206:207], v7 offset:3072
  buffer_store_dwordx4 v[168:171], v27, s[40:43], s53 offen offset:1024 sc1
  v_mfma_f32_32x32x16_bf16 v[240:255], a[220:223], a[252:255], v[240:255]
  buffer_load_dwordx4 v23, s[20:23], s48 offen offset:3072 lds
  v_add_u32 v0, s58, v3
  v_xor_b32 v12, 0x400, v0
  s_waitcnt lgkmcnt(0)
  v_mfma_f32_32x32x16_bf16 v[192:207], a[192:195], a[224:227], v[192:207]
  s_waitcnt vmcnt(14)
  ds_read_b64_tr_b16 a[208:209], v6 offset:4096
  ds_read_b64_tr_b16 a[210:211], v6 offset:5120
  s_add_u32 m0, s47, 0x5000
  v_mfma_f32_32x32x16_bf16 v[208:223], a[192:195], a[228:231], v[208:223]
  ds_read_b128 a[240:243], v0
  ds_read_b128 a[244:247], v12
  buffer_load_dwordx4 v20, s[20:23], s63 offen lds
  v_mfma_f32_32x32x16_bf16 v[224:239], a[196:199], a[224:227], v[224:239]
  ds_read_b64_tr_b16 a[212:213], v7 offset:4096
  ds_read_b64_tr_b16 a[214:215], v7 offset:5120
  s_add_u32 s48, s63, 0x8000
  s_and_b32 s48, s48, 0x7ffff
  v_cvt_pk_bf16_f32 v176, v176, v177
  v_cvt_pk_bf16_f32 v177, v178, v179
  v_mfma_f32_32x32x16_bf16 v[240:255], a[196:199], a[228:231], v[240:255]
  ds_read_b128 a[248:251], v0 offset:2048
  ds_read_b128 a[252:255], v12 offset:2048
  buffer_load_dwordx4 v21, s[20:23], s63 offen offset:1024 lds
  v_mfma_f32_32x32x16_bf16 v[192:207], a[200:203], a[232:235], v[192:207]
  ds_read_b64_tr_b16 a[216:217], v6 offset:6144
  ds_read_b64_tr_b16 a[218:219], v6 offset:7168
  v_cvt_pk_bf16_f32 v178, v180, v181
  v_cvt_pk_bf16_f32 v179, v182, v183
  v_mfma_f32_32x32x16_bf16 v[208:223], a[200:203], a[236:239], v[208:223]
  buffer_load_dwordx4 v22, s[20:23], s63 offen offset:2048 lds
  s_add_u32 s58, s58, 0x1000
  s_and_b32 s58, s58, 0xffff
  s_add_u32 s53, s9, 0x30000
  v_mfma_f32_32x32x16_bf16 v[224:239], a[204:207], a[232:235], v[224:239]
  ds_read_b64_tr_b16 a[220:221], v7 offset:6144
  ds_read_b64_tr_b16 a[222:223], v7 offset:7168
  buffer_store_dwordx4 v[176:179], v27, s[40:43], s53 offen sc1
  v_mfma_f32_32x32x16_bf16 v[240:255], a[204:207], a[236:239], v[240:255]
  buffer_load_dwordx4 v23, s[20:23], s63 offen offset:3072 lds
  v_add_u32 v0, s58, v3
  v_xor_b32 v12, 0x400, v0
  s_waitcnt lgkmcnt(0)
  v_mfma_f32_32x32x16_bf16 v[192:207], a[208:211], a[240:243], v[192:207]
  s_waitcnt vmcnt(14)
  ds_read_b64_tr_b16 a[192:193], v6 offset:8192
  ds_read_b64_tr_b16 a[194:195], v6 offset:9216
  s_add_u32 m0, s47, 0
  v_mfma_f32_32x32x16_bf16 v[208:223], a[208:211], a[244:247], v[208:223]
  ds_read_b128 a[224:227], v0
  ds_read_b128 a[228:231], v12
  buffer_load_dwordx4 v20, s[20:23], s48 offen lds
  v_mfma_f32_32x32x16_bf16 v[224:239], a[212:215], a[240:243], v[224:239]
  ds_read_b64_tr_b16 a[196:197], v7 offset:8192
  ds_read_b64_tr_b16 a[198:199], v7 offset:9216
  s_add_u32 s63, s48, 0x8000
  s_and_b32 s63, s63, 0x7ffff
  v_cvt_pk_bf16_f32 v184, v184, v185
  v_cvt_pk_bf16_f32 v185, v186, v187
  v_mfma_f32_32x32x16_bf16 v[240:255], a[212:215], a[244:247], v[240:255]
  ds_read_b128 a[232:235], v0 offset:2048
  ds_read_b128 a[236:239], v12 offset:2048
  buffer_load_dwordx4 v21, s[20:23], s48 offen offset:1024 lds
  v_mfma_f32_32x32x16_bf16 v[192:207], a[216:219], a[248:251], v[192:207]
  ds_read_b64_tr_b16 a[200:201], v6 offset:10240
  ds_read_b64_tr_b16 a[202:203], v6 offset:11264
  v_cvt_pk_bf16_f32 v186, v188, v189
  v_cvt_pk_bf16_f32 v187, v190, v191
  v_mfma_f32_32x32x16_bf16 v[208:223], a[216:219], a[252:255], v[208:223]
  buffer_load_dwordx4 v22, s[20:23], s48 offen offset:2048 lds
  s_add_u32 s58, s58, 0x1000
  s_and_b32 s58, s58, 0xffff
  v_mfma_f32_32x32x16_bf16 v[224:239], a[220:223], a[248:251], v[224:239]
  ds_read_b64_tr_b16 a[204:205], v7 offset:10240
  ds_read_b64_tr_b16 a[206:207], v7 offset:11264
  buffer_store_dwordx4 v[184:187], v27, s[40:43], s53 offen offset:1024 sc1
  v_mfma_f32_32x32x16_bf16 v[240:255], a[220:223], a[252:255], v[240:255]
  buffer_load_dwordx4 v23, s[20:23], s48 offen offset:3072 lds
  v_add_u32 v0, s58, v3
  v_xor_b32 v12, 0x400, v0
  s_waitcnt lgkmcnt(0)
  v_mfma_f32_32x32x16_bf16 v[192:207], a[192:195], a[224:227], v[192:207]
  s_waitcnt vmcnt(15)
  ds_read_b64_tr_b16 a[208:209], v6 offset:12288
  ds_read_b64_tr_b16 a[210:211], v6 offset:13312
  s_add_u32 m0, s47, 0x1000
  v_mfma_f32_32x32x16_bf16 v[208:223], a[192:195], a[228:231], v[208:223]
  ds_read_b128 a[240:243], v0
  ds_read_b128 a[244:247], v12
  buffer_load_dwordx4 v20, s[20:23], s63 offen lds
  v_mfma_f32_32x32x16_bf16 v[224:239], a[196:199], a[224:227], v[224:239]
  ds_read_b64_tr_b16 a[212:213], v7 offset:12288
  ds_read_b64_tr_b16 a[214:215], v7 offset:13312
  v_mfma_f32_32x32x16_bf16 v[240:255], a[196:199], a[228:231], v[240:255]
  ds_read_b128 a[248:251], v0 offset:2048
  ds_read_b128 a[252:255], v12 offset:2048
  buffer_load_dwordx4 v21, s[20:23], s63 offen offset:1024 lds
  v_mfma_f32_32x32x16_bf16 v[192:207], a[200:203], a[232:235], v[192:207]
  ds_read_b64_tr_b16 a[216:217], v6 offset:14336
  ds_read_b64_tr_b16 a[218:219], v6 offset:15360
  v_mfma_f32_32x32x16_bf16 v[208:223], a[200:203], a[236:239], v[208:223]
  buffer_load_dwordx4 v22, s[20:23], s63 offen offset:2048 lds
  s_add_u32 s58, s58, 0x1000
  s_and_b32 s58, s58, 0xffff
  v_mfma_f32_32x32x16_bf16 v[224:239], a[204:207], a[232:235], v[224:239]
  ds_read_b64_tr_b16 a[220:221], v7 offset:14336
  ds_read_b64_tr_b16 a[222:223], v7 offset:15360
  v_mfma_f32_32x32x16_bf16 v[240:255], a[204:207], a[236:239], v[240:255]
  buffer_load_dwordx4 v23, s[20:23], s63 offen offset:3072 lds
  v_add_u32 v0, s58, v3
  v_xor_b32 v12, 0x400, v0
  s_waitcnt lgkmcnt(0)
  v_mfma_f32_32x32x16_bf16 v[192:207], a[208:211], a[240:243], v[192:207]
  s_waitcnt vmcnt(14)
  ds_read_b64_tr_b16 a[192:193], v6 offset:16384
  ds_read_b64_tr_b16 a[194:195], v6 offset:17408
  v_mfma_f32_32x32x16_bf16 v[208:223], a[208:211], a[244:247], v[208:223]
  ds_read_b128 a[224:227], v0
  ds_read_b128 a[228:231], v12
  v_mfma_f32_32x32x16_bf16 v[224:239], a[212:215], a[240:243], v[224:239]
  ds_read_b64_tr_b16 a[196:197], v7 offset:16384
  ds_read_b64_tr_b16 a[198:199], v7 offset:17408
  v_mfma_f32_32x32x16_bf16 v[240:255], a[212:215], a[244:247], v[240:255]
  ds_read_b128 a[232:235], v0 offset:2048
  ds_read_b128 a[236:239], v12 offset:2048
  v_mfma_f32_32x32x16_bf16 v[192:207], a[216:219], a[248:251], v[192:207]
  ds_read_b64_tr_b16 a[200:201], v6 offset:18432
  ds_read_b64_tr_b16 a[202:203], v6 offset:19456
  v_mfma_f32_32x32x16_bf16 v[208:223], a[216:219], a[252:255], v[208:223]
  s_add_u32 s58, s58, 0x1000
  s_and_b32 s58, s58, 0xffff
  v_mfma_f32_32x32x16_bf16 v[224:239], a[220:223], a[248:251], v[224:239]
  ds_read_b64_tr_b16 a[204:205], v7 offset:18432
  ds_read_b64_tr_b16 a[206:207], v7 offset:19456
  v_mfma_f32_32x32x16_bf16 v[240:255], a[220:223], a[252:255], v[240:255]
  v_add_u32 v0, s58, v3
  v_xor_b32 v12, 0x400, v0
  s_waitcnt lgkmcnt(0)
  v_mfma_f32_32x32x16_bf16 v[192:207], a[192:195], a[224:227], v[192:207]
  s_waitcnt vmcnt(9)
  ds_read_b64_tr_b16 a[208:209], v6 offset:20480
  ds_read_b64_tr_b16 a[210:211], v6 offset:21504
  v_mfma_f32_32x32x16_bf16 v[208:223], a[192:195], a[228:231], v[208:223]
  ds_read_b128 a[240:243], v0
  ds_read_b128 a[244:247], v12
  v_mfma_f32_32x32x16_bf16 v[224:239], a[196:199], a[224:227], v[224:239]
  ds_read_b64_tr_b16 a[212:213], v7 offset:20480
  ds_read_b64_tr_b16 a[214:215], v7 offset:21504
  v_mfma_f32_32x32x16_bf16 v[240:255], a[196:199], a[228:231], v[240:255]
  ds_read_b128 a[248:251], v0 offset:2048
  ds_read_b128 a[252:255], v12 offset:2048
  v_mfma_f32_32x32x16_bf16 v[192:207], a[200:203], a[232:235], v[192:207]
  ds_read_b64_tr_b16 a[216:217], v6 offset:22528
  ds_read_b64_tr_b16 a[218:219], v6 offset:23552
  v_mfma_f32_32x32x16_bf16 v[208:223], a[200:203], a[236:239], v[208:223]
  s_add_u32 s58, s58, 0x1000
  s_and_b32 s58, s58, 0xffff
  v_mfma_f32_32x32x16_bf16 v[224:239], a[204:207], a[232:235], v[224:239]
  ds_read_b64_tr_b16 a[220:221], v7 offset:22528
  ds_read_b64_tr_b16 a[222:223], v7 offset:23552
  v_mfma_f32_32x32x16_bf16 v[240:255], a[204:207], a[236:239], v[240:255]
  v_add_u32 v0, s58, v3
  v_xor_b32 v12, 0x400, v0
  s_waitcnt lgkmcnt(0)
  v_mfma_f32_32x32x16_bf16 v[192:207], a[208:211], a[240:243], v[192:207]
  s_waitcnt vmcnt(4)
  ds_read_b64_tr_b16 a[192:193], v6
  ds_read_b64_tr_b16 a[194:195], v6 offset:1024
  s_barrier
  v_mfma_f32_32x32x16_bf16 v[208:223], a[208:211], a[244:247], v[208:223]
  ds_read_b128 a[224:227], v0
  ds_read_b128 a[228:231], v12
  v_mfma_f32_32x32x16_bf16 v[224:239], a[212:215], a[240:243], v[224:239]
  ds_read_b64_tr_b16 a[196:197], v7
  ds_read_b64_tr_b16 a[198:199], v7 offset:1024
  v_mfma_f32_32x32x16_bf16 v[240:255], a[212:215], a[244:247], v[240:255]
  ds_read_b128 a[232:235], v0 offset:2048
  ds_read_b128 a[236:239], v12 offset:2048
  v_mfma_f32_32x32x16_bf16 v[192:207], a[216:219], a[248:251], v[192:207]
  ds_read_b64_tr_b16 a[200:201], v6 offset:2048
  ds_read_b64_tr_b16 a[202:203], v6 offset:3072
  v_mfma_f32_32x32x16_bf16 v[208:223], a[216:219], a[252:255], v[208:223]
  s_add_u32 s58, s58, 0x1000
  s_and_b32 s58, s58, 0xffff
  v_mfma_f32_32x32x16_bf16 v[224:239], a[220:223], a[248:251], v[224:239]
  ds_read_b64_tr_b16 a[204:205], v7 offset:2048
  ds_read_b64_tr_b16 a[206:207], v7 offset:3072
  v_mfma_f32_32x32x16_bf16 v[240:255], a[220:223], a[252:255], v[240:255]
  v_add_u32 v0, s58, v3
  v_xor_b32 v12, 0x400, v0
  s_waitcnt lgkmcnt(0)
  v_mfma_f32_32x32x16_bf16 v[192:207], a[192:195], a[224:227], v[192:207]
  s_waitcnt vmcnt(0)
  ds_read_b64_tr_b16 a[208:209], v6 offset:4096
  ds_read_b64_tr_b16 a[210:211], v6 offset:5120
  v_mfma_f32_32x32x16_bf16 v[208:223], a[192:195], a[228:231], v[208:223]
  ds_read_b128 a[240:243], v0
  ds_read_b128 a[244:247], v12
  s_cmp_eq_u32 s46, 1
  s_cbranch_scc0 L_noflag_1
  s_lshl_b32 s49, s44, 2
  s_add_u32 s49, s49, 128
  v_mov_b32 v62, s49
  v_mov_b32 v60, s76
  buffer_store_dword v60, v62, s[72:75], 0 offen sc1
L_noflag_1:
  s_nop 1
  v_mfma_f32_32x32x16_bf16 v[224:239], a[196:199], a[224:227], v[224:239]
  ds_read_b64_tr_b16 a[212:213], v7 offset:4096
  ds_read_b64_tr_b16 a[214:215], v7 offset:5120
  v_mfma_f32_32x32x16_bf16 v[240:255], a[196:199], a[228:231], v[240:255]
  ds_read_b128 a[248:251], v0 offset:2048
  ds_read_b128 a[252:255], v12 offset:2048
  v_mfma_f32_32x32x16_bf16 v[192:207], a[200:203], a[232:235], v[192:207]
  ds_read_b64_tr_b16 a[216:217], v6 offset:6144
  ds_read_b64_tr_b16 a[218:219], v6 offset:7168
  v_mfma_f32_32x32x16_bf16 v[208:223], a[200:203], a[236:239], v[208:223]
  v_mfma_f32_32x32x16_bf16 v[224:239], a[204:207], a[232:235], v[224:239]
  ds_read_b64_tr_b16 a[220:221], v7 offset:6144
  ds_read_b64_tr_b16 a[222:223], v7 offset:7168
  v_mfma_f32_32x32x16_bf16 v[240:255], a[204:207], a[236:239], v[240:255]
  s_waitcnt lgkmcnt(0)
  v_mfma_f32_32x32x16_bf16 v[192:207], a[208:211], a[240:243], v[192:207]
  v_mfma_f32_32x32x16_bf16 v[208:223], a[208:211], a[244:247], v[208:223]
  v_mfma_f32_32x32x16_bf16 v[224:239], a[212:215], a[240:243], v[224:239]
  v_mfma_f32_32x32x16_bf16 v[240:255], a[212:215], a[244:247], v[240:255]
  v_mfma_f32_32x32x16_bf16 v[192:207], a[216:219], a[248:251], v[192:207]
  v_mfma_f32_32x32x16_bf16 v[208:223], a[216:219], a[252:255], v[208:223]
  v_mfma_f32_32x32x16_bf16 v[224:239], a[220:223], a[248:251], v[224:239]
  v_mfma_f32_32x32x16_bf16 v[240:255], a[220:223], a[252:255], v[240:255]
  s_lshr_b32 s49, s11, 9
  s_and_b32 s49, s49, 16
  v_and_b32 v58, 3, v1
  v_lshlrev_b32 v58, 2, v58
  v_add_u32 v58, s49, v58
  buffer_load_dword v60, v58, s[72:75], 0 offen offset:128 sc1
  s_and_b32 s51, s44, 3
  s_xor_b32 s49, s51, 1
  s_lshl_b32 s49, s49, 16
  s_add_u32 s53, s10, s49
  v_cvt_pk_bf16_f32 v208, v208, v209
  v_cvt_pk_bf16_f32 v209, v210, v211
  v_cvt_pk_bf16_f32 v210, v212, v213
  v_cvt_pk_bf16_f32 v211, v214, v215
  buffer_store_dwordx4 v[208:211], v27, s[40:43], s53 offen sc1
  v_cvt_pk_bf16_f32 v216, v216, v217
  v_cvt_pk_bf16_f32 v217, v218, v219
  v_cvt_pk_bf16_f32 v218, v220, v221
  v_cvt_pk_bf16_f32 v219, v222, v223
  buffer_store_dwordx4 v[216:219], v27, s[40:43], s53 offen offset:1024 sc1
  s_xor_b32 s49, s51, 2
  s_lshl_b32 s49, s49, 16
  s_add_u32 s53, s10, s49
  v_cvt_pk_bf16_f32 v224, v224, v225
  v_cvt_pk_bf16_f32 v225, v226, v227
  v_cvt_pk_bf16_f32 v226, v228, v229
  v_cvt_pk_bf16_f32 v227, v230, v231
  buffer_store_dwordx4 v[224:227], v27, s[40:43], s53 offen sc1
  v_cvt_pk_bf16_f32 v232, v232, v233
  v_cvt_pk_bf16_f32 v233, v234, v235
  v_cvt_pk_bf16_f32 v234, v236, v237
  v_cvt_pk_bf16_f32 v235, v238, v239
  buffer_store_dwordx4 v[232:235], v27, s[40:43], s53 offen offset:1024 sc1
  s_xor_b32 s49, s51, 3
  s_lshl_b32 s49, s49, 16
  s_add_u32 s53, s10, s49
  v_cvt_pk_bf16_f32 v240, v240, v241
  v_cvt_pk_bf16_f32 v241, v242, v243
  v_cvt_pk_bf16_f32 v242, v244, v245
  v_cvt_pk_bf16_f32 v243, v246, v247
  buffer_store_dwordx4 v[240:243], v27, s[40:43], s53 offen sc1
  v_cvt_pk_bf16_f32 v248, v248, v249
  v_cvt_pk_bf16_f32 v249, v250, v251
  v_cvt_pk_bf16_f32 v250, v252, v253
  v_cvt_pk_bf16_f32 v251, v254, v255
  buffer_store_dwordx4 v[248:251], v27, s[40:43], s53 offen offset:1024 sc1
  s_waitcnt vmcnt(6)
  v_cmp_ne_u32 vcc, s76, v60
  s_nop 1
  s_cbranch_vccz L_flag_ok_1
  s_call_b64 s[60:61], L_spin_flag_1
L_flag_ok_1:
  s_add_u32 s53, s11, 0
  buffer_load_dwordx4 v[64:67], v59, s[40:43], s53 offen sc1
  buffer_load_dwordx4 v[68:71], v59, s[40:43], s53 offen offset:1024 sc1
  buffer_load_dwordx4 v[72:75], v59, s[40:43], s53 offen offset:2048 sc1
  buffer_load_dwordx4 v[76:79], v59, s[40:43], s53 offen offset:3072 sc1
  s_add_u32 s53, s11, 0x1000
  buffer_load_dwordx4 v[80:83], v59, s[40:43], s53 offen sc1
  buffer_load_dwordx4 v[84:87], v59, s[40:43], s53 offen offset:1024 sc1
  buffer_load_dwordx4 v[88:91], v59, s[40:43], s53 offen offset:2048 sc1
  buffer_load_dwordx4 v[92:95], v59, s[40:43], s53 offen offset:3072 sc1
  v_accvgpr_read_b32 v50, a168
  v_accvgpr_read_b32 v51, a169
  v_accvgpr_read_b32 v52, a170
  v_accvgpr_read_b32 v53, a171
  v_dot2_f32_bf16 v28, v50, s15, v28
  v_dot2_f32_bf16 v29, v50, s3, v29
  v_dot2_f32_bf16 v30, v51, s15, v30
  v_dot2_f32_bf16 v31, v51, s3, v31
  v_dot2_f32_bf16 v32, v52, s15, v32
  v_dot2_f32_bf16 v33, v52, s3, v33
  v_dot2_f32_bf16 v34, v53, s15, v34
  v_dot2_f32_bf16 v35, v53, s3, v35
  v_accvgpr_read_b32 v54, a172
  v_accvgpr_read_b32 v55, a173
  v_accvgpr_read_b32 v56, a174
  v_accvgpr_read_b32 v57, a175
  v_dot2_f32_bf16 v36, v54, s15, v36
  v_dot2_f32_bf16 v37, v54, s3, v37
  v_dot2_f32_bf16 v38, v55, s15, v38
  v_dot2_f32_bf16 v39, v55, s3, v39
  v_dot2_f32_bf16 v40, v56, s15, v40
  v_dot2_f32_bf16 v41, v56, s3, v41
  v_dot2_f32_bf16 v42, v57, s15, v42
  v_dot2_f32_bf16 v43, v57, s3, v43
  v_accvgpr_read_b32 v50, a176
  v_accvgpr_read_b32 v51, a177
  v_accvgpr_read_b32 v52, a178
  v_accvgpr_read_b32 v53, a179
  v_dot2_f32_bf16 v28, v50, s15, v28
  v_dot2_f32_bf16 v29, v50, s3, v29
  v_dot2_f32_bf16 v30, v51, s15, v30
  v_dot2_f32_bf16 v31, v51, s3, v31
  v_dot2_f32_bf16 v32, v52, s15, v32
  v_dot2_f32_bf16 v33, v52, s3, v33
  v_dot2_f32_bf16 v34, v53, s15, v34
  v_dot2_f32_bf16 v35, v53, s3, v35
  v_accvgpr_read_b32 v54, a180
  v_accvgpr_read_b32 v55, a181
  v_accvgpr_read_b32 v56, a182
  v_accvgpr_read_b32 v57, a183
  v_dot2_f32_bf16 v36, v54, s15, v36
  v_dot2_f32_bf16 v37, v54, s3, v37
  v_dot2_f32_bf16 v38, v55, s15, v38
  v_dot2_f32_bf16 v39, v55, s3, v39
  v_dot2_f32_bf16 v40, v56, s15, v40
  v_dot2_f32_bf16 v41, v56, s3, v41
  v_dot2_f32_bf16 v42, v57, s15, v42
  v_dot2_f32_bf16 v43, v57, s3, v43
  v_accvgpr_read_b32 v50, a184
  v_accvgpr_read_b32 v51, a185
  v_accvgpr_read_b32 v52, a186
  v_accvgpr_read_b32 v53, a187
  v_dot2_f32_bf16 v28, v50, s15, v28
  v_dot2_f32_bf16 v29, v50, s3, v29
  v_dot2_f32_bf16 v30, v51, s15, v30
  v_dot2_f32_bf16 v31, v51, s3, v31
  v_dot2_f32_bf16 v32, v52, s15, v32
  v_dot2_f32_bf16 v33, v52, s3, v33
  v_dot2_f32_bf16 v34, v53, s15, v34
  v_dot2_f32_bf16 v35, v53, s3, v35
  v_accvgpr_read_b32 v54, a188
  v_accvgpr_read_b32 v55, a189
  v_accvgpr_read_b32 v56, a190
  v_accvgpr_read_b32 v57, a191
  v_dot2_f32_bf16 v36, v54, s15, v36
  v_dot2_f32_bf16 v37, v54, s3, v37
  v_dot2_f32_bf16 v38, v55, s15, v38
  v_dot2_f32_bf16 v39, v55, s3, v39
  v_dot2_f32_bf16 v40, v56, s15, v40
  v_dot2_f32_bf16 v41, v56, s3, v41
  v_dot2_f32_bf16 v42, v57, s15, v42
  v_dot2_f32_bf16 v43, v57, s3, v43
  s_nop 2
  s_lshr_b32 s49, s12, 9
  s_and_b32 s49, s49, 16
  v_and_b32 v58, 3, v1
  v_max_u32 v58, 1, v58
  v_add_u32 v58, s44, v58
  v_and_b32 v58, 3, v58
  v_lshlrev_b32 v58, 2, v58
  v_add_u32 v58, s49, v58
  s_waitcnt vmcnt(8)
  s_barrier
  s_cmp_eq_u32 s46, 1
  s_cbranch_scc0 L_noflag_2
  s_lshl_b32 s49, s44, 2
  s_add_u32 s49, s49, 256
  v_mov_b32 v62, s49
  v_mov_b32 v60, s76
  buffer_store_dword v60, v62, s[72:75], 0 offen sc1
L_noflag_2:
  s_nop 1
  s_cmp_eq_u32 s46, 0
  s_cbranch_scc0 L_s_nopoll
  buffer_load_dword v60, v58, s[72:75], 0 offen offset:256 sc1
L_s_nopoll:
  v_mul_f32 v46, s52, v28
  v_mul_f32 v47, s52, v29
  v_mul_f32 v48, s52, v30
  v_mul_f32 v49, s52, v31
  v_exp_f32 v46, v46
  v_exp_f32 v47, v47
  v_exp_f32 v48, v48
  v_exp_f32 v49, v49
  v_add_f32 v46, 1.0, v46
  v_add_f32 v47, 1.0, v47
  v_add_f32 v48, 1.0, v48
  v_add_f32 v49, 1.0, v49
  v_rcp_f32 v46, v46
  v_rcp_f32 v47, v47
  v_rcp_f32 v48, v48
  v_rcp_f32 v49, v49
  v_mul_f32 v28, s14, v28
  v_mul_f32 v29, s14, v29
  v_mul_f32 v30, s14, v30
  v_mul_f32 v31, s14, v31
  v_mul_f32 v28, v28, v46
  v_mul_f32 v29, v29, v47
  v_mul_f32 v30, v30, v48
  v_mul_f32 v31, v31, v49
  v_mul_f32 v46, s52, v32
  v_mul_f32 v47, s52, v33
  v_mul_f32 v48, s52, v34
  v_mul_f32 v49, s52, v35
  v_exp_f32 v46, v46
  v_exp_f32 v47, v47
  v_exp_f32 v48, v48
  v_exp_f32 v49, v49
  v_add_f32 v46, 1.0, v46
  v_add_f32 v47, 1.0, v47
  v_add_f32 v48, 1.0, v48
  v_add_f32 v49, 1.0, v49
  v_rcp_f32 v46, v46
  v_rcp_f32 v47, v47
  v_rcp_f32 v48, v48
  v_rcp_f32 v49, v49
  v_mul_f32 v32, s14, v32
  v_mul_f32 v33, s14, v33
  v_mul_f32 v34, s14, v34
  v_mul_f32 v35, s14, v35
  v_mul_f32 v32, v32, v46
  v_mul_f32 v33, v33, v47
  v_mul_f32 v34, v34, v48
  v_mul_f32 v35, v35, v49
  v_mul_f32 v46, s52, v36
  v_mul_f32 v47, s52, v37
  v_mul_f32 v48, s52, v38
  v_mul_f32 v49, s52, v39
  v_exp_f32 v46, v46
  v_exp_f32 v47, v47
  v_exp_f32 v48, v48
  v_exp_f32 v49, v49
  v_add_f32 v46, 1.0, v46
  v_add_f32 v47, 1.0, v47
  v_add_f32 v48, 1.0, v48
  v_add_f32 v49, 1.0, v49
  v_rcp_f32 v46, v46
  v_rcp_f32 v47, v47
  v_rcp_f32 v48, v48
  v_rcp_f32 v49, v49
  v_mul_f32 v36, s14, v36
  v_mul_f32 v37, s14, v37
  v_mul_f32 v38, s14, v38
  v_mul_f32 v39, s14, v39
  v_mul_f32 v36, v36, v46
  v_mul_f32 v37, v37, v47
  v_mul_f32 v38, v38, v48
  v_mul_f32 v39, v39, v49
  v_mul_f32 v46, s52, v40
  v_mul_f32 v47, s52, v41
  v_mul_f32 v48, s52, v42
  v_mul_f32 v49, s52, v43
  v_exp_f32 v46, v46
  v_exp_f32 v47, v47
  v_exp_f32 v48, v48
  v_exp_f32 v49, v49
  v_add_f32 v46, 1.0, v46
  v_add_f32 v47, 1.0, v47
  v_add_f32 v48, 1.0, v48
  v_add_f32 v49, 1.0, v49
  v_rcp_f32 v46, v46
  v_rcp_f32 v47, v47
  v_rcp_f32 v48, v48
  v_rcp_f32 v49, v49
  v_mul_f32 v40, s14, v40
  v_mul_f32 v41, s14, v41
  v_mul_f32 v42, s14, v42
  v_mul_f32 v43, s14, v43
  v_mul_f32 v40, v40, v46
  v_mul_f32 v41, v41, v47
  v_mul_f32 v42, v42, v48
  v_mul_f32 v43, v43, v49
  s_waitcnt vmcnt(7)
  v_dot2_f32_bf16 v192, v64, s15, v192
  v_dot2_f32_bf16 v193, v64, s3, v193
  v_dot2_f32_bf16 v194, v65, s15, v194
  v_dot2_f32_bf16 v195, v65, s3, v195
  v_dot2_f32_bf16 v196, v66, s15, v196
  v_dot2_f32_bf16 v197, v66, s3, v197
  v_dot2_f32_bf16 v198, v67, s15, v198
  v_dot2_f32_bf16 v199, v67, s3, v199
  s_waitcnt vmcnt(6)
  v_dot2_f32_bf16 v200, v68, s15, v200
  v_dot2_f32_bf16 v201, v68, s3, v201
  v_dot2_f32_bf16 v202, v69, s15, v202
  v_dot2_f32_bf16 v203, v69, s3, v203
  v_dot2_f32_bf16 v204, v70, s15, v204
  v_dot2_f32_bf16 v205, v70, s3, v205
  v_dot2_f32_bf16 v206, v71, s15, v206
  v_dot2_f32_bf16 v207, v71, s3, v207
  s_waitcnt vmcnt(5)
  v_dot2_f32_bf16 v192, v72, s15, v192
  v_dot2_f32_bf16 v193, v72, s3, v193
  v_dot2_f32_bf16 v194, v73, s15, v194
  v_dot2_f32_bf16 v195, v73, s3, v195
  v_dot2_f32_bf16 v196, v74, s15, v196
  v_dot2_f32_bf16 v197, v74, s3, v197
  v_dot2_f32_bf16 v198, v75, s15, v198
  v_dot2_f32_bf16 v199, v75, s3, v199
  s_waitcnt vmcnt(4)
  v_dot2_f32_bf16 v200, v76, s15, v200
  v_dot2_f32_bf16 v201, v76, s3, v201
  v_dot2_f32_bf16 v202, v77, s15, v202
  v_dot2_f32_bf16 v203, v77, s3, v203
  v_dot2_f32_bf16 v204, v78, s15, v204
  v_dot2_f32_bf16 v205, v78, s3, v205
  v_dot2_f32_bf16 v206, v79, s15, v206
  v_dot2_f32_bf16 v207, v79, s3, v207
  s_waitcnt vmcnt(3)
  v_dot2_f32_bf16 v192, v80, s15, v192
  v_dot2_f32_bf16 v193, v80, s3, v193
  v_dot2_f32_bf16 v194, v81, s15, v194
  v_dot2_f32_bf16 v195, v81, s3, v195
  v_dot2_f32_bf16 v196, v82, s15, v196
  v_dot2_f32_bf16 v197, v82, s3, v197
  v_dot2_f32_bf16 v198, v83, s15, v198
  v_dot2_f32_bf16 v199, v83, s3, v199
  s_waitcnt vmcnt(2)
  v_dot2_f32_bf16 v200, v84, s15, v200
  v_dot2_f32_bf16 v201, v84, s3, v201
  v_dot2_f32_bf16 v202, v85, s15, v202
  v_dot2_f32_bf16 v203, v85, s3, v203
  v_dot2_f32_bf16 v204, v86, s15, v204
  v_dot2_f32_bf16 v205, v86, s3, v205
  v_dot2_f32_bf16 v206, v87, s15, v206
  v_dot2_f32_bf16 v207, v87, s3, v207
  s_waitcnt vmcnt(1)
  v_dot2_f32_bf16 v192, v88, s15, v192
  v_dot2_f32_bf16 v193, v88, s3, v193
  v_dot2_f32_bf16 v194, v89, s15, v194
  v_dot2_f32_bf16 v195, v89, s3, v195
  v_dot2_f32_bf16 v196, v90, s15, v196
  v_dot2_f32_bf16 v197, v90, s3, v197
  v_dot2_f32_bf16 v198, v91, s15, v198
  v_dot2_f32_bf16 v199, v91, s3, v199
  s_waitcnt vmcnt(0)
  v_dot2_f32_bf16 v200, v92, s15, v200
  v_dot2_f32_bf16 v201, v92, s3, v201
  v_dot2_f32_bf16 v202, v93, s15, v202
  v_dot2_f32_bf16 v203, v93, s3, v203
  v_dot2_f32_bf16 v204, v94, s15, v204
  v_dot2_f32_bf16 v205, v94, s3, v205
  v_dot2_f32_bf16 v206, v95, s15, v206
  v_dot2_f32_bf16 v207, v95, s3, v207
  s_nop 2
  s_cmp_eq_u32 s46, 0
  s_cbranch_scc0 L_s_polled
  s_waitcnt vmcnt(0)
  v_cmp_ne_u32 vcc, s76, v60
  s_nop 2
  s_cbranch_vccz L_s_polled
  s_call_b64 s[60:61], L_spin_flag_2
L_s_polled:
  s_barrier
  s_add_u32 s49, s44, 1
  s_and_b32 s49, s49, 3
  s_lshl_b32 s49, s49, 11
  s_add_u32 s53, s12, s49
  buffer_load_dwordx4 v[96:99], v59, s[40:43], s53 offen sc1
  buffer_load_dwordx4 v[100:103], v59, s[40:43], s53 offen offset:1024 sc1
  s_add_u32 s49, s44, 2
  s_and_b32 s49, s49, 3
  s_lshl_b32 s49, s49, 11
  s_add_u32 s53, s12, s49
  buffer_load_dwordx4 v[104:107], v59, s[40:43], s53 offen sc1
  buffer_load_dwordx4 v[108:111], v59, s[40:43], s53 offen offset:1024 sc1
  s_add_u32 s49, s44, 3
  s_and_b32 s49, s49, 3
  s_lshl_b32 s49, s49, 11
  s_add_u32 s53, s12, s49
  buffer_load_dwordx4 v[112:115], v59, s[40:43], s53 offen sc1
  buffer_load_dwordx4 v[116:119], v59, s[40:43], s53 offen offset:1024 sc1
  s_waitcnt vmcnt(5)
  v_dot2_f32_bf16 v192, v96, s15, v192
  v_dot2_f32_bf16 v193, v96, s3, v193
  v_dot2_f32_bf16 v194, v97, s15, v194
  v_dot2_f32_bf16 v195, v97, s3, v195
  v_dot2_f32_bf16 v196, v98, s15, v196
  v_dot2_f32_bf16 v197, v98, s3, v197
  v_dot2_f32_bf16 v198, v99, s15, v198
  v_dot2_f32_bf16 v199, v99, s3, v199
  s_waitcnt vmcnt(4)
  v_dot2_f32_bf16 v200, v100, s15, v200
  v_dot2_f32_bf16 v201, v100, s3, v201
  v_dot2_f32_bf16 v202, v101, s15, v202
  v_dot2_f32_bf16 v203, v101, s3, v203
  v_dot2_f32_bf16 v204, v102, s15, v204
  v_dot2_f32_bf16 v205, v102, s3, v205
  v_dot2_f32_bf16 v206, v103, s15, v206
  v_dot2_f32_bf16 v207, v103, s3, v207
  s_waitcnt vmcnt(3)
  v_dot2_f32_bf16 v192, v104, s15, v192
  v_dot2_f32_bf16 v193, v104, s3, v193
  v_dot2_f32_bf16 v194, v105, s15, v194
  v_dot2_f32_bf16 v195, v105, s3, v195
  v_dot2_f32_bf16 v196, v106, s15, v196
  v_dot2_f32_bf16 v197, v106, s3, v197
  v_dot2_f32_bf16 v198, v107, s15, v198
  v_dot2_f32_bf16 v199, v107, s3, v199
  s_waitcnt vmcnt(2)
  v_dot2_f32_bf16 v200, v108, s15, v200
  v_dot2_f32_bf16 v201, v108, s3, v201
  v_dot2_f32_bf16 v202, v109, s15, v202
  v_dot2_f32_bf16 v203, v109, s3, v203
  v_dot2_f32_bf16 v204, v110, s15, v204
  v_dot2_f32_bf16 v205, v110, s3, v205
  v_dot2_f32_bf16 v206, v111, s15, v206
  v_dot2_f32_bf16 v207, v111, s3, v207
  s_waitcnt vmcnt(1)
  v_dot2_f32_bf16 v192, v112, s15, v192
  v_dot2_f32_bf16 v193, v112, s3, v193
  v_dot2_f32_bf16 v194, v113, s15, v194
  v_dot2_f32_bf16 v195, v113, s3, v195
  v_dot2_f32_bf16 v196, v114, s15, v196
  v_dot2_f32_bf16 v197, v114, s3, v197
  v_dot2_f32_bf16 v198, v115, s15, v198
  v_dot2_f32_bf16 v199, v115, s3, v199
  s_waitcnt vmcnt(0)
  v_dot2_f32_bf16 v200, v116, s15, v200
  v_dot2_f32_bf16 v201, v116, s3, v201
  v_dot2_f32_bf16 v202, v117, s15, v202
  v_dot2_f32_bf16 v203, v117, s3, v203
  v_dot2_f32_bf16 v204, v118, s15, v204
  v_dot2_f32_bf16 v205, v118, s3, v205
  v_dot2_f32_bf16 v206, v119, s15, v206
  v_dot2_f32_bf16 v207, v119, s3, v207
  s_nop 2
  v_mul_f32 v192, v192, v28
  v_mul_f32 v193, v193, v29
  v_mul_f32 v194, v194, v30
  v_mul_f32 v195, v195, v31
  v_mul_f32 v196, v196, v32
  v_mul_f32 v197, v197, v33
  v_mul_f32 v198, v198, v34
  v_mul_f32 v199, v199, v35
  v_mul_f32 v200, v200, v36
  v_mul_f32 v201, v201, v37
  v_mul_f32 v202, v202, v38
  v_mul_f32 v203, v203, v39
  v_mul_f32 v204, v204, v40
  v_mul_f32 v205, v205, v41
  v_mul_f32 v206, v206, v42
  v_mul_f32 v207, v207, v43
  v_permlane32_swap_b32 v192, v196
  v_permlane32_swap_b32 v193, v197
  v_permlane32_swap_b32 v194, v198
  v_permlane32_swap_b32 v195, v199
  v_lshlrev_b32 v46, 16, v8
  v_and_b32 v47, 0xffff0000, v8
  v_add_f32 v46, v46, v192
  v_add_f32 v47, v47, v193
  v_cvt_pk_bf16_f32 v148, v46, v47
  v_lshlrev_b32 v48, 16, v9
  v_and_b32 v49, 0xffff0000, v9
  v_add_f32 v48, v48, v194
  v_add_f32 v49, v49, v195
  v_cvt_pk_bf16_f32 v149, v48, v49
  v_lshlrev_b32 v46, 16, v10
  v_and_b32 v47, 0xffff0000, v10
  v_add_f32 v46, v46, v196
  v_add_f32 v47, v47, v197
  v_cvt_pk_bf16_f32 v150, v46, v47
  v_lshlrev_b32 v48, 16, v11
  v_and_b32 v49, 0xffff0000, v11
  v_add_f32 v48, v48, v198
  v_add_f32 v49, v49, v199
  v_cvt_pk_bf16_f32 v151, v48, v49
  buffer_store_dwordx4 v[148:151], v13, s[64:67], 0 offen
  v_permlane32_swap_b32 v200, v204
  v_permlane32_swap_b32 v201, v205
  v_permlane32_swap_b32 v202, v206
  v_permlane32_swap_b32 v203, v207
  v_lshlrev_b32 v46, 16, v14
  v_and_b32 v47, 0xffff0000, v14
  v_add_f32 v46, v46, v200
  v_add_f32 v47, v47, v201
  v_cvt_pk_bf16_f32 v152, v46, v47
  v_lshlrev_b32 v48, 16, v15
  v_and_b32 v49, 0xffff0000, v15
  v_add_f32 v48, v48, v202
  v_add_f32 v49, v49, v203
  v_cvt_pk_bf16_f32 v153, v48, v49
  v_lshlrev_b32 v46, 16, v16
  v_and_b32 v47, 0xffff0000, v16
  v_add_f32 v46, v46, v204
  v_add_f32 v47, v47, v205
  v_cvt_pk_bf16_f32 v154, v46, v47
  v_lshlrev_b32 v48, 16, v17
  v_and_b32 v49, 0xffff0000, v17
  v_add_f32 v48, v48, v206
  v_add_f32 v49, v49, v207
  v_cvt_pk_bf16_f32 v155, v48, v49
  buffer_store_dwordx4 v[152:155], v13, s[64:67], 0 offen offset:32
  s_waitcnt vmcnt(0) lgkmcnt(0)
L_end:
  s_endpgm
L_slow_0:
  s_waitcnt lgkmcnt(0)
  s_nop 15
  s_nop 7
  v_max3_f32 v32, v128, v129, v130
  v_max3_f32 v32, v32, v131, v132
  v_max3_f32 v32, v32, v133, v134
  v_max3_f32 v32, v32, v135, v136
  v_max3_f32 v32, v32, v137, v138
  v_max3_f32 v32, v32, v139, v140
  v_max3_f32 v32, v32, v141, v142
  v_max_f32 v32, v32, v143
  v_max3_f32 v33, v144, v145, v146
  v_max3_f32 v33, v33, v147, v148
  v_max3_f32 v33, v33, v149, v150
  v_max3_f32 v33, v33, v151, v152
  v_max3_f32 v33, v33, v153, v154
  v_max3_f32 v33, v33, v155, v156
  v_max3_f32 v33, v33, v157, v158
  v_max_f32 v33, v33, v159
  s_nop 1
  v_permlane32_swap_b32 v32, v33
  v_max_f32 v32, v32, v33
  v_mov_b32 v33, v32
  s_nop 1
  v_permlane32_swap_b32 v32, v33
  v_max_f32 v32, 0, v32
  v_exp_f32 v34, -v32
  v_sub_f32 v192, v192, v32
  v_sub_f32 v128, v128, v32
  v_sub_f32 v160, v160, v32
  v_sub_f32 v193, v193, v32
  v_sub_f32 v129, v129, v32
  v_sub_f32 v161, v161, v32
  v_sub_f32 v194, v194, v32
  v_sub_f32 v130, v130, v32
  v_sub_f32 v162, v162, v32
  v_sub_f32 v195, v195, v32
  v_sub_f32 v131, v131, v32
  v_sub_f32 v163, v163, v32
  v_sub_f32 v196, v196, v32
  v_sub_f32 v132, v132, v32
  v_sub_f32 v164, v164, v32
  v_sub_f32 v197, v197, v32
  v_sub_f32 v133, v133, v32
  v_sub_f32 v165, v165, v32
  v_sub_f32 v198, v198, v32
  v_sub_f32 v134, v134, v32
  v_sub_f32 v166, v166, v32
  v_sub_f32 v199, v199, v32
  v_sub_f32 v135, v135, v32
  v_sub_f32 v167, v167, v32
  v_sub_f32 v200, v200, v32
  v_sub_f32 v136, v136, v32
  v_sub_f32 v168, v168, v32
  v_sub_f32 v201, v201, v32
  v_sub_f32 v137, v137, v32
  v_sub_f32 v169, v169, v32
  v_sub_f32 v202, v202, v32
  v_sub_f32 v138, v138, v32
  v_sub_f32 v170, v170, v32
  v_sub_f32 v203, v203, v32
  v_sub_f32 v139, v139, v32
  v_sub_f32 v171, v171, v32
  v_sub_f32 v204, v204, v32
  v_sub_f32 v140, v140, v32
  v_sub_f32 v172, v172, v32
  v_sub_f32 v205, v205, v32
  v_sub_f32 v141, v141, v32
  v_sub_f32 v173, v173, v32
  v_sub_f32 v206, v206, v32
  v_sub_f32 v142, v142, v32
  v_sub_f32 v174, v174, v32
  v_sub_f32 v207, v207, v32
  v_sub_f32 v143, v143, v32
  v_sub_f32 v175, v175, v32
  v_mul_f32 v28, v28, v34
  v_accvgpr_read_b32 v36, a0
  v_mul_f32 v36, v36, v34
  v_accvgpr_write_b32 a0, v36
  v_accvgpr_read_b32 v36, a1
  v_mul_f32 v36, v36, v34
  v_accvgpr_write_b32 a1, v36
  v_accvgpr_read_b32 v36, a2
  v_mul_f32 v36, v36, v34
  v_accvgpr_write_b32 a2, v36
  v_accvgpr_read_b32 v36, a3
  v_mul_f32 v36, v36, v34
  v_accvgpr_write_b32 a3, v36
  v_accvgpr_read_b32 v36, a4
  v_mul_f32 v36, v36, v34
  v_accvgpr_write_b32 a4, v36
  v_accvgpr_read_b32 v36, a5
  v_mul_f32 v36, v36, v34
  v_accvgpr_write_b32 a5, v36
  v_accvgpr_read_b32 v36, a6
  v_mul_f32 v36, v36, v34
  v_accvgpr_write_b32 a6, v36
  v_accvgpr_read_b32 v36, a7
  v_mul_f32 v36, v36, v34
  v_accvgpr_write_b32 a7, v36
  v_accvgpr_read_b32 v36, a8
  v_mul_f32 v36, v36, v34
  v_accvgpr_write_b32 a8, v36
  v_accvgpr_read_b32 v36, a9
  v_mul_f32 v36, v36, v34
  v_accvgpr_write_b32 a9, v36
  v_accvgpr_read_b32 v36, a10
  v_mul_f32 v36, v36, v34
  v_accvgpr_write_b32 a10, v36
  v_accvgpr_read_b32 v36, a11
  v_mul_f32 v36, v36, v34
  v_accvgpr_write_b32 a11, v36
  v_accvgpr_read_b32 v36, a12
  v_mul_f32 v36, v36, v34
  v_accvgpr_write_b32 a12, v36
  v_accvgpr_read_b32 v36, a13
  v_mul_f32 v36, v36, v34
  v_accvgpr_write_b32 a13, v36
  v_accvgpr_read_b32 v36, a14
  v_mul_f32 v36, v36, v34
  v_accvgpr_write_b32 a14, v36
  v_accvgpr_read_b32 v36, a15
  v_mul_f32 v36, v36, v34
  v_accvgpr_write_b32 a15, v36
  v_accvgpr_read_b32 v36, a32
  v_mul_f32 v36, v36, v34
  v_accvgpr_write_b32 a32, v36
  v_accvgpr_read_b32 v36, a33
  v_mul_f32 v36, v36, v34
  v_accvgpr_write_b32 a33, v36
  v_accvgpr_read_b32 v36, a34
  v_mul_f32 v36, v36, v34
  v_accvgpr_write_b32 a34, v36
  v_accvgpr_read_b32 v36, a35
  v_mul_f32 v36, v36, v34
  v_accvgpr_write_b32 a35, v36
  v_accvgpr_read_b32 v36, a36
  v_mul_f32 v36, v36, v34
  v_accvgpr_write_b32 a36, v36
  v_accvgpr_read_b32 v36, a37
  v_mul_f32 v36, v36, v34
  v_accvgpr_write_b32 a37, v36
  v_accvgpr_read_b32 v36, a38
  v_mul_f32 v36, v36, v34
  v_accvgpr_write_b32 a38, v36
  v_accvgpr_read_b32 v36, a39
  v_mul_f32 v36, v36, v34
  v_accvgpr_write_b32 a39, v36
  v_accvgpr_read_b32 v36, a40
  v_mul_f32 v36, v36, v34
  v_accvgpr_write_b32 a40, v36
  v_accvgpr_read_b32 v36, a41
  v_mul_f32 v36, v36, v34
  v_accvgpr_write_b32 a41, v36
  v_accvgpr_read_b32 v36, a42
  v_mul_f32 v36, v36, v34
  v_accvgpr_write_b32 a42, v36
  v_accvgpr_read_b32 v36, a43
  v_mul_f32 v36, v36, v34
  v_accvgpr_write_b32 a43, v36
  v_accvgpr_read_b32 v36, a44
  v_mul_f32 v36, v36, v34
  v_accvgpr_write_b32 a44, v36
  v_accvgpr_read_b32 v36, a45
  v_mul_f32 v36, v36, v34
  v_accvgpr_write_b32 a45, v36
  v_accvgpr_read_b32 v36, a46
  v_mul_f32 v36, v36, v34
  v_accvgpr_write_b32 a46, v36
  v_accvgpr_read_b32 v36, a47
  v_mul_f32 v36, v36, v34
  v_accvgpr_write_b32 a47, v36
  v_accvgpr_read_b32 v36, a64
  v_mul_f32 v36, v36, v34
  v_accvgpr_write_b32 a64, v36
  v_accvgpr_read_b32 v36, a65
  v_mul_f32 v36, v36, v34
  v_accvgpr_write_b32 a65, v36
  v_accvgpr_read_b32 v36, a66
  v_mul_f32 v36, v36, v34
  v_accvgpr_write_b32 a66, v36
  v_accvgpr_read_b32 v36, a67
  v_mul_f32 v36, v36, v34
  v_accvgpr_write_b32 a67, v36
  v_accvgpr_read_b32 v36, a68
  v_mul_f32 v36, v36, v34
  v_accvgpr_write_b32 a68, v36
  v_accvgpr_read_b32 v36, a69
  v_mul_f32 v36, v36, v34
  v_accvgpr_write_b32 a69, v36
  v_accvgpr_read_b32 v36, a70
  v_mul_f32 v36, v36, v34
  v_accvgpr_write_b32 a70, v36
  v_accvgpr_read_b32 v36, a71
  v_mul_f32 v36, v36, v34
  v_accvgpr_write_b32 a71, v36
  v_accvgpr_read_b32 v36, a72
  v_mul_f32 v36, v36, v34
  v_accvgpr_write_b32 a72, v36
  v_accvgpr_read_b32 v36, a73
  v_mul_f32 v36, v36, v34
  v_accvgpr_write_b32 a73, v36
  v_accvgpr_read_b32 v36, a74
  v_mul_f32 v36, v36, v34
  v_accvgpr_write_b32 a74, v36
  v_accvgpr_read_b32 v36, a75
  v_mul_f32 v36, v36, v34
  v_accvgpr_write_b32 a75, v36
  v_accvgpr_read_b32 v36, a76
  v_mul_f32 v36, v36, v34
  v_accvgpr_write_b32 a76, v36
  v_accvgpr_read_b32 v36, a77
  v_mul_f32 v36, v36, v34
  v_accvgpr_write_b32 a77, v36
  v_accvgpr_read_b32 v36, a78
  v_mul_f32 v36, v36, v34
  v_accvgpr_write_b32 a78, v36
  v_accvgpr_read_b32 v36, a79
  v_mul_f32 v36, v36, v34
  v_accvgpr_write_b32 a79, v36
  v_accvgpr_read_b32 v36, a96
  v_mul_f32 v36, v36, v34
  v_accvgpr_write_b32 a96, v36
  v_accvgpr_read_b32 v36, a97
  v_mul_f32 v36, v36, v34
  v_accvgpr_write_b32 a97, v36
  v_accvgpr_read_b32 v36, a98
  v_mul_f32 v36, v36, v34
  v_accvgpr_write_b32 a98, v36
  v_accvgpr_read_b32 v36, a99
  v_mul_f32 v36, v36, v34
  v_accvgpr_write_b32 a99, v36
  v_accvgpr_read_b32 v36, a100
  v_mul_f32 v36, v36, v34
  v_accvgpr_write_b32 a100, v36
  v_accvgpr_read_b32 v36, a101
  v_mul_f32 v36, v36, v34
  v_accvgpr_write_b32 a101, v36
  v_accvgpr_read_b32 v36, a102
  v_mul_f32 v36, v36, v34
  v_accvgpr_write_b32 a102, v36
  v_accvgpr_read_b32 v36, a103
  v_mul_f32 v36, v36, v34
  v_accvgpr_write_b32 a103, v36
  v_accvgpr_read_b32 v36, a104
  v_mul_f32 v36, v36, v34
  v_accvgpr_write_b32 a104, v36
  v_accvgpr_read_b32 v36, a105
  v_mul_f32 v36, v36, v34
  v_accvgpr_write_b32 a105, v36
  v_accvgpr_read_b32 v36, a106
  v_mul_f32 v36, v36, v34
  v_accvgpr_write_b32 a106, v36
  v_accvgpr_read_b32 v36, a107
  v_mul_f32 v36, v36, v34
  v_accvgpr_write_b32 a107, v36
  v_accvgpr_read_b32 v36, a108
  v_mul_f32 v36, v36, v34
  v_accvgpr_write_b32 a108, v36
  v_accvgpr_read_b32 v36, a109
  v_mul_f32 v36, v36, v34
  v_accvgpr_write_b32 a109, v36
  v_accvgpr_read_b32 v36, a110
  v_mul_f32 v36, v36, v34
  v_accvgpr_write_b32 a110, v36
  v_accvgpr_read_b32 v36, a111
  v_mul_f32 v36, v36, v34
  v_accvgpr_write_b32 a111, v36
  v_max_f32 v33, 0, v33
  v_exp_f32 v35, -v33
  v_sub_f32 v208, v208, v33
  v_sub_f32 v144, v144, v33
  v_sub_f32 v176, v176, v33
  v_sub_f32 v209, v209, v33
  v_sub_f32 v145, v145, v33
  v_sub_f32 v177, v177, v33
  v_sub_f32 v210, v210, v33
  v_sub_f32 v146, v146, v33
  v_sub_f32 v178, v178, v33
  v_sub_f32 v211, v211, v33
  v_sub_f32 v147, v147, v33
  v_sub_f32 v179, v179, v33
  v_sub_f32 v212, v212, v33
  v_sub_f32 v148, v148, v33
  v_sub_f32 v180, v180, v33
  v_sub_f32 v213, v213, v33
  v_sub_f32 v149, v149, v33
  v_sub_f32 v181, v181, v33
  v_sub_f32 v214, v214, v33
  v_sub_f32 v150, v150, v33
  v_sub_f32 v182, v182, v33
  v_sub_f32 v215, v215, v33
  v_sub_f32 v151, v151, v33
  v_sub_f32 v183, v183, v33
  v_sub_f32 v216, v216, v33
  v_sub_f32 v152, v152, v33
  v_sub_f32 v184, v184, v33
  v_sub_f32 v217, v217, v33
  v_sub_f32 v153, v153, v33
  v_sub_f32 v185, v185, v33
  v_sub_f32 v218, v218, v33
  v_sub_f32 v154, v154, v33
  v_sub_f32 v186, v186, v33
  v_sub_f32 v219, v219, v33
  v_sub_f32 v155, v155, v33
  v_sub_f32 v187, v187, v33
  v_sub_f32 v220, v220, v33
  v_sub_f32 v156, v156, v33
  v_sub_f32 v188, v188, v33
  v_sub_f32 v221, v221, v33
  v_sub_f32 v157, v157, v33
  v_sub_f32 v189, v189, v33
  v_sub_f32 v222, v222, v33
  v_sub_f32 v158, v158, v33
  v_sub_f32 v190, v190, v33
  v_sub_f32 v223, v223, v33
  v_sub_f32 v159, v159, v33
  v_sub_f32 v191, v191, v33
  v_mul_f32 v29, v29, v35
  v_accvgpr_read_b32 v36, a16
  v_mul_f32 v36, v36, v35
  v_accvgpr_write_b32 a16, v36
  v_accvgpr_read_b32 v36, a17
  v_mul_f32 v36, v36, v35
  v_accvgpr_write_b32 a17, v36
  v_accvgpr_read_b32 v36, a18
  v_mul_f32 v36, v36, v35
  v_accvgpr_write_b32 a18, v36
  v_accvgpr_read_b32 v36, a19
  v_mul_f32 v36, v36, v35
  v_accvgpr_write_b32 a19, v36
  v_accvgpr_read_b32 v36, a20
  v_mul_f32 v36, v36, v35
  v_accvgpr_write_b32 a20, v36
  v_accvgpr_read_b32 v36, a21
  v_mul_f32 v36, v36, v35
  v_accvgpr_write_b32 a21, v36
  v_accvgpr_read_b32 v36, a22
  v_mul_f32 v36, v36, v35
  v_accvgpr_write_b32 a22, v36
  v_accvgpr_read_b32 v36, a23
  v_mul_f32 v36, v36, v35
  v_accvgpr_write_b32 a23, v36
  v_accvgpr_read_b32 v36, a24
  v_mul_f32 v36, v36, v35
  v_accvgpr_write_b32 a24, v36
  v_accvgpr_read_b32 v36, a25
  v_mul_f32 v36, v36, v35
  v_accvgpr_write_b32 a25, v36
  v_accvgpr_read_b32 v36, a26
  v_mul_f32 v36, v36, v35
  v_accvgpr_write_b32 a26, v36
  v_accvgpr_read_b32 v36, a27
  v_mul_f32 v36, v36, v35
  v_accvgpr_write_b32 a27, v36
  v_accvgpr_read_b32 v36, a28
  v_mul_f32 v36, v36, v35
  v_accvgpr_write_b32 a28, v36
  v_accvgpr_read_b32 v36, a29
  v_mul_f32 v36, v36, v35
  v_accvgpr_write_b32 a29, v36
  v_accvgpr_read_b32 v36, a30
  v_mul_f32 v36, v36, v35
  v_accvgpr_write_b32 a30, v36
  v_accvgpr_read_b32 v36, a31
  v_mul_f32 v36, v36, v35
  v_accvgpr_write_b32 a31, v36
  v_accvgpr_read_b32 v36, a48
  v_mul_f32 v36, v36, v35
  v_accvgpr_write_b32 a48, v36
  v_accvgpr_read_b32 v36, a49
  v_mul_f32 v36, v36, v35
  v_accvgpr_write_b32 a49, v36
  v_accvgpr_read_b32 v36, a50
  v_mul_f32 v36, v36, v35
  v_accvgpr_write_b32 a50, v36
  v_accvgpr_read_b32 v36, a51
  v_mul_f32 v36, v36, v35
  v_accvgpr_write_b32 a51, v36
  v_accvgpr_read_b32 v36, a52
  v_mul_f32 v36, v36, v35
  v_accvgpr_write_b32 a52, v36
  v_accvgpr_read_b32 v36, a53
  v_mul_f32 v36, v36, v35
  v_accvgpr_write_b32 a53, v36
  v_accvgpr_read_b32 v36, a54
  v_mul_f32 v36, v36, v35
  v_accvgpr_write_b32 a54, v36
  v_accvgpr_read_b32 v36, a55
  v_mul_f32 v36, v36, v35
  v_accvgpr_write_b32 a55, v36
  v_accvgpr_read_b32 v36, a56
  v_mul_f32 v36, v36, v35
  v_accvgpr_write_b32 a56, v36
  v_accvgpr_read_b32 v36, a57
  v_mul_f32 v36, v36, v35
  v_accvgpr_write_b32 a57, v36
  v_accvgpr_read_b32 v36, a58
  v_mul_f32 v36, v36, v35
  v_accvgpr_write_b32 a58, v36
  v_accvgpr_read_b32 v36, a59
  v_mul_f32 v36, v36, v35
  v_accvgpr_write_b32 a59, v36
  v_accvgpr_read_b32 v36, a60
  v_mul_f32 v36, v36, v35
  v_accvgpr_write_b32 a60, v36
  v_accvgpr_read_b32 v36, a61
  v_mul_f32 v36, v36, v35
  v_accvgpr_write_b32 a61, v36
  v_accvgpr_read_b32 v36, a62
  v_mul_f32 v36, v36, v35
  v_accvgpr_write_b32 a62, v36
  v_accvgpr_read_b32 v36, a63
  v_mul_f32 v36, v36, v35
  v_accvgpr_write_b32 a63, v36
  v_accvgpr_read_b32 v36, a80
  v_mul_f32 v36, v36, v35
  v_accvgpr_write_b32 a80, v36
  v_accvgpr_read_b32 v36, a81
  v_mul_f32 v36, v36, v35
  v_accvgpr_write_b32 a81, v36
  v_accvgpr_read_b32 v36, a82
  v_mul_f32 v36, v36, v35
  v_accvgpr_write_b32 a82, v36
  v_accvgpr_read_b32 v36, a83
  v_mul_f32 v36, v36, v35
  v_accvgpr_write_b32 a83, v36
  v_accvgpr_read_b32 v36, a84
  v_mul_f32 v36, v36, v35
  v_accvgpr_write_b32 a84, v36
  v_accvgpr_read_b32 v36, a85
  v_mul_f32 v36, v36, v35
  v_accvgpr_write_b32 a85, v36
  v_accvgpr_read_b32 v36, a86
  v_mul_f32 v36, v36, v35
  v_accvgpr_write_b32 a86, v36
  v_accvgpr_read_b32 v36, a87
  v_mul_f32 v36, v36, v35
  v_accvgpr_write_b32 a87, v36
  v_accvgpr_read_b32 v36, a88
  v_mul_f32 v36, v36, v35
  v_accvgpr_write_b32 a88, v36
  v_accvgpr_read_b32 v36, a89
  v_mul_f32 v36, v36, v35
  v_accvgpr_write_b32 a89, v36
  v_accvgpr_read_b32 v36, a90
  v_mul_f32 v36, v36, v35
  v_accvgpr_write_b32 a90, v36
  v_accvgpr_read_b32 v36, a91
  v_mul_f32 v36, v36, v35
  v_accvgpr_write_b32 a91, v36
  v_accvgpr_read_b32 v36, a92
  v_mul_f32 v36, v36, v35
  v_accvgpr_write_b32 a92, v36
  v_accvgpr_read_b32 v36, a93
  v_mul_f32 v36, v36, v35
  v_accvgpr_write_b32 a93, v36
  v_accvgpr_read_b32 v36, a94
  v_mul_f32 v36, v36, v35
  v_accvgpr_write_b32 a94, v36
  v_accvgpr_read_b32 v36, a95
  v_mul_f32 v36, v36, v35
  v_accvgpr_write_b32 a95, v36
  v_accvgpr_read_b32 v36, a112
  v_mul_f32 v36, v36, v35
  v_accvgpr_write_b32 a112, v36
  v_accvgpr_read_b32 v36, a113
  v_mul_f32 v36, v36, v35
  v_accvgpr_write_b32 a113, v36
  v_accvgpr_read_b32 v36, a114
  v_mul_f32 v36, v36, v35
  v_accvgpr_write_b32 a114, v36
  v_accvgpr_read_b32 v36, a115
  v_mul_f32 v36, v36, v35
  v_accvgpr_write_b32 a115, v36
  v_accvgpr_read_b32 v36, a116
  v_mul_f32 v36, v36, v35
  v_accvgpr_write_b32 a116, v36
  v_accvgpr_read_b32 v36, a117
  v_mul_f32 v36, v36, v35
  v_accvgpr_write_b32 a117, v36
  v_accvgpr_read_b32 v36, a118
  v_mul_f32 v36, v36, v35
  v_accvgpr_write_b32 a118, v36
  v_accvgpr_read_b32 v36, a119
  v_mul_f32 v36, v36, v35
  v_accvgpr_write_b32 a119, v36
  v_accvgpr_read_b32 v36, a120
  v_mul_f32 v36, v36, v35
  v_accvgpr_write_b32 a120, v36
  v_accvgpr_read_b32 v36, a121
  v_mul_f32 v36, v36, v35
  v_accvgpr_write_b32 a121, v36
  v_accvgpr_read_b32 v36, a122
  v_mul_f32 v36, v36, v35
  v_accvgpr_write_b32 a122, v36
  v_accvgpr_read_b32 v36, a123
  v_mul_f32 v36, v36, v35
  v_accvgpr_write_b32 a123, v36
  v_accvgpr_read_b32 v36, a124
  v_mul_f32 v36, v36, v35
  v_accvgpr_write_b32 a124, v36
  v_accvgpr_read_b32 v36, a125
  v_mul_f32 v36, v36, v35
  v_accvgpr_write_b32 a125, v36
  v_accvgpr_read_b32 v36, a126
  v_mul_f32 v36, v36, v35
  v_accvgpr_write_b32 a126, v36
  v_accvgpr_read_b32 v36, a127
  v_mul_f32 v36, v36, v35
  v_accvgpr_write_b32 a127, v36
  v_exp_f32 v32, v128
  v_exp_f32 v33, v129
  v_exp_f32 v34, v130
  v_exp_f32 v35, v131
  v_add_f32 v30, v32, v33
  v_cvt_pk_bf16_f32 v224, v32, v33
  v_exp_f32 v36, v132
  v_exp_f32 v37, v133
  v_add_f32 v30, v30, v34
  v_add_f32 v30, v30, v35
  v_cvt_pk_bf16_f32 v225, v34, v35
  v_exp_f32 v38, v134
  v_exp_f32 v39, v135
  v_add_f32 v30, v30, v36
  v_add_f32 v30, v30, v37
  v_cvt_pk_bf16_f32 v226, v36, v37
  v_exp_f32 v40, v144
  v_exp_f32 v41, v145
  v_add_f32 v30, v30, v38
  v_add_f32 v30, v30, v39
  v_cvt_pk_bf16_f32 v227, v38, v39
  v_exp_f32 v42, v146
  v_exp_f32 v43, v147
  v_add_f32 v31, v40, v41
  v_cvt_pk_bf16_f32 v232, v40, v41
  v_exp_f32 v32, v148
  v_exp_f32 v33, v149
  v_add_f32 v31, v31, v42
  v_add_f32 v31, v31, v43
  v_cvt_pk_bf16_f32 v233, v42, v43
  v_exp_f32 v34, v150
  v_exp_f32 v35, v151
  v_add_f32 v31, v31, v32
  v_add_f32 v31, v31, v33
  v_cvt_pk_bf16_f32 v234, v32, v33
  v_exp_f32 v36, v136
  v_exp_f32 v37, v137
  v_add_f32 v31, v31, v34
  v_add_f32 v31, v31, v35
  v_cvt_pk_bf16_f32 v235, v34, v35
  v_exp_f32 v38, v138
  v_exp_f32 v39, v139
  v_add_f32 v30, v30, v36
  v_add_f32 v30, v30, v37
  v_cvt_pk_bf16_f32 v228, v36, v37
  v_exp_f32 v40, v140
  v_exp_f32 v41, v141
  v_add_f32 v30, v30, v38
  v_add_f32 v30, v30, v39
  v_cvt_pk_bf16_f32 v229, v38, v39
  v_exp_f32 v42, v142
  v_exp_f32 v43, v143
  v_add_f32 v30, v30, v40
  v_add_f32 v30, v30, v41
  v_cvt_pk_bf16_f32 v230, v40, v41
  v_exp_f32 v32, v152
  v_exp_f32 v33, v153
  v_add_f32 v30, v30, v42
  v_add_f32 v30, v30, v43
  v_cvt_pk_bf16_f32 v231, v42, v43
  v_exp_f32 v34, v154
  v_exp_f32 v35, v155
  v_add_f32 v31, v31, v32
  v_add_f32 v31, v31, v33
  v_cvt_pk_bf16_f32 v236, v32, v33
  v_exp_f32 v36, v156
  v_exp_f32 v37, v157
  v_add_f32 v31, v31, v34
  v_add_f32 v31, v31, v35
  v_cvt_pk_bf16_f32 v237, v34, v35
  v_exp_f32 v38, v158
  v_exp_f32 v39, v159
  v_add_f32 v31, v31, v36
  v_add_f32 v31, v31, v37
  v_cvt_pk_bf16_f32 v238, v36, v37
  v_add_f32 v31, v31, v38
  v_add_f32 v31, v31, v39
  v_cvt_pk_bf16_f32 v239, v38, v39
  s_nop 7
  s_setpc_b64 s[60:61]
L_slow_1:
  s_waitcnt lgkmcnt(0)
  s_nop 15
  s_nop 7
  v_max3_f32 v32, v160, v161, v162
  v_max3_f32 v32, v32, v163, v164
  v_max3_f32 v32, v32, v165, v166
  v_max3_f32 v32, v32, v167, v168
  v_max3_f32 v32, v32, v169, v170
  v_max3_f32 v32, v32, v171, v172
  v_max3_f32 v32, v32, v173, v174
  v_max_f32 v32, v32, v175
  v_max3_f32 v33, v176, v177, v178
  v_max3_f32 v33, v33, v179, v180
  v_max3_f32 v33, v33, v181, v182
  v_max3_f32 v33, v33, v183, v184
  v_max3_f32 v33, v33, v185, v186
  v_max3_f32 v33, v33, v187, v188
  v_max3_f32 v33, v33, v189, v190
  v_max_f32 v33, v33, v191
  s_nop 1
  v_permlane32_swap_b32 v32, v33
  v_max_f32 v32, v32, v33
  v_mov_b32 v33, v32
  s_nop 1
  v_permlane32_swap_b32 v32, v33
  v_max_f32 v32, 0, v32
  v_exp_f32 v34, -v32
  v_sub_f32 v192, v192, v32
  v_sub_f32 v160, v160, v32
  v_sub_f32 v128, v128, v32
  v_sub_f32 v193, v193, v32
  v_sub_f32 v161, v161, v32
  v_sub_f32 v129, v129, v32
  v_sub_f32 v194, v194, v32
  v_sub_f32 v162, v162, v32
  v_sub_f32 v130, v130, v32
  v_sub_f32 v195, v195, v32
  v_sub_f32 v163, v163, v32
  v_sub_f32 v131, v131, v32
  v_sub_f32 v196, v196, v32
  v_sub_f32 v164, v164, v32
  v_sub_f32 v132, v132, v32
  v_sub_f32 v197, v197, v32
  v_sub_f32 v165, v165, v32
  v_sub_f32 v133, v133, v32
  v_sub_f32 v198, v198, v32
  v_sub_f32 v166, v166, v32
  v_sub_f32 v134, v134, v32
  v_sub_f32 v199, v199, v32
  v_sub_f32 v167, v167, v32
  v_sub_f32 v135, v135, v32
  v_sub_f32 v200, v200, v32
  v_sub_f32 v168, v168, v32
  v_sub_f32 v136, v136, v32
  v_sub_f32 v201, v201, v32
  v_sub_f32 v169, v169, v32
  v_sub_f32 v137, v137, v32
  v_sub_f32 v202, v202, v32
  v_sub_f32 v170, v170, v32
  v_sub_f32 v138, v138, v32
  v_sub_f32 v203, v203, v32
  v_sub_f32 v171, v171, v32
  v_sub_f32 v139, v139, v32
  v_sub_f32 v204, v204, v32
  v_sub_f32 v172, v172, v32
  v_sub_f32 v140, v140, v32
  v_sub_f32 v205, v205, v32
  v_sub_f32 v173, v173, v32
  v_sub_f32 v141, v141, v32
  v_sub_f32 v206, v206, v32
  v_sub_f32 v174, v174, v32
  v_sub_f32 v142, v142, v32
  v_sub_f32 v207, v207, v32
  v_sub_f32 v175, v175, v32
  v_sub_f32 v143, v143, v32
  v_mul_f32 v28, v28, v34
  v_accvgpr_read_b32 v36, a0
  v_mul_f32 v36, v36, v34
  v_accvgpr_write_b32 a0, v36
  v_accvgpr_read_b32 v36, a1
  v_mul_f32 v36, v36, v34
  v_accvgpr_write_b32 a1, v36
  v_accvgpr_read_b32 v36, a2
  v_mul_f32 v36, v36, v34
  v_accvgpr_write_b32 a2, v36
  v_accvgpr_read_b32 v36, a3
  v_mul_f32 v36, v36, v34
  v_accvgpr_write_b32 a3, v36
  v_accvgpr_read_b32 v36, a4
  v_mul_f32 v36, v36, v34
  v_accvgpr_write_b32 a4, v36
  v_accvgpr_read_b32 v36, a5
  v_mul_f32 v36, v36, v34
  v_accvgpr_write_b32 a5, v36
  v_accvgpr_read_b32 v36, a6
  v_mul_f32 v36, v36, v34
  v_accvgpr_write_b32 a6, v36
  v_accvgpr_read_b32 v36, a7
  v_mul_f32 v36, v36, v34
  v_accvgpr_write_b32 a7, v36
  v_accvgpr_read_b32 v36, a8
  v_mul_f32 v36, v36, v34
  v_accvgpr_write_b32 a8, v36
  v_accvgpr_read_b32 v36, a9
  v_mul_f32 v36, v36, v34
  v_accvgpr_write_b32 a9, v36
  v_accvgpr_read_b32 v36, a10
  v_mul_f32 v36, v36, v34
  v_accvgpr_write_b32 a10, v36
  v_accvgpr_read_b32 v36, a11
  v_mul_f32 v36, v36, v34
  v_accvgpr_write_b32 a11, v36
  v_accvgpr_read_b32 v36, a12
  v_mul_f32 v36, v36, v34
  v_accvgpr_write_b32 a12, v36
  v_accvgpr_read_b32 v36, a13
  v_mul_f32 v36, v36, v34
  v_accvgpr_write_b32 a13, v36
  v_accvgpr_read_b32 v36, a14
  v_mul_f32 v36, v36, v34
  v_accvgpr_write_b32 a14, v36
  v_accvgpr_read_b32 v36, a15
  v_mul_f32 v36, v36, v34
  v_accvgpr_write_b32 a15, v36
  v_accvgpr_read_b32 v36, a32
  v_mul_f32 v36, v36, v34
  v_accvgpr_write_b32 a32, v36
  v_accvgpr_read_b32 v36, a33
  v_mul_f32 v36, v36, v34
  v_accvgpr_write_b32 a33, v36
  v_accvgpr_read_b32 v36, a34
  v_mul_f32 v36, v36, v34
  v_accvgpr_write_b32 a34, v36
  v_accvgpr_read_b32 v36, a35
  v_mul_f32 v36, v36, v34
  v_accvgpr_write_b32 a35, v36
  v_accvgpr_read_b32 v36, a36
  v_mul_f32 v36, v36, v34
  v_accvgpr_write_b32 a36, v36
  v_accvgpr_read_b32 v36, a37
  v_mul_f32 v36, v36, v34
  v_accvgpr_write_b32 a37, v36
  v_accvgpr_read_b32 v36, a38
  v_mul_f32 v36, v36, v34
  v_accvgpr_write_b32 a38, v36
  v_accvgpr_read_b32 v36, a39
  v_mul_f32 v36, v36, v34
  v_accvgpr_write_b32 a39, v36
  v_accvgpr_read_b32 v36, a40
  v_mul_f32 v36, v36, v34
  v_accvgpr_write_b32 a40, v36
  v_accvgpr_read_b32 v36, a41
  v_mul_f32 v36, v36, v34
  v_accvgpr_write_b32 a41, v36
  v_accvgpr_read_b32 v36, a42
  v_mul_f32 v36, v36, v34
  v_accvgpr_write_b32 a42, v36
  v_accvgpr_read_b32 v36, a43
  v_mul_f32 v36, v36, v34
  v_accvgpr_write_b32 a43, v36
  v_accvgpr_read_b32 v36, a44
  v_mul_f32 v36, v36, v34
  v_accvgpr_write_b32 a44, v36
  v_accvgpr_read_b32 v36, a45
  v_mul_f32 v36, v36, v34
  v_accvgpr_write_b32 a45, v36
  v_accvgpr_read_b32 v36, a46
  v_mul_f32 v36, v36, v34
  v_accvgpr_write_b32 a46, v36
  v_accvgpr_read_b32 v36, a47
  v_mul_f32 v36, v36, v34
  v_accvgpr_write_b32 a47, v36
  v_accvgpr_read_b32 v36, a64
  v_mul_f32 v36, v36, v34
  v_accvgpr_write_b32 a64, v36
  v_accvgpr_read_b32 v36, a65
  v_mul_f32 v36, v36, v34
  v_accvgpr_write_b32 a65, v36
  v_accvgpr_read_b32 v36, a66
  v_mul_f32 v36, v36, v34
  v_accvgpr_write_b32 a66, v36
  v_accvgpr_read_b32 v36, a67
  v_mul_f32 v36, v36, v34
  v_accvgpr_write_b32 a67, v36
  v_accvgpr_read_b32 v36, a68
  v_mul_f32 v36, v36, v34
  v_accvgpr_write_b32 a68, v36
  v_accvgpr_read_b32 v36, a69
  v_mul_f32 v36, v36, v34
  v_accvgpr_write_b32 a69, v36
  v_accvgpr_read_b32 v36, a70
  v_mul_f32 v36, v36, v34
  v_accvgpr_write_b32 a70, v36
  v_accvgpr_read_b32 v36, a71
  v_mul_f32 v36, v36, v34
  v_accvgpr_write_b32 a71, v36
  v_accvgpr_read_b32 v36, a72
  v_mul_f32 v36, v36, v34
  v_accvgpr_write_b32 a72, v36
  v_accvgpr_read_b32 v36, a73
  v_mul_f32 v36, v36, v34
  v_accvgpr_write_b32 a73, v36
  v_accvgpr_read_b32 v36, a74
  v_mul_f32 v36, v36, v34
  v_accvgpr_write_b32 a74, v36
  v_accvgpr_read_b32 v36, a75
  v_mul_f32 v36, v36, v34
  v_accvgpr_write_b32 a75, v36
  v_accvgpr_read_b32 v36, a76
  v_mul_f32 v36, v36, v34
  v_accvgpr_write_b32 a76, v36
  v_accvgpr_read_b32 v36, a77
  v_mul_f32 v36, v36, v34
  v_accvgpr_write_b32 a77, v36
  v_accvgpr_read_b32 v36, a78
  v_mul_f32 v36, v36, v34
  v_accvgpr_write_b32 a78, v36
  v_accvgpr_read_b32 v36, a79
  v_mul_f32 v36, v36, v34
  v_accvgpr_write_b32 a79, v36
  v_accvgpr_read_b32 v36, a96
  v_mul_f32 v36, v36, v34
  v_accvgpr_write_b32 a96, v36
  v_accvgpr_read_b32 v36, a97
  v_mul_f32 v36, v36, v34
  v_accvgpr_write_b32 a97, v36
  v_accvgpr_read_b32 v36, a98
  v_mul_f32 v36, v36, v34
  v_accvgpr_write_b32 a98, v36
  v_accvgpr_read_b32 v36, a99
  v_mul_f32 v36, v36, v34
  v_accvgpr_write_b32 a99, v36
  v_accvgpr_read_b32 v36, a100
  v_mul_f32 v36, v36, v34
  v_accvgpr_write_b32 a100, v36
  v_accvgpr_read_b32 v36, a101
  v_mul_f32 v36, v36, v34
  v_accvgpr_write_b32 a101, v36
  v_accvgpr_read_b32 v36, a102
  v_mul_f32 v36, v36, v34
  v_accvgpr_write_b32 a102, v36
  v_accvgpr_read_b32 v36, a103
  v_mul_f32 v36, v36, v34
  v_accvgpr_write_b32 a103, v36
  v_accvgpr_read_b32 v36, a104
  v_mul_f32 v36, v36, v34
  v_accvgpr_write_b32 a104, v36
  v_accvgpr_read_b32 v36, a105
  v_mul_f32 v36, v36, v34
  v_accvgpr_write_b32 a105, v36
  v_accvgpr_read_b32 v36, a106
  v_mul_f32 v36, v36, v34
  v_accvgpr_write_b32 a106, v36
  v_accvgpr_read_b32 v36, a107
  v_mul_f32 v36, v36, v34
  v_accvgpr_write_b32 a107, v36
  v_accvgpr_read_b32 v36, a108
  v_mul_f32 v36, v36, v34
  v_accvgpr_write_b32 a108, v36
  v_accvgpr_read_b32 v36, a109
  v_mul_f32 v36, v36, v34
  v_accvgpr_write_b32 a109, v36
  v_accvgpr_read_b32 v36, a110
  v_mul_f32 v36, v36, v34
  v_accvgpr_write_b32 a110, v36
  v_accvgpr_read_b32 v36, a111
  v_mul_f32 v36, v36, v34
  v_accvgpr_write_b32 a111, v36
  v_max_f32 v33, 0, v33
  v_exp_f32 v35, -v33
  v_sub_f32 v208, v208, v33
  v_sub_f32 v176, v176, v33
  v_sub_f32 v144, v144, v33
  v_sub_f32 v209, v209, v33
  v_sub_f32 v177, v177, v33
  v_sub_f32 v145, v145, v33
  v_sub_f32 v210, v210, v33
  v_sub_f32 v178, v178, v33
  v_sub_f32 v146, v146, v33
  v_sub_f32 v211, v211, v33
  v_sub_f32 v179, v179, v33
  v_sub_f32 v147, v147, v33
  v_sub_f32 v212, v212, v33
  v_sub_f32 v180, v180, v33
  v_sub_f32 v148, v148, v33
  v_sub_f32 v213, v213, v33
  v_sub_f32 v181, v181, v33
  v_sub_f32 v149, v149, v33
  v_sub_f32 v214, v214, v33
  v_sub_f32 v182, v182, v33
  v_sub_f32 v150, v150, v33
  v_sub_f32 v215, v215, v33
  v_sub_f32 v183, v183, v33
  v_sub_f32 v151, v151, v33
  v_sub_f32 v216, v216, v33
  v_sub_f32 v184, v184, v33
  v_sub_f32 v152, v152, v33
  v_sub_f32 v217, v217, v33
  v_sub_f32 v185, v185, v33
  v_sub_f32 v153, v153, v33
  v_sub_f32 v218, v218, v33
  v_sub_f32 v186, v186, v33
  v_sub_f32 v154, v154, v33
  v_sub_f32 v219, v219, v33
  v_sub_f32 v187, v187, v33
  v_sub_f32 v155, v155, v33
  v_sub_f32 v220, v220, v33
  v_sub_f32 v188, v188, v33
  v_sub_f32 v156, v156, v33
  v_sub_f32 v221, v221, v33
  v_sub_f32 v189, v189, v33
  v_sub_f32 v157, v157, v33
  v_sub_f32 v222, v222, v33
  v_sub_f32 v190, v190, v33
  v_sub_f32 v158, v158, v33
  v_sub_f32 v223, v223, v33
  v_sub_f32 v191, v191, v33
  v_sub_f32 v159, v159, v33
  v_mul_f32 v29, v29, v35
  v_accvgpr_read_b32 v36, a16
  v_mul_f32 v36, v36, v35
  v_accvgpr_write_b32 a16, v36
  v_accvgpr_read_b32 v36, a17
  v_mul_f32 v36, v36, v35
  v_accvgpr_write_b32 a17, v36
  v_accvgpr_read_b32 v36, a18
  v_mul_f32 v36, v36, v35
  v_accvgpr_write_b32 a18, v36
  v_accvgpr_read_b32 v36, a19
  v_mul_f32 v36, v36, v35
  v_accvgpr_write_b32 a19, v36
  v_accvgpr_read_b32 v36, a20
  v_mul_f32 v36, v36, v35
  v_accvgpr_write_b32 a20, v36
  v_accvgpr_read_b32 v36, a21
  v_mul_f32 v36, v36, v35
  v_accvgpr_write_b32 a21, v36
  v_accvgpr_read_b32 v36, a22
  v_mul_f32 v36, v36, v35
  v_accvgpr_write_b32 a22, v36
  v_accvgpr_read_b32 v36, a23
  v_mul_f32 v36, v36, v35
  v_accvgpr_write_b32 a23, v36
  v_accvgpr_read_b32 v36, a24
  v_mul_f32 v36, v36, v35
  v_accvgpr_write_b32 a24, v36
  v_accvgpr_read_b32 v36, a25
  v_mul_f32 v36, v36, v35
  v_accvgpr_write_b32 a25, v36
  v_accvgpr_read_b32 v36, a26
  v_mul_f32 v36, v36, v35
  v_accvgpr_write_b32 a26, v36
  v_accvgpr_read_b32 v36, a27
  v_mul_f32 v36, v36, v35
  v_accvgpr_write_b32 a27, v36
  v_accvgpr_read_b32 v36, a28
  v_mul_f32 v36, v36, v35
  v_accvgpr_write_b32 a28, v36
  v_accvgpr_read_b32 v36, a29
  v_mul_f32 v36, v36, v35
  v_accvgpr_write_b32 a29, v36
  v_accvgpr_read_b32 v36, a30
  v_mul_f32 v36, v36, v35
  v_accvgpr_write_b32 a30, v36
  v_accvgpr_read_b32 v36, a31
  v_mul_f32 v36, v36, v35
  v_accvgpr_write_b32 a31, v36
  v_accvgpr_read_b32 v36, a48
  v_mul_f32 v36, v36, v35
  v_accvgpr_write_b32 a48, v36
  v_accvgpr_read_b32 v36, a49
  v_mul_f32 v36, v36, v35
  v_accvgpr_write_b32 a49, v36
  v_accvgpr_read_b32 v36, a50
  v_mul_f32 v36, v36, v35
  v_accvgpr_write_b32 a50, v36
  v_accvgpr_read_b32 v36, a51
  v_mul_f32 v36, v36, v35
  v_accvgpr_write_b32 a51, v36
  v_accvgpr_read_b32 v36, a52
  v_mul_f32 v36, v36, v35
  v_accvgpr_write_b32 a52, v36
  v_accvgpr_read_b32 v36, a53
  v_mul_f32 v36, v36, v35
  v_accvgpr_write_b32 a53, v36
  v_accvgpr_read_b32 v36, a54
  v_mul_f32 v36, v36, v35
  v_accvgpr_write_b32 a54, v36
  v_accvgpr_read_b32 v36, a55
  v_mul_f32 v36, v36, v35
  v_accvgpr_write_b32 a55, v36
  v_accvgpr_read_b32 v36, a56
  v_mul_f32 v36, v36, v35
  v_accvgpr_write_b32 a56, v36
  v_accvgpr_read_b32 v36, a57
  v_mul_f32 v36, v36, v35
  v_accvgpr_write_b32 a57, v36
  v_accvgpr_read_b32 v36, a58
  v_mul_f32 v36, v36, v35
  v_accvgpr_write_b32 a58, v36
  v_accvgpr_read_b32 v36, a59
  v_mul_f32 v36, v36, v35
  v_accvgpr_write_b32 a59, v36
  v_accvgpr_read_b32 v36, a60
  v_mul_f32 v36, v36, v35
  v_accvgpr_write_b32 a60, v36
  v_accvgpr_read_b32 v36, a61
  v_mul_f32 v36, v36, v35
  v_accvgpr_write_b32 a61, v36
  v_accvgpr_read_b32 v36, a62
  v_mul_f32 v36, v36, v35
  v_accvgpr_write_b32 a62, v36
  v_accvgpr_read_b32 v36, a63
  v_mul_f32 v36, v36, v35
  v_accvgpr_write_b32 a63, v36
  v_accvgpr_read_b32 v36, a80
  v_mul_f32 v36, v36, v35
  v_accvgpr_write_b32 a80, v36
  v_accvgpr_read_b32 v36, a81
  v_mul_f32 v36, v36, v35
  v_accvgpr_write_b32 a81, v36
  v_accvgpr_read_b32 v36, a82
  v_mul_f32 v36, v36, v35
  v_accvgpr_write_b32 a82, v36
  v_accvgpr_read_b32 v36, a83
  v_mul_f32 v36, v36, v35
  v_accvgpr_write_b32 a83, v36
  v_accvgpr_read_b32 v36, a84
  v_mul_f32 v36, v36, v35
  v_accvgpr_write_b32 a84, v36
  v_accvgpr_read_b32 v36, a85
  v_mul_f32 v36, v36, v35
  v_accvgpr_write_b32 a85, v36
  v_accvgpr_read_b32 v36, a86
  v_mul_f32 v36, v36, v35
  v_accvgpr_write_b32 a86, v36
  v_accvgpr_read_b32 v36, a87
  v_mul_f32 v36, v36, v35
  v_accvgpr_write_b32 a87, v36
  v_accvgpr_read_b32 v36, a88
  v_mul_f32 v36, v36, v35
  v_accvgpr_write_b32 a88, v36
  v_accvgpr_read_b32 v36, a89
  v_mul_f32 v36, v36, v35
  v_accvgpr_write_b32 a89, v36
  v_accvgpr_read_b32 v36, a90
  v_mul_f32 v36, v36, v35
  v_accvgpr_write_b32 a90, v36
  v_accvgpr_read_b32 v36, a91
  v_mul_f32 v36, v36, v35
  v_accvgpr_write_b32 a91, v36
  v_accvgpr_read_b32 v36, a92
  v_mul_f32 v36, v36, v35
  v_accvgpr_write_b32 a92, v36
  v_accvgpr_read_b32 v36, a93
  v_mul_f32 v36, v36, v35
  v_accvgpr_write_b32 a93, v36
  v_accvgpr_read_b32 v36, a94
  v_mul_f32 v36, v36, v35
  v_accvgpr_write_b32 a94, v36
  v_accvgpr_read_b32 v36, a95
  v_mul_f32 v36, v36, v35
  v_accvgpr_write_b32 a95, v36
  v_accvgpr_read_b32 v36, a112
  v_mul_f32 v36, v36, v35
  v_accvgpr_write_b32 a112, v36
  v_accvgpr_read_b32 v36, a113
  v_mul_f32 v36, v36, v35
  v_accvgpr_write_b32 a113, v36
  v_accvgpr_read_b32 v36, a114
  v_mul_f32 v36, v36, v35
  v_accvgpr_write_b32 a114, v36
  v_accvgpr_read_b32 v36, a115
  v_mul_f32 v36, v36, v35
  v_accvgpr_write_b32 a115, v36
  v_accvgpr_read_b32 v36, a116
  v_mul_f32 v36, v36, v35
  v_accvgpr_write_b32 a116, v36
  v_accvgpr_read_b32 v36, a117
  v_mul_f32 v36, v36, v35
  v_accvgpr_write_b32 a117, v36
  v_accvgpr_read_b32 v36, a118
  v_mul_f32 v36, v36, v35
  v_accvgpr_write_b32 a118, v36
  v_accvgpr_read_b32 v36, a119
  v_mul_f32 v36, v36, v35
  v_accvgpr_write_b32 a119, v36
  v_accvgpr_read_b32 v36, a120
  v_mul_f32 v36, v36, v35
  v_accvgpr_write_b32 a120, v36
  v_accvgpr_read_b32 v36, a121
  v_mul_f32 v36, v36, v35
  v_accvgpr_write_b32 a121, v36
  v_accvgpr_read_b32 v36, a122
  v_mul_f32 v36, v36, v35
  v_accvgpr_write_b32 a122, v36
  v_accvgpr_read_b32 v36, a123
  v_mul_f32 v36, v36, v35
  v_accvgpr_write_b32 a123, v36
  v_accvgpr_read_b32 v36, a124
  v_mul_f32 v36, v36, v35
  v_accvgpr_write_b32 a124, v36
  v_accvgpr_read_b32 v36, a125
  v_mul_f32 v36, v36, v35
  v_accvgpr_write_b32 a125, v36
  v_accvgpr_read_b32 v36, a126
  v_mul_f32 v36, v36, v35
  v_accvgpr_write_b32 a126, v36
  v_accvgpr_read_b32 v36, a127
  v_mul_f32 v36, v36, v35
  v_accvgpr_write_b32 a127, v36
  v_exp_f32 v32, v160
  v_exp_f32 v33, v161
  v_exp_f32 v34, v162
  v_exp_f32 v35, v163
  v_add_f32 v30, v32, v33
  v_cvt_pk_bf16_f32 v240, v32, v33
  v_exp_f32 v36, v164
  v_exp_f32 v37, v165
  v_add_f32 v30, v30, v34
  v_add_f32 v30, v30, v35
  v_cvt_pk_bf16_f32 v241, v34, v35
  v_exp_f32 v38, v166
  v_exp_f32 v39, v167
  v_add_f32 v30, v30, v36
  v_add_f32 v30, v30, v37
  v_cvt_pk_bf16_f32 v242, v36, v37
  v_exp_f32 v40, v176
  v_exp_f32 v41, v177
  v_add_f32 v30, v30, v38
  v_add_f32 v30, v30, v39
  v_cvt_pk_bf16_f32 v243, v38, v39
  v_exp_f32 v42, v178
  v_exp_f32 v43, v179
  v_add_f32 v31, v40, v41
  v_cvt_pk_bf16_f32 v248, v40, v41
  v_exp_f32 v32, v180
  v_exp_f32 v33, v181
  v_add_f32 v31, v31, v42
  v_add_f32 v31, v31, v43
  v_cvt_pk_bf16_f32 v249, v42, v43
  v_exp_f32 v34, v182
  v_exp_f32 v35, v183
  v_add_f32 v31, v31, v32
  v_add_f32 v31, v31, v33
  v_cvt_pk_bf16_f32 v250, v32, v33
  v_exp_f32 v36, v168
  v_exp_f32 v37, v169
  v_add_f32 v31, v31, v34
  v_add_f32 v31, v31, v35
  v_cvt_pk_bf16_f32 v251, v34, v35
  v_exp_f32 v38, v170
  v_exp_f32 v39, v171
  v_add_f32 v30, v30, v36
  v_add_f32 v30, v30, v37
  v_cvt_pk_bf16_f32 v244, v36, v37
  v_exp_f32 v40, v172
  v_exp_f32 v41, v173
  v_add_f32 v30, v30, v38
  v_add_f32 v30, v30, v39
  v_cvt_pk_bf16_f32 v245, v38, v39
  v_exp_f32 v42, v174
  v_exp_f32 v43, v175
  v_add_f32 v30, v30, v40
  v_add_f32 v30, v30, v41
  v_cvt_pk_bf16_f32 v246, v40, v41
  v_exp_f32 v32, v184
  v_exp_f32 v33, v185
  v_add_f32 v30, v30, v42
  v_add_f32 v30, v30, v43
  v_cvt_pk_bf16_f32 v247, v42, v43
  v_exp_f32 v34, v186
  v_exp_f32 v35, v187
  v_add_f32 v31, v31, v32
  v_add_f32 v31, v31, v33
  v_cvt_pk_bf16_f32 v252, v32, v33
  v_exp_f32 v36, v188
  v_exp_f32 v37, v189
  v_add_f32 v31, v31, v34
  v_add_f32 v31, v31, v35
  v_cvt_pk_bf16_f32 v253, v34, v35
  v_exp_f32 v38, v190
  v_exp_f32 v39, v191
  v_add_f32 v31, v31, v36
  v_add_f32 v31, v31, v37
  v_cvt_pk_bf16_f32 v254, v36, v37
  v_add_f32 v31, v31, v38
  v_add_f32 v31, v31, v39
  v_cvt_pk_bf16_f32 v255, v38, v39
  s_nop 7
  s_setpc_b64 s[60:61]
L_spin_nonce:
  s_mov_b32 s77, 0
L_spin_nonce_loop:
  s_sleep 2
  v_mov_b32 v61, 0
  s_nop 1
  buffer_load_dword v61, v61, s[68:71], 0 offen sc1
  s_waitcnt vmcnt(0)
  v_readfirstlane_b32 s76, v61
  s_add_u32 s77, s77, 1
  s_cmp_ge_u32 s77, 65536
  s_cbranch_scc1 L_spin_nonce_out
  s_cmp_eq_u32 s76, 0
  s_cbranch_scc1 L_spin_nonce_loop
L_spin_nonce_out:
  s_nop 4
  s_setpc_b64 s[60:61]
L_spin_flag_0:
  s_mov_b32 s77, 0
  s_branch L_spin_flag_go_0
L_spin_flag_loop_0:
  s_sleep 16
L_spin_flag_go_0:
  buffer_load_dword v60, v58, s[72:75], 0 offen offset:0 sc1
  s_waitcnt vmcnt(0)
  v_cmp_ne_u32 vcc, s76, v60
  s_add_u32 s77, s77, 1
  s_cmp_ge_u32 s77, 65536
  s_cbranch_scc1 L_spin_flag_out_0
  s_nop 2
  s_cbranch_vccnz L_spin_flag_loop_0
L_spin_flag_out_0:
  s_nop 4
  s_setpc_b64 s[60:61]
L_spin_flag_1:
  s_mov_b32 s77, 0
  s_branch L_spin_flag_go_1
L_spin_flag_loop_1:
  s_sleep 16
L_spin_flag_go_1:
  buffer_load_dword v60, v58, s[72:75], 0 offen offset:128 sc1
  s_waitcnt vmcnt(0)
  v_cmp_ne_u32 vcc, s76, v60
  s_add_u32 s77, s77, 1
  s_cmp_ge_u32 s77, 65536
  s_cbranch_scc1 L_spin_flag_out_1
  s_nop 2
  s_cbranch_vccnz L_spin_flag_loop_1
L_spin_flag_out_1:
  s_nop 4
  s_setpc_b64 s[60:61]
L_spin_flag_2:
  s_mov_b32 s77, 0
  s_branch L_spin_flag_go_2
L_spin_flag_loop_2:
  s_sleep 4
L_spin_flag_go_2:
  buffer_load_dword v60, v58, s[72:75], 0 offen offset:256 sc1
  s_waitcnt vmcnt(0)
  v_cmp_ne_u32 vcc, s76, v60
  s_add_u32 s77, s77, 1
  s_cmp_ge_u32 s77, 65536
  s_cbranch_scc1 L_spin_flag_out_2
  s_nop 2
  s_cbranch_vccnz L_spin_flag_loop_2
L_spin_flag_out_2:
  s_nop 4
  s_setpc_b64 s[60:61]
.section .rodata,"a"
.p2align 6
.amdhsa_kernel recurrent_scan__sliding_block_cached__glu_gated_reglu__prompt_kernel
  .amdhsa_next_free_vgpr 512
  .amdhsa_next_free_sgpr 102
  .amdhsa_accum_offset 256
  .amdhsa_group_segment_fixed_size 0
  .amdhsa_kernarg_size 96
  .amdhsa_user_sgpr_count 2
  .amdhsa_user_sgpr_kernarg_segment_ptr 1
  .amdhsa_system_sgpr_workgroup_id_x 1
  .amdhsa_float_denorm_mode_32 3
.end_amdhsa_kernel
```
